```python
import torch

def _softmax(x, axis=-1):
    return torch.softmax(x, dim=axis)
def _gelu(x):
    return torch.nn.functional.gelu(x, approximate="tanh")
def _silu(x):
    return torch.nn.functional.silu(x)
def _sigmoid(x):
    return torch.sigmoid(x)
def _layernorm(x, axis=-1, eps=1e-5):
    m = x.mean(dim=axis, keepdim=True)
    v = x.var(dim=axis, keepdim=True, unbiased=False)
    return (x - m) / torch.sqrt(v + eps)
def _scatter_add(tgt, idx, src, axis=0):
    return tgt.clone().index_add_(axis, idx, src)
def _segment_sum(src, seg, n):
    out = torch.zeros((n,) + src.shape[1:], dtype=src.dtype)
    return out.index_add_(0, seg, src)
def _pad(x, pw):
    flat = tuple(v for pair in reversed(pw) for v in pair)
    return torch.nn.functional.pad(x, flat)

kernel_name = 'recurrent_scan__sliding_block_cached__glu_gated_geglu__prompt'

def setup_inputs():

    _w = (lambda a: (lambda t: t.to(torch.bfloat16) if t.is_floating_point() else t)(torch.as_tensor(a)))
    def _A_setup():
        B, Sq, D = 1, 2048, 448
        Hq, Hkv, Sk, Dh = 16, 8, 2048, 256
        assert Hq % Hkv == 0, (Hq, Hkv)
        return {
            "x": _w((lambda *s: torch.randn(*s, dtype=torch.bfloat16) * 0.2)(B, Sq, D)),
            "k_cache": _w((lambda *s: torch.randn(*s, dtype=torch.bfloat16) * 0.8)(B, Hkv, Sk, Dh)),
            "v_cache": _w((lambda *s: torch.randn(*s, dtype=torch.bfloat16) * 1.6)(B, Hkv, Sk, Dh)),
            "wq": _w((lambda *s: torch.randn(*s, dtype=torch.bfloat16) * 0.8)(D, Hq * Dh) * (D ** -0.5)),
            "wo": _w((lambda *s: torch.randn(*s, dtype=torch.bfloat16) * 1.6)(Hq * Dh, D) * ((Hq * Dh) ** -0.5)),
        }
    _A_in = _A_setup()

    def _B_setup():
        B, S, Dm, Df = 1, 2048, 448, 1792
        return {
            "x": _w((lambda *s: torch.randn(*s, dtype=torch.bfloat16) * 0.2)(B, S, Dm)),
            "w_gate": _w((lambda *s: torch.randn(*s, dtype=torch.bfloat16) * 0.8)(Dm, Df) * (Dm ** -0.5)),
            "w_up": _w((lambda *s: torch.randn(*s, dtype=torch.bfloat16) * 0.8)(Dm, Df) * (Dm ** -0.5)),
            "w_down": _w((lambda *s: torch.randn(*s, dtype=torch.bfloat16) * 0.8)(Df, Dm) * (Df ** -0.5)),
        }
    _B_in = _B_setup()

    return {
        "A_x": _A_in["x"],
        "A_k_cache": _A_in["k_cache"],
        "A_v_cache": _A_in["v_cache"],
        "A_wq": _A_in["wq"],
        "A_wo": _A_in["wo"],
        "B_x": _B_in["x"],
        "B_w_gate": _B_in["w_gate"],
        "B_w_up": _B_in["w_up"],
        "B_w_down": _B_in["w_down"],
    }

def reference(A_x, A_k_cache, A_v_cache, A_wq, A_wo, B_x, B_w_gate, B_w_up, B_w_down):
    def _A_ref(x, k_cache, v_cache, wq, wo):
        B, Sq, D = x.shape
        Hq, Dh = 16, 256
        Hkv, Sk = k_cache.shape[1], k_cache.shape[2]
        W = min(4096, max(256, Sk // 4))
        rep = Hq // Hkv
        q = (lambda x, *d: x.permute(*d))((x @ wq).reshape(B, Sq, Hq, Dh), 0, 2, 1, 3)
        k = (lambda x, n, axis: torch.repeat_interleave(x, n, dim=axis))(k_cache[:, :, Sk - W:, :], rep, axis=1)
        v = (lambda x, n, axis: torch.repeat_interleave(x, n, dim=axis))(v_cache[:, :, Sk - W:, :], rep, axis=1)
        scores = torch.einsum("bhqd,bhkd->bhqk", q, k) * (Dh ** -0.5)
        p = _softmax(scores, axis=-1)
        o = torch.einsum("bhqk,bhkd->bhqd", p, v)
        return (lambda x, *d: x.permute(*d))(o, 0, 2, 1, 3).reshape(B, Sq, Hq * Dh) @ wo

    def _B_ref(x, w_gate, w_up, w_down):
        g = torch.einsum("bsd,df->bsf", x, w_gate)
        u = torch.einsum("bsd,df->bsf", x, w_up)
        h = _gelu(g) * u
        return torch.einsum("bsf,fd->bsd", h, w_down)

    x = A_x
    xn = _layernorm(x, axis=-1)
    s = _A_ref(xn, A_k_cache, A_v_cache, A_wq, A_wo)
    g = _silu(_B_ref(xn, B_w_gate, B_w_up, B_w_down))
    return x + s * g
```

```asm
; @launch grid=(256,1,1) block=(256,1,1) lds=163840
.amdgcn_target "amdgcn-amd-amdhsa--gfx950"
.text
.globl recurrent_scan__sliding_block_cached__glu_gated_geglu__prompt_kernel
.p2align 8
.type recurrent_scan__sliding_block_cached__glu_gated_geglu__prompt_kernel,@function
recurrent_scan__sliding_block_cached__glu_gated_geglu__prompt_kernel:
s_cmp_ge_u32 s2, 256
s_cbranch_scc1 L_end_main
s_load_dwordx16 s[80:95], s[0:1], 0
s_load_dwordx8 s[72:79], s[0:1], 64
v_lshrrev_b32 v1, 6, v0
v_and_b32 v255, 63, v0
v_readfirstlane_b32 s44, v1
s_and_b32 s45, s2, 3
s_lshl_b32 s45, s45, 1
s_bfe_u32 s3, s2, 0x10003
s_add_u32 s45, s45, s3
s_bfe_u32 s46, s2, 0x10002
s_lshl_b32 s46, s46, 4
s_lshr_b32 s3, s2, 4
s_add_u32 s46, s46, s3
s_nop 1
v_lshrrev_b32 v177, 3, v255
s_lshl_b32 s98, s44, 4
v_add_u32 v177, s98, v177
v_and_b32 v176, 7, v255
v_mul_u32_u24 v177, 896, v177
v_lshlrev_b32 v176, 4, v176
v_add_u32 v235, v176, v177
s_mov_b32 s3, 7168
s_lshr_b32 s98, s2, 3
s_lshl_b32 s98, s98, 2
s_add_u32 s98, s98, s44
v_min_u32 v190, 3, v255
s_mul_i32 s98, s98, 512
v_lshlrev_b32 v190, 7, v190
s_mov_b32 s99, L_end_main-L_pc
v_add_u32 v190, s98, v190
v_min_u32 v190, s99, v190
v_and_b32 v176, 7, v255
s_and_b32 s99, s45, 1
s_and_b32 s98, s44, 1
v_bfe_u32 v177, v255, 4, 1
s_lshl_b32 s99, s99, 6
s_lshl_b32 s98, s98, 7
v_lshrrev_b32 v178, 3, v255
s_add_u32 s99, s99, s98
s_lshr_b32 s98, s44, 1
s_lshl_b32 s98, s98, 2
v_xor_b32 v176, s98, v176
v_xor_b32 v176, v176, v177
v_mul_u32_u24 v178, 3584, v178
v_mov_b32 v179, v176
v_add_u32 v178, s99, v178
v_lshlrev_b32 v179, 4, v179
s_lshl_b32 s48, s44, 12
v_add_u32 v179, v179, v178
v_add_u32 v209, 0, v179
v_xor_b32 v179, 2, v176
v_lshlrev_b32 v179, 4, v179
v_add_u32 v179, v179, v178
v_add_u32 v210, 27648, v179
v_mov_b32 v179, v176
v_lshlrev_b32 v179, 4, v179
v_add_u32 v179, v179, v178
v_add_u32 v211, 55296, v179
v_xor_b32 v179, 2, v176
v_lshlrev_b32 v179, 4, v179
v_add_u32 v179, v179, v178
v_add_u32 v212, 82944, v179
s_add_u32 m0, s48, 65536
s_mov_b32 s70, 114688
s_and_b32 s99, s44, 1
v_lshrrev_b32 v191, 2, v255
v_and_b32 v189, 3, v255
v_mul_u32_u24 v191, 3584, v191
v_lshlrev_b32 v189, 7, v189
v_add_u32 v191, v191, v189
v_mov_b32 v202, 0x7ffffff0
v_cmp_gt_u32 vcc, 56, v255
s_mov_b32 s71, 229376
v_bfe_u32 v195, v255, 4, 1
s_lshr_b32 s100, s44, 1
s_lshl_b32 s47, s100, 12
s_and_b32 s100, s44, 1
s_waitcnt lgkmcnt(0)
s_mul_i32 s69, s46, 57344
s_add_u32 s8, s80, s69
s_addc_u32 s9, s81, 0
s_and_b32 s9, s9, 0xffff
s_mov_b32 s10, 57344
s_mov_b32 s11, 0x20000
buffer_load_dwordx4 v[112:115], v235, s[8:11], 0 offen offset:0
s_cmp_ge_u32 s44, 2
s_cselect_b32 s92, s94, s92
s_cselect_b32 s93, s95, s93
buffer_load_dwordx4 v[116:119], v235, s[8:11], s3 offen offset:0
s_getpc_b64 s[94:95]
L_pc:
buffer_load_dwordx4 v[120:123], v235, s[8:11], 0 offen offset:128
s_mul_i32 s69, s45, 448
s_add_u32 s28, s92, s69
s_addc_u32 s29, s93, 0
s_and_b32 s29, s29, 0xffff
s_sub_u32 s30, 1605632, s69
s_mov_b32 s31, 0x20000
buffer_load_dwordx4 v[124:127], v235, s[8:11], s3 offen offset:128
s_mov_b32 s36, s78
s_and_b32 s37, s79, 0xffff
s_mov_b32 s38, 29425664
s_mov_b32 s39, 0x20000
buffer_load_dwordx4 v[128:131], v235, s[8:11], 0 offen offset:256
s_lshl_b32 s100, s100, 11
buffer_load_dwordx4 v[132:135], v235, s[8:11], s3 offen offset:256
s_add_u32 s47, s47, s100
buffer_load_dwordx4 v[136:139], v235, s[8:11], 0 offen offset:384
v_bfe_u32 v181, v255, 1, 2
buffer_load_dwordx4 v[140:143], v235, s[8:11], s3 offen offset:384
v_and_b32 v182, 1, v255
buffer_load_dwordx4 v[144:147], v235, s[8:11], 0 offen offset:512
v_lshrrev_b32 v183, 3, v255
buffer_load_dwordx4 v[148:151], v235, s[8:11], s3 offen offset:512
v_lshrrev_b32 v4, 4, v255
buffer_load_dwordx4 v[152:155], v235, s[8:11], 0 offen offset:640
v_and_b32 v5, 15, v255
buffer_load_dwordx4 v[156:159], v235, s[8:11], s3 offen offset:640
v_lshrrev_b32 v184, 5, v255
buffer_load_dwordx4 v[160:163], v235, s[8:11], 0 offen offset:768
v_and_b32 v185, 31, v255
buffer_load_dwordx4 v[164:167], v235, s[8:11], s3 offen offset:768
s_lshl_b32 s69, s45, 10
s_lshl_b32 s3, s44, 8
s_add_u32 s69, s69, s3
s_add_u32 s20, s86, s69
s_addc_u32 s21, s87, 0
s_and_b32 s21, s21, 0xffff
s_sub_u32 s22, 3670016, s69
s_mov_b32 s23, 0x20000
s_mov_b64 exec, 15
global_load_dword v205, v190, s[94:95]
s_mov_b64 exec, -1
s_add_u32 s3, s45, 1
s_cmp_ge_u32 s3, 14
s_cselect_b32 s101, 14, 0
s_sub_u32 s3, s3, s101
s_cmp_ge_u32 s3, 7
s_cselect_b32 s101, 7, 0
s_sub_u32 s3, s3, s101
s_lshl_b32 s52, s3, 7
s_mul_i32 s101, s46, 7
s_add_u32 s101, s101, s3
s_lshl_b32 s101, s101, 3
s_add_u32 s101, s101, s45
s_lshl_b32 s59, s101, 14
s_add_u32 s3, s45, 2
s_cmp_ge_u32 s3, 14
s_cselect_b32 s101, 14, 0
s_sub_u32 s3, s3, s101
s_cmp_ge_u32 s3, 7
s_cselect_b32 s101, 7, 0
s_sub_u32 s3, s3, s101
s_lshl_b32 s53, s3, 7
s_mul_i32 s101, s46, 7
s_add_u32 s101, s101, s3
s_lshl_b32 s101, s101, 3
s_add_u32 s101, s101, s45
s_lshl_b32 s60, s101, 14
s_add_u32 s3, s45, 3
s_cmp_ge_u32 s3, 14
s_cselect_b32 s101, 14, 0
s_sub_u32 s3, s3, s101
s_cmp_ge_u32 s3, 7
s_cselect_b32 s101, 7, 0
s_sub_u32 s3, s3, s101
s_lshl_b32 s54, s3, 7
s_mul_i32 s101, s46, 7
s_add_u32 s101, s101, s3
s_lshl_b32 s101, s101, 3
s_add_u32 s101, s101, s45
s_lshl_b32 s61, s101, 14
s_add_u32 s3, s45, 4
s_cmp_ge_u32 s3, 14
s_cselect_b32 s101, 14, 0
s_sub_u32 s3, s3, s101
s_cmp_ge_u32 s3, 7
s_cselect_b32 s101, 7, 0
s_sub_u32 s3, s3, s101
s_lshl_b32 s55, s3, 7
s_mul_i32 s101, s46, 7
s_add_u32 s101, s101, s3
s_lshl_b32 s101, s101, 3
s_add_u32 s101, s101, s45
s_lshl_b32 s62, s101, 14
s_add_u32 s3, s45, 5
s_cmp_ge_u32 s3, 14
s_cselect_b32 s101, 14, 0
s_sub_u32 s3, s3, s101
s_cmp_ge_u32 s3, 7
s_cselect_b32 s101, 7, 0
s_sub_u32 s3, s3, s101
s_lshl_b32 s56, s3, 7
s_mul_i32 s101, s46, 7
s_add_u32 s101, s101, s3
s_lshl_b32 s101, s101, 3
s_add_u32 s101, s101, s45
s_lshl_b32 s63, s101, 14
s_add_u32 s3, s45, 6
s_cmp_ge_u32 s3, 14
s_cselect_b32 s101, 14, 0
s_sub_u32 s3, s3, s101
s_cmp_ge_u32 s3, 7
s_cselect_b32 s101, 7, 0
s_sub_u32 s3, s3, s101
s_lshl_b32 s57, s3, 7
s_mul_i32 s101, s46, 7
s_add_u32 s101, s101, s3
s_lshl_b32 s101, s101, 3
s_add_u32 s101, s101, s45
s_lshl_b32 s64, s101, 14
s_add_u32 s3, s45, 7
s_cmp_ge_u32 s3, 14
s_cselect_b32 s101, 14, 0
s_sub_u32 s3, s3, s101
s_cmp_ge_u32 s3, 7
s_cselect_b32 s101, 7, 0
s_sub_u32 s3, s3, s101
s_lshl_b32 s58, s3, 7
s_mul_i32 s101, s46, 7
s_add_u32 s101, s101, s3
s_lshl_b32 s101, s101, 3
s_add_u32 s101, s101, s45
s_lshl_b32 s65, s101, 14
s_lshl_b32 s69, s45, 20
s_add_u32 s69, s69, 786432
s_add_u32 s12, s82, s69
s_addc_u32 s13, s83, 0
s_and_b32 s13, s13, 0xffff
s_mov_b32 s14, 262144
s_mov_b32 s15, 0x20000
s_lshl_b32 s69, s45, 20
s_add_u32 s69, s69, 786432
s_add_u32 s16, s84, s69
s_addc_u32 s17, s85, 0
s_and_b32 s17, s17, 0xffff
s_mov_b32 s18, 262144
s_mov_b32 s19, 0x20000
v_min_u32 v194, 1, v255
v_lshlrev_b32 v194, 7, v194
v_lshrrev_b32 v192, 1, v255
v_and_b32 v189, 1, v255
v_lshlrev_b32 v192, 13, v192
v_lshlrev_b32 v189, 7, v189
v_add_u32 v192, v192, v189
v_lshlrev_b32 v193, 7, v255
s_mul_i32 s49, s44, 7168
s_mul_i32 s50, s44, 50176
s_mov_b32 s4, s76
s_and_b32 s5, s77, 0xffff
s_mov_b32 s6, 256
s_mov_b32 s7, 0x20000
s_mov_b32 s76, 802816
s_mov_b32 s77, 917504
s_mul_i32 s69, s45, 458752
s_add_u32 s24, s88, s69
s_addc_u32 s25, s89, 0
s_and_b32 s25, s25, 0xffff
s_mov_b32 s26, 458752
s_mov_b32 s27, 0x20000
s_mul_i32 s69, s45, 200704
s_add_u32 s32, s72, s69
s_addc_u32 s33, s73, 0
s_and_b32 s33, s33, 0xffff
s_mov_b32 s34, 200704
s_mov_b32 s35, 0x20000
s_and_b32 s69, s46, 15
s_lshl_b32 s98, s69, 1
s_add_u32 s98, s98, s99
s_mul_i32 s98, s98, 50176
v_add_u32 v191, s98, v191
v_cndmask_b32 v191, v202, v191, vcc
buffer_load_dword v205, v191, s[28:31], 0 offen
s_mov_b32 s72, 344064
s_mov_b32 s73, 458752
s_and_b32 s69, s46, 15
s_mul_i32 s98, s69, 229376
s_and_b32 s69, s46, 15
v_add_u32 v192, s98, v192
v_cmp_gt_u32 vcc, 56, v255
s_mul_i32 s51, s44, 28672
v_lshrrev_b32 v187, 2, v255
v_cndmask_b32 v192, v202, v192, vcc
v_cmp_gt_u32 vcc, 32, v255
v_and_b32 v6, 3, v255
v_lshlrev_b32 v251, 4, v255
v_and_b32 v177, 1, v4
v_lshrrev_b32 v7, 2, v5
v_lshlrev_b32 v8, 3, v4
v_bfe_u32 v188, v5, 3, 1
v_lshlrev_b32 v177, 1, v177
v_add_u32 v8, v8, v7
v_or_b32 v188, v188, v177
v_and_b32 v176, 1, v6
v_lshlrev_b32 v176, 3, v176
v_lshlrev_b32 v177, 7, v8
v_xor_b32 v190, s44, v188
v_lshrrev_b32 v188, 3, v255
v_lshlrev_b32 v188, 7, v188
v_add_u32 v176, v176, v177
v_lshlrev_b32 v177, 4, v190
v_and_b32 v190, 7, v255
v_lshlrev_b32 v190, 2, v190
v_add_u32 v190, v190, v188
v_lshrrev_b32 v189, 1, v6
v_add_u32 v176, v176, v177
v_xor_b32 v177, 0, v189
v_lshlrev_b32 v177, 6, v177
v_add_u32 v178, v176, v177
v_lshlrev_b32 v179, 13, v189
v_add_u32 v179, v179, v178
v_add_u32 v204, 65536, v179
v_add_u32 v207, 131072, v179
v_lshlrev_b32 v179, 12, v189
v_xor_b32 v177, 1, v189
v_add_u32 v196, v179, v178
v_lshlrev_b32 v177, 6, v177
v_add_u32 v178, v176, v177
v_lshlrev_b32 v179, 13, v189
v_add_u32 v179, v179, v178
v_and_b32 v177, 1, v4
v_add_u32 v206, 65536, v179
v_add_u32 v208, 131072, v179
v_lshlrev_b32 v177, 1, v177
v_lshlrev_b32 v179, 12, v189
v_xor_b32 v177, s44, v177
v_add_u32 v197, v179, v178
v_xor_b32 v177, v177, v189
v_lshlrev_b32 v177, 4, v177
v_lshlrev_b32 v178, 6, v8
v_add_u32 v177, v177, v178
v_lshlrev_b32 v178, 11, v189
v_mov_b32 v189, 0
v_add_u32 v177, v177, v178
v_and_b32 v178, 1, v6
v_lshlrev_b32 v178, 3, v178
v_add_u32 v177, v177, v178
v_and_b32 v178, 7, v187
v_lshlrev_b32 v176, 1, v4
v_add_u32 v198, 8192, v177
v_xor_b32 v176, v176, v5
v_lshlrev_b32 v176, 4, v176
v_lshlrev_b32 v177, 8, v4
v_add_u32 v200, v176, v177
v_lshlrev_b32 v176, 1, v4
v_or_b32 v176, 1, v176
v_xor_b32 v176, v176, v5
v_lshlrev_b32 v176, 4, v176
v_lshlrev_b32 v177, 8, v4
v_add_u32 v201, v176, v177
v_and_b32 v177, 1, v4
v_bfe_u32 v180, v5, 3, 1
v_lshlrev_b32 v177, 1, v177
v_or_b32 v180, v180, v177
v_lshlrev_b32 v176, 7, v8
v_lshlrev_b32 v177, 3, v6
v_add_u32 v176, v176, v177
s_add_u32 s98, s48, 98304
v_xor_b32 v177, 0, v180
v_add_u32 v176, s98, v176
v_lshlrev_b32 v177, 5, v177
v_add_u32 v213, v176, v177
v_xor_b32 v177, 1, v180
v_lshlrev_b32 v177, 5, v177
v_add_u32 v214, v176, v177
v_xor_b32 v177, 2, v180
v_lshlrev_b32 v177, 5, v177
v_add_u32 v215, v176, v177
v_xor_b32 v177, 3, v180
v_and_b32 v180, 3, v255
v_lshlrev_b32 v177, 5, v177
v_add_u32 v216, v176, v177
v_bfe_u32 v176, v255, 4, 1
v_xor_b32 v176, v181, v176
v_lshlrev_b32 v176, 1, v176
v_or_b32 v176, v176, v182
v_lshlrev_b32 v176, 4, v176
v_lshlrev_b32 v177, 13, v183
v_add_u32 v176, v176, v177
v_lshlrev_b32 v177, 13, v183
v_add_u32 v217, 0, v176
v_bfe_u32 v176, v255, 4, 1
v_or_b32 v176, 2, v176
v_xor_b32 v176, v181, v176
v_lshlrev_b32 v176, 1, v176
v_or_b32 v176, v176, v182
v_lshlrev_b32 v176, 4, v176
v_add_u32 v176, v176, v177
v_lshlrev_b32 v177, 13, v183
v_add_u32 v218, 64512, v176
v_bfe_u32 v176, v255, 4, 1
v_xor_b32 v176, v181, v176
v_lshlrev_b32 v176, 1, v176
v_or_b32 v176, v176, v182
v_lshlrev_b32 v176, 4, v176
v_add_u32 v176, v176, v177
v_lshlrev_b32 v177, 13, v183
v_add_u32 v219, 129024, v176
v_bfe_u32 v176, v255, 4, 1
v_or_b32 v176, 2, v176
v_xor_b32 v176, v181, v176
v_lshlrev_b32 v176, 1, v176
v_or_b32 v176, v176, v182
v_lshlrev_b32 v176, 4, v176
v_add_u32 v176, v176, v177
v_add_u32 v220, 193536, v176
v_lshrrev_b32 v176, 5, v255
v_and_b32 v177, 1, v4
v_lshlrev_b32 v176, 10, v176
v_lshlrev_b32 v177, 8, v177
s_and_b32 s98, s44, 1
s_lshr_b32 s99, s44, 1
v_add_u32 v176, v176, v177
s_lshl_b32 s98, s98, 9
s_lshl_b32 s99, s99, 3
v_lshlrev_b32 v177, 4, v5
s_add_u32 s98, s98, s99
v_add_u32 v176, v176, v177
v_lshlrev_b32 v177, 4, v5
s_add_u32 s98, s98, 65536
v_add_u32 v176, s98, v176
s_and_b32 s99, s45, 1
s_lshl_b32 s98, s99, 12
v_add_u32 v221, s98, v176
v_lshrrev_b32 v176, 1, v4
v_lshlrev_b32 v176, 8, v176
v_add_u32 v176, v176, v177
v_and_b32 v177, 1, v4
v_lshlrev_b32 v177, 3, v177
v_add_u32 v176, v176, v177
s_lshl_b32 s98, s44, 14
v_add_u32 v222, s98, v176
s_lshr_b32 s98, s44, 1
s_and_b32 s99, s44, 1
s_lshl_b32 s98, s98, 15
s_lshl_b32 s99, s99, 11
s_add_u32 s98, s98, s99
v_add_u32 v254, s98, v251
s_lshl_b32 s98, s44, 3
v_add_u32 v176, s98, v184
v_add_u32 v177, 0, v176
v_and_b32 v177, 15, v177
v_xor_b32 v177, v185, v177
v_lshlrev_b32 v186, 9, v176
v_lshlrev_b32 v177, 4, v177
v_add_u32 v223, v186, v177
v_add_u32 v177, 0, v184
v_and_b32 v177, 7, v177
v_lshlrev_b32 v177, 1, v177
v_xor_b32 v177, v185, v177
v_lshlrev_b32 v177, 4, v177
v_add_u32 v227, v186, v177
v_add_u32 v177, 2, v176
v_and_b32 v177, 15, v177
v_xor_b32 v177, v185, v177
v_lshlrev_b32 v177, 4, v177
v_add_u32 v224, v186, v177
v_add_u32 v177, 2, v184
v_and_b32 v177, 7, v177
v_lshlrev_b32 v177, 1, v177
v_xor_b32 v177, v185, v177
v_lshlrev_b32 v177, 4, v177
v_add_u32 v228, v186, v177
v_add_u32 v177, 4, v176
v_and_b32 v177, 15, v177
v_xor_b32 v177, v185, v177
v_lshlrev_b32 v177, 4, v177
v_add_u32 v225, v186, v177
v_add_u32 v177, 4, v184
v_and_b32 v177, 7, v177
v_lshlrev_b32 v177, 1, v177
v_xor_b32 v177, v185, v177
v_lshlrev_b32 v177, 4, v177
v_add_u32 v229, v186, v177
v_add_u32 v177, 6, v176
v_and_b32 v177, 15, v177
v_xor_b32 v177, v185, v177
v_lshlrev_b32 v177, 4, v177
v_add_u32 v226, v186, v177
v_add_u32 v177, 6, v184
v_and_b32 v177, 7, v177
v_lshlrev_b32 v177, 1, v177
v_xor_b32 v177, v185, v177
v_lshlrev_b32 v177, 4, v177
v_add_u32 v230, v186, v177
s_lshl_b32 s98, s69, 2
s_lshl_b32 s66, s46, 11
s_lshl_b32 s3, s44, 5
s_add_u32 s66, s66, s3
s_add_u32 s66, s66, 29360128
s_lshl_b32 s3, s45, 8
s_add_u32 s69, s66, s3
s_lshl_b32 s3, s45, 2
s_add_u32 s66, s66, s3
s_add_u32 s98, s98, s44
s_mul_i32 s98, s98, 4096
v_add_u32 v193, s98, v193
v_cndmask_b32 v193, v202, v193, vcc
v_cmp_gt_u32 vcc, 25, v255
v_add_u32 v177, 0, v4
v_lshlrev_b32 v176, 9, v5
v_xor_b32 v177, v177, v5
v_add_u32 v176, 98304, v176
v_lshlrev_b32 v177, 4, v177
v_add_u32 v231, v176, v177
v_add_u32 v177, 4, v4
v_xor_b32 v177, v177, v5
v_lshlrev_b32 v177, 4, v177
v_add_u32 v232, v176, v177
v_add_u32 v177, 8, v4
v_xor_b32 v177, v177, v5
v_lshlrev_b32 v177, 4, v177
v_add_u32 v233, v176, v177
v_add_u32 v177, 12, v4
v_xor_b32 v177, v177, v5
v_lshlrev_b32 v177, 4, v177
v_add_u32 v234, v176, v177
v_lshlrev_b32 v176, 9, v187
v_lshlrev_b32 v177, 3, v6
v_add_u32 v176, v176, v177
v_xor_b32 v177, 0, v178
v_lshlrev_b32 v177, 5, v177
v_add_u32 v236, v176, v177
v_xor_b32 v177, 1, v178
v_lshlrev_b32 v177, 5, v177
v_add_u32 v237, v176, v177
v_xor_b32 v177, 2, v178
v_lshlrev_b32 v177, 5, v177
v_add_u32 v238, v176, v177
v_xor_b32 v177, 3, v178
v_lshlrev_b32 v177, 5, v177
v_add_u32 v239, v176, v177
v_xor_b32 v177, 4, v178
v_lshlrev_b32 v177, 5, v177
v_add_u32 v240, v176, v177
v_xor_b32 v177, 5, v178
v_lshlrev_b32 v177, 5, v177
v_add_u32 v241, v176, v177
v_xor_b32 v177, 6, v178
v_lshlrev_b32 v177, 5, v177
v_add_u32 v242, v176, v177
v_xor_b32 v177, 7, v178
v_lshlrev_b32 v177, 5, v177
v_add_u32 v243, v176, v177
v_bfe_u32 v176, v255, 4, 2
v_xor_b32 v176, v181, v176
v_lshlrev_b32 v176, 1, v176
v_or_b32 v176, v176, v182
v_lshlrev_b32 v176, 4, v176
v_mul_u32_u24 v177, 896, v183
v_add_u32 v176, v176, v177
v_add_u32 v244, 0, v176
v_add_u32 v245, 6144, v176
v_add_u32 v246, 12288, v176
v_add_u32 v247, 18432, v176
v_bfe_u32 v181, v255, 2, 1
v_lshlrev_b32 v182, 1, v180
v_or_b32 v182, v182, v181
v_lshlrev_b32 v180, 8, v180
v_lshlrev_b32 v181, 12, v181
v_add_u32 v180, v180, v181
v_lshrrev_b32 v181, 3, v255
v_xor_b32 v181, v181, v182
v_lshlrev_b32 v181, 4, v181
v_add_u32 v180, v180, v181
s_lshl_b32 s98, s44, 11
v_add_u32 v253, s98, v251
s_lshl_b32 s98, s44, 10
v_add_u32 v235, s98, v180
s_and_b32 s98, s44, 1
s_mul_i32 s98, s98, 57344
s_waitcnt vmcnt(10)
s_nop 0
buffer_load_dwordx4 v209, s[28:31], 0 offen offset:0 lds
s_waitcnt vmcnt(5)
s_nop 0
s_mov_b32 s100, 0x3f803f80
v_mov_b32 v168, 0
v_mov_b32 v169, 0
v_dot2c_f32_bf16 v168, s100, v112
v_dot2c_f32_bf16 v169, s100, v113
v_mov_b32 v170, 0
v_mov_b32 v171, 0
v_dot2c_f32_bf16 v168, s100, v114
v_dot2c_f32_bf16 v169, s100, v115
v_dot2c_f32_bf16 v170, v112, v112
v_dot2c_f32_bf16 v171, v113, v113
v_mov_b32 v172, 0
v_mov_b32 v173, 0
buffer_load_dwordx4 v210, s[28:31], 0 offen offset:1024 lds
v_dot2c_f32_bf16 v168, s100, v120
v_dot2c_f32_bf16 v169, s100, v121
v_dot2c_f32_bf16 v170, v114, v114
v_dot2c_f32_bf16 v171, v115, v115
v_dot2c_f32_bf16 v172, s100, v116
v_dot2c_f32_bf16 v173, s100, v117
v_dot2c_f32_bf16 v168, s100, v122
v_dot2c_f32_bf16 v169, s100, v123
v_mov_b32 v174, 0
v_mov_b32 v175, 0
v_dot2c_f32_bf16 v172, s100, v118
v_dot2c_f32_bf16 v173, s100, v119
v_dot2c_f32_bf16 v170, v120, v120
v_dot2c_f32_bf16 v171, v121, v121
v_dot2c_f32_bf16 v168, s100, v128
buffer_load_dwordx4 v211, s[28:31], 0 offen offset:2048 lds
v_dot2c_f32_bf16 v169, s100, v129
v_dot2c_f32_bf16 v174, v116, v116
v_dot2c_f32_bf16 v175, v117, v117
v_dot2c_f32_bf16 v170, v122, v122
v_dot2c_f32_bf16 v171, v123, v123
v_dot2c_f32_bf16 v172, s100, v124
v_dot2c_f32_bf16 v173, s100, v125
v_dot2c_f32_bf16 v168, s100, v130
v_dot2c_f32_bf16 v169, s100, v131
v_dot2c_f32_bf16 v174, v118, v118
v_dot2c_f32_bf16 v175, v119, v119
v_dot2c_f32_bf16 v172, s100, v126
v_dot2c_f32_bf16 v173, s100, v127
v_dot2c_f32_bf16 v170, v128, v128
v_dot2c_f32_bf16 v171, v129, v129
buffer_load_dwordx4 v212, s[28:31], 0 offen offset:3072 lds
s_add_u32 m0, s48, 81920
v_dot2c_f32_bf16 v168, s100, v136
v_dot2c_f32_bf16 v169, s100, v137
v_dot2c_f32_bf16 v174, v124, v124
v_dot2c_f32_bf16 v175, v125, v125
v_dot2c_f32_bf16 v170, v130, v130
v_dot2c_f32_bf16 v171, v131, v131
v_dot2c_f32_bf16 v172, s100, v132
v_dot2c_f32_bf16 v173, s100, v133
v_dot2c_f32_bf16 v168, s100, v138
v_dot2c_f32_bf16 v169, s100, v139
v_dot2c_f32_bf16 v174, v126, v126
v_dot2c_f32_bf16 v175, v127, v127
v_dot2c_f32_bf16 v172, s100, v134
v_dot2c_f32_bf16 v173, s100, v135
buffer_load_dwordx4 v209, s[28:31], s70 offen offset:0 lds
v_dot2c_f32_bf16 v170, v136, v136
v_dot2c_f32_bf16 v171, v137, v137
v_dot2c_f32_bf16 v168, s100, v144
v_dot2c_f32_bf16 v169, s100, v145
v_dot2c_f32_bf16 v174, v132, v132
v_dot2c_f32_bf16 v175, v133, v133
v_dot2c_f32_bf16 v170, v138, v138
v_dot2c_f32_bf16 v171, v139, v139
v_dot2c_f32_bf16 v172, s100, v140
v_dot2c_f32_bf16 v173, s100, v141
v_dot2c_f32_bf16 v168, s100, v146
v_dot2c_f32_bf16 v169, s100, v147
v_dot2c_f32_bf16 v174, v134, v134
v_dot2c_f32_bf16 v175, v135, v135
v_dot2c_f32_bf16 v172, s100, v142
buffer_load_dwordx4 v210, s[28:31], s70 offen offset:1024 lds
v_dot2c_f32_bf16 v173, s100, v143
v_dot2c_f32_bf16 v170, v144, v144
v_dot2c_f32_bf16 v171, v145, v145
v_dot2c_f32_bf16 v168, s100, v152
v_dot2c_f32_bf16 v169, s100, v153
v_dot2c_f32_bf16 v174, v140, v140
v_dot2c_f32_bf16 v175, v141, v141
v_dot2c_f32_bf16 v170, v146, v146
v_dot2c_f32_bf16 v171, v147, v147
v_dot2c_f32_bf16 v172, s100, v148
v_dot2c_f32_bf16 v173, s100, v149
v_dot2c_f32_bf16 v168, s100, v154
v_dot2c_f32_bf16 v169, s100, v155
v_dot2c_f32_bf16 v174, v142, v142
v_dot2c_f32_bf16 v175, v143, v143
buffer_load_dwordx4 v211, s[28:31], s70 offen offset:2048 lds
v_dot2c_f32_bf16 v172, s100, v150
v_dot2c_f32_bf16 v173, s100, v151
v_dot2c_f32_bf16 v170, v152, v152
v_dot2c_f32_bf16 v171, v153, v153
s_waitcnt vmcnt(10)
v_dot2c_f32_bf16 v168, s100, v160
v_dot2c_f32_bf16 v169, s100, v161
v_dot2c_f32_bf16 v174, v148, v148
v_dot2c_f32_bf16 v175, v149, v149
v_dot2c_f32_bf16 v170, v154, v154
v_dot2c_f32_bf16 v171, v155, v155
v_dot2c_f32_bf16 v172, s100, v156
v_dot2c_f32_bf16 v173, s100, v157
v_dot2c_f32_bf16 v168, s100, v162
v_dot2c_f32_bf16 v169, s100, v163
buffer_load_dwordx4 v212, s[28:31], s70 offen offset:3072 lds
s_add_u32 m0, s48, 98304
s_mov_b32 s70, 1032192
v_dot2c_f32_bf16 v174, v150, v150
v_dot2c_f32_bf16 v175, v151, v151
v_dot2c_f32_bf16 v172, s100, v158
v_dot2c_f32_bf16 v173, s100, v159
v_dot2c_f32_bf16 v170, v160, v160
v_dot2c_f32_bf16 v171, v161, v161
v_dot2c_f32_bf16 v174, v156, v156
v_dot2c_f32_bf16 v175, v157, v157
v_dot2c_f32_bf16 v170, v162, v162
v_dot2c_f32_bf16 v171, v163, v163
s_waitcnt vmcnt(10)
v_dot2c_f32_bf16 v172, s100, v164
v_dot2c_f32_bf16 v173, s100, v165
buffer_load_dwordx4 v209, s[28:31], s71 offen offset:0 lds
v_dot2c_f32_bf16 v174, v158, v158
v_dot2c_f32_bf16 v175, v159, v159
v_dot2c_f32_bf16 v172, s100, v166
v_dot2c_f32_bf16 v173, s100, v167
v_dot2c_f32_bf16 v174, v164, v164
v_dot2c_f32_bf16 v175, v165, v165
v_add_f32 v168, v168, v169
v_dot2c_f32_bf16 v174, v166, v166
v_dot2c_f32_bf16 v175, v167, v167
v_add_f32 v170, v170, v171
v_add_f32 v172, v172, v173
v_add_f32_dpp v168, v168, v168 quad_perm:[1,0,3,2] row_mask:0xf bank_mask:0xf
v_add_f32 v174, v174, v175
v_add_f32_dpp v170, v170, v170 quad_perm:[1,0,3,2] row_mask:0xf bank_mask:0xf
v_add_f32_dpp v172, v172, v172 quad_perm:[1,0,3,2] row_mask:0xf bank_mask:0xf
buffer_load_dwordx4 v210, s[28:31], s71 offen offset:1024 lds
v_add_f32_dpp v168, v168, v168 quad_perm:[2,3,0,1] row_mask:0xf bank_mask:0xf
v_add_f32_dpp v174, v174, v174 quad_perm:[1,0,3,2] row_mask:0xf bank_mask:0xf
v_add_f32_dpp v170, v170, v170 quad_perm:[2,3,0,1] row_mask:0xf bank_mask:0xf
v_lshlrev_b32 v176, 7, v187
v_lshlrev_b32 v177, 3, v6
v_add_f32_dpp v172, v172, v172 quad_perm:[2,3,0,1] row_mask:0xf bank_mask:0xf
v_add_f32_dpp v168, v168, v168 row_half_mirror row_mask:0xf bank_mask:0xf
v_add_u32 v176, v176, v177
v_mul_f32 v168, 0x3b124925, v168
v_bfe_u32 v177, v255, 3, 2
v_mov_b32 v183, 0x3b124925
v_add_f32_dpp v174, v174, v174 quad_perm:[2,3,0,1] row_mask:0xf bank_mask:0xf
v_add_f32_dpp v170, v170, v170 row_half_mirror row_mask:0xf bank_mask:0xf
v_mul_f32 v169, v168, v168
v_xor_b32 v177, s44, v177
buffer_load_dwordx4 v211, s[28:31], s71 offen offset:2048 lds
v_add_f32_dpp v172, v172, v172 row_half_mirror row_mask:0xf bank_mask:0xf
v_fma_f32 v170, v170, v183, -v169
v_lshlrev_b32 v177, 5, v177
v_max_f32 v170, 0, v170
v_mul_f32 v172, 0x3b124925, v172
v_add_u32 v248, v176, v177
v_add_f32_dpp v174, v174, v174 row_half_mirror row_mask:0xf bank_mask:0xf
v_add_f32 v170, 0x3727c5ac, v170
v_mul_f32 v173, v172, v172
v_rsq_f32 v176, v170
v_fma_f32 v174, v174, v183, -v173
v_max_f32 v174, 0, v174
v_add_f32 v174, 0x3727c5ac, v174
v_mul_f32 v177, v168, v176
buffer_load_dwordx4 v212, s[28:31], s71 offen offset:3072 lds
s_add_u32 m0, s48, 114688
s_mov_b32 s71, 1146880
v_rsq_f32 v178, v174
v_lshlrev_b32 v184, 16, v112
v_and_b32 v185, 0xffff0000, v112
v_lshlrev_b32 v186, 16, v113
v_and_b32 v187, 0xffff0000, v113
v_lshlrev_b32 v188, 16, v114
v_and_b32 v191, 0xffff0000, v115
v_fma_f32 v184, v184, v176, -v177
v_fma_f32 v185, v185, v176, -v177
v_fma_f32 v186, v186, v176, -v177
v_fma_f32 v187, v187, v176, -v177
v_fma_f32 v188, v188, v176, -v177
buffer_load_dwordx4 v209, s[28:31], s72 offen offset:0 lds
v_fma_f32 v191, v191, v176, -v177
v_cvt_pk_bf16_f32 v112, v184, v185
v_cvt_pk_bf16_f32 v113, v186, v187
v_mul_f32 v179, v172, v178
v_lshlrev_b32 v184, 16, v116
v_and_b32 v185, 0xffff0000, v116
v_lshlrev_b32 v186, 16, v117
v_and_b32 v187, 0xffff0000, v117
v_fma_f32 v184, v184, v178, -v179
v_fma_f32 v185, v185, v178, -v179
v_fma_f32 v186, v186, v178, -v179
v_fma_f32 v187, v187, v178, -v179
v_cvt_pk_bf16_f32 v116, v184, v185
v_cvt_pk_bf16_f32 v117, v186, v187
v_lshlrev_b32 v184, 16, v120
buffer_load_dwordx4 v210, s[28:31], s72 offen offset:1024 lds
v_and_b32 v185, 0xffff0000, v120
v_lshlrev_b32 v186, 16, v121
v_and_b32 v187, 0xffff0000, v121
v_fma_f32 v184, v184, v176, -v177
v_fma_f32 v185, v185, v176, -v177
v_fma_f32 v186, v186, v176, -v177
v_fma_f32 v187, v187, v176, -v177
v_cvt_pk_bf16_f32 v120, v184, v185
v_cvt_pk_bf16_f32 v121, v186, v187
v_lshlrev_b32 v184, 16, v124
v_and_b32 v185, 0xffff0000, v124
v_lshlrev_b32 v186, 16, v125
v_and_b32 v187, 0xffff0000, v125
v_fma_f32 v184, v184, v178, -v179
v_fma_f32 v185, v185, v178, -v179
buffer_load_dwordx4 v211, s[28:31], s72 offen offset:2048 lds
v_fma_f32 v186, v186, v178, -v179
v_fma_f32 v187, v187, v178, -v179
v_cvt_pk_bf16_f32 v124, v184, v185
v_cvt_pk_bf16_f32 v125, v186, v187
v_lshlrev_b32 v184, 16, v128
v_and_b32 v185, 0xffff0000, v128
v_lshlrev_b32 v186, 16, v129
v_and_b32 v187, 0xffff0000, v129
v_fma_f32 v184, v184, v176, -v177
v_fma_f32 v185, v185, v176, -v177
v_fma_f32 v186, v186, v176, -v177
v_fma_f32 v187, v187, v176, -v177
v_cvt_pk_bf16_f32 v128, v184, v185
v_cvt_pk_bf16_f32 v129, v186, v187
v_lshlrev_b32 v184, 16, v132
buffer_load_dwordx4 v212, s[28:31], s72 offen offset:3072 lds
s_add_u32 m0, s48, 131072
s_mov_b32 s72, 1261568
v_and_b32 v185, 0xffff0000, v132
v_lshlrev_b32 v186, 16, v133
v_and_b32 v187, 0xffff0000, v133
v_fma_f32 v184, v184, v178, -v179
v_fma_f32 v185, v185, v178, -v179
v_fma_f32 v186, v186, v178, -v179
v_fma_f32 v187, v187, v178, -v179
v_cvt_pk_bf16_f32 v132, v184, v185
v_cvt_pk_bf16_f32 v133, v186, v187
v_lshlrev_b32 v184, 16, v136
v_and_b32 v185, 0xffff0000, v136
v_lshlrev_b32 v186, 16, v137
v_and_b32 v187, 0xffff0000, v137
buffer_load_dwordx4 v209, s[28:31], s73 offen offset:0 lds
v_fma_f32 v184, v184, v176, -v177
v_fma_f32 v185, v185, v176, -v177
v_fma_f32 v186, v186, v176, -v177
v_fma_f32 v187, v187, v176, -v177
v_cvt_pk_bf16_f32 v136, v184, v185
v_cvt_pk_bf16_f32 v137, v186, v187
v_lshlrev_b32 v184, 16, v140
v_and_b32 v185, 0xffff0000, v140
v_lshlrev_b32 v186, 16, v141
v_and_b32 v187, 0xffff0000, v141
v_fma_f32 v184, v184, v178, -v179
v_fma_f32 v185, v185, v178, -v179
v_fma_f32 v186, v186, v178, -v179
v_fma_f32 v187, v187, v178, -v179
v_cvt_pk_bf16_f32 v140, v184, v185
buffer_load_dwordx4 v210, s[28:31], s73 offen offset:1024 lds
v_cvt_pk_bf16_f32 v141, v186, v187
v_lshlrev_b32 v184, 16, v144
v_and_b32 v185, 0xffff0000, v144
v_lshlrev_b32 v186, 16, v145
v_and_b32 v187, 0xffff0000, v145
v_fma_f32 v184, v184, v176, -v177
v_fma_f32 v185, v185, v176, -v177
v_fma_f32 v186, v186, v176, -v177
v_fma_f32 v187, v187, v176, -v177
v_cvt_pk_bf16_f32 v144, v184, v185
v_cvt_pk_bf16_f32 v145, v186, v187
v_lshlrev_b32 v184, 16, v148
v_and_b32 v185, 0xffff0000, v148
v_lshlrev_b32 v186, 16, v149
v_and_b32 v187, 0xffff0000, v149
buffer_load_dwordx4 v211, s[28:31], s73 offen offset:2048 lds
v_fma_f32 v184, v184, v178, -v179
v_fma_f32 v185, v185, v178, -v179
v_fma_f32 v186, v186, v178, -v179
v_fma_f32 v187, v187, v178, -v179
v_cvt_pk_bf16_f32 v148, v184, v185
v_cvt_pk_bf16_f32 v149, v186, v187
s_mov_b32 s40, s74
s_and_b32 s41, s75, 0xffff
s_mov_b32 s42, 1835008
s_mov_b32 s43, 0x20000
s_mov_b32 s74, 573440
s_mov_b32 s75, 688128
v_lshlrev_b32 v184, 16, v152
v_and_b32 v185, 0xffff0000, v152
v_lshlrev_b32 v186, 16, v153
buffer_load_dwordx4 v212, s[28:31], s73 offen offset:3072 lds
s_add_u32 m0, s48, 147456
s_mov_b32 s73, 114688
v_and_b32 v187, 0xffff0000, v153
v_fma_f32 v184, v184, v176, -v177
v_fma_f32 v185, v185, v176, -v177
v_fma_f32 v186, v186, v176, -v177
v_fma_f32 v187, v187, v176, -v177
v_cvt_pk_bf16_f32 v152, v184, v185
v_cvt_pk_bf16_f32 v153, v186, v187
v_lshlrev_b32 v184, 16, v156
v_and_b32 v185, 0xffff0000, v156
v_lshlrev_b32 v186, 16, v157
v_and_b32 v187, 0xffff0000, v157
v_fma_f32 v184, v184, v178, -v179
v_fma_f32 v185, v185, v178, -v179
buffer_load_dwordx4 v209, s[28:31], s74 offen offset:0 lds
v_fma_f32 v186, v186, v178, -v179
v_fma_f32 v187, v187, v178, -v179
v_cvt_pk_bf16_f32 v156, v184, v185
v_cvt_pk_bf16_f32 v157, v186, v187
v_lshlrev_b32 v184, 16, v160
v_and_b32 v185, 0xffff0000, v160
v_lshlrev_b32 v186, 16, v161
v_and_b32 v187, 0xffff0000, v161
v_fma_f32 v184, v184, v176, -v177
v_fma_f32 v185, v185, v176, -v177
v_fma_f32 v186, v186, v176, -v177
v_fma_f32 v187, v187, v176, -v177
v_cvt_pk_bf16_f32 v160, v184, v185
v_cvt_pk_bf16_f32 v161, v186, v187
v_lshlrev_b32 v184, 16, v164
buffer_load_dwordx4 v210, s[28:31], s74 offen offset:1024 lds
v_and_b32 v185, 0xffff0000, v164
v_lshlrev_b32 v186, 16, v165
v_and_b32 v187, 0xffff0000, v165
v_fma_f32 v184, v184, v178, -v179
v_fma_f32 v185, v185, v178, -v179
v_fma_f32 v186, v186, v178, -v179
v_fma_f32 v187, v187, v178, -v179
v_cvt_pk_bf16_f32 v164, v184, v185
v_cvt_pk_bf16_f32 v165, v186, v187
s_and_b32 s99, s45, 1
s_mul_i32 s99, s99, 28672
s_mov_b32 s67, 0xbdd2d3e8
v_mov_b32 v203, 0xc0135761
s_mov_b32 s68, 0x3db8aa3b
v_add_u32 v252, 65536, v251
buffer_load_dwordx4 v211, s[28:31], s74 offen offset:2048 lds
s_cmp_eq_u32 s44, 0
s_cselect_b32 s79, s45, 99
v_add_u32 v249, 65536, v248
s_add_u32 s100, s59, 8192
v_add_u32 v250, 131072, v248
s_mov_b32 s92, 0x00003f80
s_mov_b32 s93, 0x3f800000
buffer_load_dwordx4 v212, s[28:31], s74 offen offset:3072 lds
s_add_u32 m0, s48, 65536
s_mov_b32 s74, 1376256
buffer_load_dword v205, v192, s[20:23], 0 offen
v_mov_b32 v192, 0
s_mov_b64 exec, 0xffff
buffer_store_dword v189, v190, s[36:39], s69 offen sc1
s_mov_b64 exec, -1
s_nop 1
s_lshl_b32 s69, s44, 14
s_add_u32 s69, s69, 8192
v_and_b32 v189, 0xffff0000, v114
v_lshlrev_b32 v190, 16, v115
v_fma_f32 v189, v189, v176, -v177
v_fma_f32 v190, v190, v176, -v177
v_cvt_pk_bf16_f32 v114, v188, v189
v_cvt_pk_bf16_f32 v115, v190, v191
v_lshlrev_b32 v188, 16, v118
v_and_b32 v189, 0xffff0000, v118
v_lshlrev_b32 v190, 16, v119
v_and_b32 v191, 0xffff0000, v119
v_fma_f32 v188, v188, v178, -v179
v_fma_f32 v189, v189, v178, -v179
v_fma_f32 v190, v190, v178, -v179
v_fma_f32 v191, v191, v178, -v179
v_cvt_pk_bf16_f32 v118, v188, v189
v_cvt_pk_bf16_f32 v119, v190, v191
v_lshlrev_b32 v188, 16, v122
v_and_b32 v189, 0xffff0000, v122
v_lshlrev_b32 v190, 16, v123
v_and_b32 v191, 0xffff0000, v123
v_fma_f32 v188, v188, v176, -v177
v_fma_f32 v189, v189, v176, -v177
v_fma_f32 v190, v190, v176, -v177
v_fma_f32 v191, v191, v176, -v177
v_cvt_pk_bf16_f32 v122, v188, v189
v_cvt_pk_bf16_f32 v123, v190, v191
v_lshlrev_b32 v188, 16, v126
v_and_b32 v189, 0xffff0000, v126
v_lshlrev_b32 v190, 16, v127
v_and_b32 v191, 0xffff0000, v127
v_fma_f32 v188, v188, v178, -v179
v_fma_f32 v189, v189, v178, -v179
v_fma_f32 v190, v190, v178, -v179
v_fma_f32 v191, v191, v178, -v179
v_cvt_pk_bf16_f32 v126, v188, v189
v_cvt_pk_bf16_f32 v127, v190, v191
v_lshlrev_b32 v188, 16, v130
v_and_b32 v189, 0xffff0000, v130
v_lshlrev_b32 v190, 16, v131
v_and_b32 v191, 0xffff0000, v131
v_fma_f32 v188, v188, v176, -v177
v_fma_f32 v189, v189, v176, -v177
v_fma_f32 v190, v190, v176, -v177
v_fma_f32 v191, v191, v176, -v177
v_cvt_pk_bf16_f32 v130, v188, v189
v_cvt_pk_bf16_f32 v131, v190, v191
v_lshlrev_b32 v188, 16, v134
v_and_b32 v189, 0xffff0000, v134
v_lshlrev_b32 v190, 16, v135
v_and_b32 v191, 0xffff0000, v135
v_fma_f32 v188, v188, v178, -v179
v_fma_f32 v189, v189, v178, -v179
v_fma_f32 v190, v190, v178, -v179
v_fma_f32 v191, v191, v178, -v179
v_cvt_pk_bf16_f32 v134, v188, v189
v_cvt_pk_bf16_f32 v135, v190, v191
v_lshlrev_b32 v188, 16, v138
v_and_b32 v189, 0xffff0000, v138
v_lshlrev_b32 v190, 16, v139
v_and_b32 v191, 0xffff0000, v139
v_fma_f32 v188, v188, v176, -v177
v_fma_f32 v189, v189, v176, -v177
v_fma_f32 v190, v190, v176, -v177
v_fma_f32 v191, v191, v176, -v177
v_cvt_pk_bf16_f32 v138, v188, v189
v_cvt_pk_bf16_f32 v139, v190, v191
v_lshlrev_b32 v188, 16, v142
v_and_b32 v189, 0xffff0000, v142
v_lshlrev_b32 v190, 16, v143
v_and_b32 v191, 0xffff0000, v143
v_fma_f32 v188, v188, v178, -v179
v_fma_f32 v189, v189, v178, -v179
v_fma_f32 v190, v190, v178, -v179
v_fma_f32 v191, v191, v178, -v179
v_cvt_pk_bf16_f32 v142, v188, v189
v_cvt_pk_bf16_f32 v143, v190, v191
ds_write_b128 v235, v[112:115] offset:0
ds_write_b128 v235, v[116:119] offset:128
ds_write_b128 v235, v[120:123] offset:8192
ds_write_b128 v235, v[124:127] offset:8320
ds_write_b128 v235, v[128:131] offset:16384
ds_write_b128 v235, v[132:135] offset:16512
ds_write_b128 v235, v[136:139] offset:24576
ds_write_b128 v235, v[140:143] offset:24704
v_lshlrev_b32 v188, 16, v146
v_and_b32 v189, 0xffff0000, v146
v_lshlrev_b32 v190, 16, v147
v_and_b32 v191, 0xffff0000, v147
v_fma_f32 v188, v188, v176, -v177
v_fma_f32 v189, v189, v176, -v177
v_fma_f32 v190, v190, v176, -v177
v_fma_f32 v191, v191, v176, -v177
v_cvt_pk_bf16_f32 v146, v188, v189
v_cvt_pk_bf16_f32 v147, v190, v191
v_lshlrev_b32 v188, 16, v150
v_and_b32 v189, 0xffff0000, v150
v_lshlrev_b32 v190, 16, v151
s_waitcnt lgkmcnt(0) vmcnt(18)
s_barrier
ds_read_b128 a[0:3], v200 offset:0
ds_read_b64_tr_b16 a[224:225], v204 offset:0
ds_read_b64_tr_b16 a[226:227], v204 offset:512
ds_read_b128 a[4:7], v200 offset:1024
ds_read_b128 a[8:11], v200 offset:2048
ds_read_b128 a[12:15], v200 offset:3072
ds_read_b64_tr_b16 a[228:229], v206 offset:0
ds_read_b64_tr_b16 a[230:231], v206 offset:512
ds_read_b64_tr_b16 a[232:233], v204 offset:4096
ds_read_b64_tr_b16 a[234:235], v204 offset:4608
ds_read_b64_tr_b16 a[236:237], v206 offset:4096
ds_read_b64_tr_b16 a[238:239], v206 offset:4608
ds_read_b128 a[16:19], v201 offset:4096
ds_read_b64_tr_b16 a[240:241], v204 offset:16384
ds_read_b64_tr_b16 a[242:243], v204 offset:16896
ds_read_b128 a[20:23], v201 offset:5120
s_waitcnt lgkmcnt(13)
v_mfma_f32_16x16x32_bf16 v[0:3], a[224:227], a[0:3], 0
ds_read_b128 a[24:27], v201 offset:6144
s_waitcnt lgkmcnt(13)
v_mfma_f32_16x16x32_bf16 v[4:7], a[224:227], a[4:7], 0
ds_read_b128 a[28:31], v201 offset:7168
s_waitcnt lgkmcnt(13)
v_mfma_f32_16x16x32_bf16 v[8:11], a[224:227], a[8:11], 0
ds_read_b64_tr_b16 a[244:245], v206 offset:16384
s_waitcnt lgkmcnt(12)
v_mfma_f32_16x16x32_bf16 v[12:15], a[224:227], a[12:15], 0
ds_read_b64_tr_b16 a[246:247], v206 offset:16896
s_waitcnt lgkmcnt(11)
v_mfma_f32_16x16x32_bf16 v[16:19], a[228:231], a[0:3], 0
ds_read_b64_tr_b16 a[248:249], v204 offset:20480
v_and_b32 v191, 0xffff0000, v151
v_mfma_f32_16x16x32_bf16 v[20:23], a[228:231], a[4:7], 0
ds_read_b64_tr_b16 a[250:251], v204 offset:20992
v_fma_f32 v188, v188, v178, -v179
v_mfma_f32_16x16x32_bf16 v[24:27], a[228:231], a[8:11], 0
ds_read_b128 a[32:35], v200 offset:8192
v_fma_f32 v189, v189, v178, -v179
v_mfma_f32_16x16x32_bf16 v[28:31], a[228:231], a[12:15], 0
ds_read_b128 a[36:39], v200 offset:9216
s_waitcnt lgkmcnt(8)
v_mfma_f32_16x16x32_bf16 v[32:35], a[232:235], a[0:3], 0
ds_read_b128 a[40:43], v200 offset:10240
v_fma_f32 v190, v190, v178, -v179
v_mfma_f32_16x16x32_bf16 v[36:39], a[232:235], a[4:7], 0
ds_read_b128 a[44:47], v200 offset:11264
v_fma_f32 v191, v191, v178, -v179
v_mfma_f32_16x16x32_bf16 v[40:43], a[232:235], a[8:11], 0
ds_read_b128 a[48:51], v201 offset:12288
v_cvt_pk_bf16_f32 v150, v188, v189
v_mfma_f32_16x16x32_bf16 v[44:47], a[232:235], a[12:15], 0
ds_read_b128 a[52:55], v201 offset:13312
v_cvt_pk_bf16_f32 v151, v190, v191
v_mfma_f32_16x16x32_bf16 v[48:51], a[236:239], a[0:3], 0
ds_read_b128 a[56:59], v201 offset:14336
v_lshlrev_b32 v188, 16, v154
v_mfma_f32_16x16x32_bf16 v[52:55], a[236:239], a[4:7], 0
ds_read_b128 a[60:63], v201 offset:15360
v_and_b32 v189, 0xffff0000, v154
v_mfma_f32_16x16x32_bf16 v[56:59], a[236:239], a[8:11], 0
ds_read_b128 a[64:67], v200 offset:16384
v_lshlrev_b32 v190, 16, v155
v_mfma_f32_16x16x32_bf16 v[60:63], a[236:239], a[12:15], 0
ds_read_b128 a[68:71], v200 offset:17408
v_and_b32 v191, 0xffff0000, v155
v_mfma_f32_16x16x32_bf16 v[0:3], a[240:243], a[16:19], v[0:3]
ds_read_b128 a[72:75], v200 offset:18432
v_fma_f32 v188, v188, v176, -v177
v_mfma_f32_16x16x32_bf16 v[4:7], a[240:243], a[20:23], v[4:7]
ds_read_b128 a[76:79], v200 offset:19456
s_waitcnt lgkmcnt(8)
v_mfma_f32_16x16x32_bf16 v[8:11], a[240:243], a[24:27], v[8:11]
ds_read_b128 a[80:83], v201 offset:20480
v_fma_f32 v189, v189, v176, -v177
ds_read_b128 a[84:87], v201 offset:21504
ds_read_b128 a[88:91], v201 offset:22528
ds_read_b128 a[92:95], v201 offset:23552
ds_read_b128 a[96:99], v200 offset:24576
ds_read_b128 a[100:103], v200 offset:25600
ds_read_b128 a[104:107], v200 offset:26624
ds_read_b128 a[108:111], v200 offset:27648
ds_read_b128 a[112:115], v201 offset:28672
ds_read_b128 a[116:119], v201 offset:29696
ds_read_b128 a[120:123], v201 offset:30720
ds_read_b128 a[124:127], v201 offset:31744
ds_read_b64_tr_b16 a[252:253], v206 offset:20480
ds_read_b64_tr_b16 a[254:255], v206 offset:20992
v_mfma_f32_16x16x32_bf16 v[12:15], a[240:243], a[28:31], v[12:15]
ds_write_b128 v235, v[144:147] offset:32768
v_mfma_f32_16x16x32_bf16 v[16:19], a[244:247], a[16:19], v[16:19]
ds_write_b128 v235, v[148:151] offset:32896
v_mfma_f32_16x16x32_bf16 v[20:23], a[244:247], a[20:23], v[20:23]
v_fma_f32 v190, v190, v176, -v177
v_fma_f32 v191, v191, v176, -v177
v_mfma_f32_16x16x32_bf16 v[24:27], a[244:247], a[24:27], v[24:27]
v_cvt_pk_bf16_f32 v154, v188, v189
v_mfma_f32_16x16x32_bf16 v[28:31], a[244:247], a[28:31], v[28:31]
v_cvt_pk_bf16_f32 v155, v190, v191
v_mfma_f32_16x16x32_bf16 v[32:35], a[248:251], a[16:19], v[32:35]
s_waitcnt lgkmcnt(0) vmcnt(10)
s_barrier
v_mfma_f32_16x16x32_bf16 v[36:39], a[248:251], a[20:23], v[36:39]
buffer_load_dwordx4 v209, s[28:31], s75 offen offset:0 lds
ds_read_b64_tr_b16 a[224:225], v204 offset:32768
ds_read_b64_tr_b16 a[226:227], v204 offset:33280
v_mfma_f32_16x16x32_bf16 v[40:43], a[248:251], a[24:27], v[40:43]
ds_read_b64_tr_b16 a[228:229], v206 offset:32768
v_lshlrev_b32 v188, 16, v158
v_mfma_f32_16x16x32_bf16 v[44:47], a[248:251], a[28:31], v[44:47]
ds_read_b64_tr_b16 a[230:231], v206 offset:33280
v_and_b32 v189, 0xffff0000, v158
v_mfma_f32_16x16x32_bf16 v[48:51], a[252:255], a[16:19], v[48:51]
buffer_load_dwordx4 v210, s[28:31], s75 offen offset:1024 lds
v_mfma_f32_16x16x32_bf16 v[52:55], a[252:255], a[20:23], v[52:55]
ds_read_b64_tr_b16 a[232:233], v204 offset:36864
v_lshlrev_b32 v190, 16, v159
v_mfma_f32_16x16x32_bf16 v[56:59], a[252:255], a[24:27], v[56:59]
ds_read_b64_tr_b16 a[234:235], v204 offset:37376
v_and_b32 v191, 0xffff0000, v159
v_mfma_f32_16x16x32_bf16 v[60:63], a[252:255], a[28:31], v[60:63]
ds_read_b64_tr_b16 a[236:237], v206 offset:36864
ds_read_b64_tr_b16 a[238:239], v206 offset:37376
s_waitcnt lgkmcnt(6)
v_mfma_f32_16x16x32_bf16 v[0:3], a[224:227], a[32:35], v[0:3]
buffer_load_dwordx4 v211, s[28:31], s75 offen offset:2048 lds
v_mfma_f32_16x16x32_bf16 v[4:7], a[224:227], a[36:39], v[4:7]
ds_read_b64_tr_b16 a[240:241], v204 offset:49152
v_fma_f32 v188, v188, v178, -v179
v_mfma_f32_16x16x32_bf16 v[8:11], a[224:227], a[40:43], v[8:11]
ds_read_b64_tr_b16 a[242:243], v204 offset:49664
v_fma_f32 v189, v189, v178, -v179
v_mfma_f32_16x16x32_bf16 v[12:15], a[224:227], a[44:47], v[12:15]
ds_read_b64_tr_b16 a[244:245], v206 offset:49152
s_waitcnt lgkmcnt(7)
v_mfma_f32_16x16x32_bf16 v[16:19], a[228:231], a[32:35], v[16:19]
buffer_load_dwordx4 v212, s[28:31], s75 offen offset:3072 lds
v_mfma_f32_16x16x32_bf16 v[20:23], a[228:231], a[36:39], v[20:23]
s_add_u32 m0, s48, 81920
s_mov_b32 s75, 1490944
v_mfma_f32_16x16x32_bf16 v[24:27], a[228:231], a[40:43], v[24:27]
ds_read_b64_tr_b16 a[246:247], v206 offset:49664
v_fma_f32 v190, v190, v178, -v179
v_mfma_f32_16x16x32_bf16 v[28:31], a[228:231], a[44:47], v[28:31]
ds_read_b64_tr_b16 a[248:249], v204 offset:53248
s_waitcnt lgkmcnt(5)
v_mfma_f32_16x16x32_bf16 v[32:35], a[232:235], a[32:35], v[32:35]
buffer_load_dwordx4 v209, s[28:31], s76 offen offset:0 lds
v_mfma_f32_16x16x32_bf16 v[36:39], a[232:235], a[36:39], v[36:39]
ds_read_b64_tr_b16 a[250:251], v204 offset:53760
v_fma_f32 v191, v191, v178, -v179
v_mfma_f32_16x16x32_bf16 v[40:43], a[232:235], a[40:43], v[40:43]
ds_read_b128 a[128:131], v200 offset:32768
v_cvt_pk_bf16_f32 v158, v188, v189
v_mfma_f32_16x16x32_bf16 v[44:47], a[232:235], a[44:47], v[44:47]
ds_read_b128 a[132:135], v200 offset:33792
v_cvt_pk_bf16_f32 v159, v190, v191
v_mfma_f32_16x16x32_bf16 v[48:51], a[236:239], a[32:35], v[48:51]
buffer_load_dwordx4 v210, s[28:31], s76 offen offset:1024 lds
v_mfma_f32_16x16x32_bf16 v[52:55], a[236:239], a[36:39], v[52:55]
ds_read_b128 a[136:139], v200 offset:34816
v_lshlrev_b32 v188, 16, v162
v_mfma_f32_16x16x32_bf16 v[56:59], a[236:239], a[40:43], v[56:59]
ds_read_b128 a[140:143], v200 offset:35840
v_and_b32 v189, 0xffff0000, v162
v_mfma_f32_16x16x32_bf16 v[60:63], a[236:239], a[44:47], v[60:63]
ds_read_b128 a[144:147], v201 offset:36864
s_waitcnt lgkmcnt(6)
v_mfma_f32_16x16x32_bf16 v[0:3], a[240:243], a[48:51], v[0:3]
buffer_load_dwordx4 v211, s[28:31], s76 offen offset:2048 lds
v_mfma_f32_16x16x32_bf16 v[4:7], a[240:243], a[52:55], v[4:7]
ds_read_b128 a[148:151], v201 offset:37888
v_lshlrev_b32 v190, 16, v163
v_mfma_f32_16x16x32_bf16 v[8:11], a[240:243], a[56:59], v[8:11]
ds_read_b128 a[152:155], v201 offset:38912
v_and_b32 v191, 0xffff0000, v163
ds_read_b128 a[156:159], v201 offset:39936
ds_read_b64_tr_b16 a[252:253], v206 offset:53248
ds_read_b64_tr_b16 a[254:255], v206 offset:53760
v_mfma_f32_16x16x32_bf16 v[12:15], a[240:243], a[60:63], v[12:15]
buffer_load_dwordx4 v212, s[28:31], s76 offen offset:3072 lds
v_mfma_f32_16x16x32_bf16 v[16:19], a[244:247], a[48:51], v[16:19]
s_add_u32 m0, s48, 98304
s_mov_b32 s76, 229376
v_mfma_f32_16x16x32_bf16 v[20:23], a[244:247], a[52:55], v[20:23]
ds_write_b128 v235, v[152:155] offset:40960
ds_write_b128 v235, v[156:159] offset:41088
v_mfma_f32_16x16x32_bf16 v[24:27], a[244:247], a[56:59], v[24:27]
v_fma_f32 v188, v188, v176, -v177
v_fma_f32 v189, v189, v176, -v177
v_mfma_f32_16x16x32_bf16 v[28:31], a[244:247], a[60:63], v[28:31]
v_fma_f32 v190, v190, v176, -v177
s_waitcnt lgkmcnt(5)
v_mfma_f32_16x16x32_bf16 v[32:35], a[248:251], a[48:51], v[32:35]
v_fma_f32 v191, v191, v176, -v177
v_mfma_f32_16x16x32_bf16 v[36:39], a[248:251], a[52:55], v[36:39]
s_waitcnt lgkmcnt(0) vmcnt(10)
s_barrier
ds_read_b64_tr_b16 a[224:225], v207 offset:0
ds_read_b64_tr_b16 a[226:227], v207 offset:512
v_mfma_f32_16x16x32_bf16 v[40:43], a[248:251], a[56:59], v[40:43]
buffer_load_dwordx4 v209, s[28:31], s77 offen offset:0 lds
v_mfma_f32_16x16x32_bf16 v[44:47], a[248:251], a[60:63], v[44:47]
ds_read_b64_tr_b16 a[228:229], v208 offset:0
v_cvt_pk_bf16_f32 v162, v188, v189
v_mfma_f32_16x16x32_bf16 v[48:51], a[252:255], a[48:51], v[48:51]
ds_read_b64_tr_b16 a[230:231], v208 offset:512
v_cvt_pk_bf16_f32 v163, v190, v191
v_mfma_f32_16x16x32_bf16 v[52:55], a[252:255], a[52:55], v[52:55]
ds_read_b64_tr_b16 a[232:233], v207 offset:4096
v_lshlrev_b32 v188, 16, v166
v_mfma_f32_16x16x32_bf16 v[56:59], a[252:255], a[56:59], v[56:59]
buffer_load_dwordx4 v210, s[28:31], s77 offen offset:1024 lds
v_mfma_f32_16x16x32_bf16 v[60:63], a[252:255], a[60:63], v[60:63]
ds_read_b64_tr_b16 a[234:235], v207 offset:4608
s_waitcnt lgkmcnt(4)
v_mfma_f32_16x16x32_bf16 v[0:3], a[224:227], a[64:67], v[0:3]
ds_read_b64_tr_b16 a[236:237], v208 offset:4096
v_and_b32 v189, 0xffff0000, v166
v_mfma_f32_16x16x32_bf16 v[4:7], a[224:227], a[68:71], v[4:7]
ds_read_b64_tr_b16 a[238:239], v208 offset:4608
v_lshlrev_b32 v190, 16, v167
v_mfma_f32_16x16x32_bf16 v[8:11], a[224:227], a[72:75], v[8:11]
buffer_load_dwordx4 v211, s[28:31], s77 offen offset:2048 lds
v_mfma_f32_16x16x32_bf16 v[12:15], a[224:227], a[76:79], v[12:15]
ds_read_b64_tr_b16 a[240:241], v207 offset:16384
s_waitcnt lgkmcnt(5)
v_mfma_f32_16x16x32_bf16 v[16:19], a[228:231], a[64:67], v[16:19]
ds_read_b64_tr_b16 a[242:243], v207 offset:16896
v_and_b32 v191, 0xffff0000, v167
v_mfma_f32_16x16x32_bf16 v[20:23], a[228:231], a[68:71], v[20:23]
ds_read_b64_tr_b16 a[244:245], v208 offset:16384
v_fma_f32 v188, v188, v178, -v179
v_mfma_f32_16x16x32_bf16 v[24:27], a[228:231], a[72:75], v[24:27]
buffer_load_dwordx4 v212, s[28:31], s77 offen offset:3072 lds
v_mfma_f32_16x16x32_bf16 v[28:31], a[228:231], a[76:79], v[28:31]
s_add_u32 m0, s48, 114688
s_waitcnt lgkmcnt(4)
v_mfma_f32_16x16x32_bf16 v[32:35], a[232:235], a[64:67], v[32:35]
s_mov_b32 s77, 344064
ds_read_b64_tr_b16 a[246:247], v208 offset:16896
v_mfma_f32_16x16x32_bf16 v[36:39], a[232:235], a[68:71], v[36:39]
ds_read_b64_tr_b16 a[248:249], v207 offset:20480
v_fma_f32 v189, v189, v178, -v179
v_mfma_f32_16x16x32_bf16 v[40:43], a[232:235], a[72:75], v[40:43]
buffer_load_dwordx4 v209, s[28:31], s70 offen offset:0 lds
v_mfma_f32_16x16x32_bf16 v[44:47], a[232:235], a[76:79], v[44:47]
ds_read_b64_tr_b16 a[250:251], v207 offset:20992
s_waitcnt lgkmcnt(4)
v_mfma_f32_16x16x32_bf16 v[48:51], a[236:239], a[64:67], v[48:51]
ds_read_b128 a[160:163], v200 offset:40960
v_fma_f32 v190, v190, v178, -v179
v_mfma_f32_16x16x32_bf16 v[52:55], a[236:239], a[68:71], v[52:55]
ds_read_b128 a[164:167], v200 offset:41984
v_fma_f32 v191, v191, v178, -v179
v_mfma_f32_16x16x32_bf16 v[56:59], a[236:239], a[72:75], v[56:59]
buffer_load_dwordx4 v210, s[28:31], s70 offen offset:1024 lds
v_mfma_f32_16x16x32_bf16 v[60:63], a[236:239], a[76:79], v[60:63]
ds_read_b128 a[168:171], v200 offset:43008
v_cvt_pk_bf16_f32 v166, v188, v189
v_mfma_f32_16x16x32_bf16 v[0:3], a[240:243], a[80:83], v[0:3]
ds_read_b128 a[172:175], v200 offset:44032
v_cvt_pk_bf16_f32 v167, v190, v191
v_mfma_f32_16x16x32_bf16 v[4:7], a[240:243], a[84:87], v[4:7]
v_and_b32 v190, 7, v255
ds_read_b128 a[176:179], v201 offset:45056
v_mfma_f32_16x16x32_bf16 v[8:11], a[240:243], a[88:91], v[8:11]
buffer_load_dwordx4 v211, s[28:31], s70 offen offset:2048 lds
ds_read_b128 a[180:183], v201 offset:46080
ds_read_b128 a[184:187], v201 offset:47104
ds_read_b128 a[188:191], v201 offset:48128
ds_read_b64_tr_b16 a[252:253], v208 offset:20480
ds_read_b64_tr_b16 a[254:255], v208 offset:20992
v_mfma_f32_16x16x32_bf16 v[12:15], a[240:243], a[92:95], v[12:15]
v_add_u32 v191, 24576, v221
s_waitcnt lgkmcnt(8)
v_mfma_f32_16x16x32_bf16 v[16:19], a[244:247], a[80:83], v[16:19]
buffer_load_dwordx4 v212, s[28:31], s70 offen offset:3072 lds
v_mfma_f32_16x16x32_bf16 v[20:23], a[244:247], a[84:87], v[20:23]
s_add_u32 m0, s48, 131072
s_mov_b32 s70, 458752
ds_write_b128 v235, v[160:163] offset:49152
ds_write_b128 v235, v[164:167] offset:49280
v_mfma_f32_16x16x32_bf16 v[24:27], a[244:247], a[88:91], v[24:27]
v_subrev_u32 v191, s99, v191
s_and_b32 s99, s45, 1
v_mfma_f32_16x16x32_bf16 v[28:31], a[244:247], a[92:95], v[28:31]
s_lshl_b32 s99, s99, 6
v_mfma_f32_16x16x32_bf16 v[32:35], a[248:251], a[80:83], v[32:35]
s_add_u32 s99, s99, 256
v_mfma_f32_16x16x32_bf16 v[36:39], a[248:251], a[84:87], v[36:39]
s_add_u32 s99, s99, s98
s_waitcnt lgkmcnt(0) vmcnt(8)
s_barrier
ds_read_b64_tr_b16 a[224:225], v204 offset:0
ds_read_b64_tr_b16 a[226:227], v204 offset:512
v_mfma_f32_16x16x32_bf16 v[40:43], a[248:251], a[88:91], v[40:43]
buffer_load_dwordx4 v209, s[28:31], s71 offen offset:0 lds
v_mfma_f32_16x16x32_bf16 v[44:47], a[248:251], a[92:95], v[44:47]
s_lshr_b32 s98, s44, 1
ds_read_b64_tr_b16 a[228:229], v206 offset:0
v_mfma_f32_16x16x32_bf16 v[48:51], a[252:255], a[80:83], v[48:51]
s_lshl_b32 s98, s98, 2
ds_read_b64_tr_b16 a[230:231], v206 offset:512
v_mfma_f32_16x16x32_bf16 v[52:55], a[252:255], a[84:87], v[52:55]
v_xor_b32 v190, s98, v190
v_xor_b32 v190, v190, v195
v_mfma_f32_16x16x32_bf16 v[56:59], a[252:255], a[88:91], v[56:59]
buffer_load_dwordx4 v210, s[28:31], s71 offen offset:1024 lds
v_mfma_f32_16x16x32_bf16 v[60:63], a[252:255], a[92:95], v[60:63]
v_lshrrev_b32 v195, 3, v255
s_waitcnt lgkmcnt(2)
v_mfma_f32_16x16x32_bf16 v[0:3], a[224:227], a[96:99], v[0:3]
v_mul_u32_u24 v195, 3584, v195
s_and_b32 s98, s44, 1
v_mfma_f32_16x16x32_bf16 v[4:7], a[224:227], a[100:103], v[4:7]
v_add_u32 v195, s99, v195
s_and_b32 s99, s45, 1
ds_read_b64_tr_b16 a[232:233], v204 offset:4096
v_mfma_f32_16x16x32_bf16 v[8:11], a[224:227], a[104:107], v[8:11]
buffer_load_dwordx4 v211, s[28:31], s71 offen offset:2048 lds
ds_read_b64_tr_b16 a[234:235], v204 offset:4608
v_mfma_f32_16x16x32_bf16 v[12:15], a[224:227], a[108:111], v[12:15]
s_xor_b32 s99, s99, 1
s_waitcnt lgkmcnt(2)
v_mfma_f32_16x16x32_bf16 v[16:19], a[228:231], a[96:99], v[16:19]
v_lshlrev_b32 v182, 4, v190
v_xor_b32 v190, 2, v190
v_mfma_f32_16x16x32_bf16 v[20:23], a[228:231], a[100:103], v[20:23]
v_lshlrev_b32 v183, 4, v190
s_mul_i32 s99, s99, 384
v_mfma_f32_16x16x32_bf16 v[24:27], a[228:231], a[104:107], v[24:27]
buffer_load_dwordx4 v212, s[28:31], s71 offen offset:3072 lds
v_mfma_f32_16x16x32_bf16 v[28:31], a[228:231], a[108:111], v[28:31]
s_add_u32 m0, s48, 147456
v_and_b32 v190, 3, v255
v_add_u32 v183, v183, v195
s_mul_i32 s98, s98, 57344
v_add_u32 v182, v182, v195
v_lshrrev_b32 v195, 5, v255
v_lshlrev_b32 v195, 1, v195
ds_read_b64_tr_b16 a[236:237], v206 offset:4096
ds_read_b64_tr_b16 a[238:239], v206 offset:4608
s_waitcnt lgkmcnt(2)
v_mfma_f32_16x16x32_bf16 v[32:35], a[232:235], a[96:99], v[32:35]
buffer_load_dwordx4 v209, s[28:31], s72 offen offset:0 lds
v_mfma_f32_16x16x32_bf16 v[36:39], a[232:235], a[100:103], v[36:39]
v_add_u32 v183, 27648, v183
s_add_u32 s99, s99, s98
ds_read_b64_tr_b16 a[240:241], v204 offset:16384
ds_read_b64_tr_b16 a[242:243], v204 offset:16896
v_mfma_f32_16x16x32_bf16 v[40:43], a[232:235], a[104:107], v[40:43]
s_lshr_b32 s98, s44, 1
s_mov_b32 s71, 573440
v_mfma_f32_16x16x32_bf16 v[44:47], a[232:235], a[108:111], v[44:47]
buffer_load_dwordx4 v210, s[28:31], s72 offen offset:1024 lds
v_xor_b32 v190, s98, v190
v_xor_b32 v190, v190, v195
v_lshrrev_b32 v195, 2, v255
v_lshlrev_b32 v190, 4, v190
v_mul_u32_u24 v195, 3584, v195
v_add_u32 v190, v190, v195
s_waitcnt lgkmcnt(2)
v_mfma_f32_16x16x32_bf16 v[48:51], a[236:239], a[96:99], v[48:51]
v_add_u32 v199, s99, v190
s_lshr_b32 s98, s2, 3
v_mfma_f32_16x16x32_bf16 v[52:55], a[236:239], a[100:103], v[52:55]
s_lshl_b32 s98, s98, 2
s_mov_b32 s99, L_end_main-L_pc
ds_read_b64_tr_b16 a[244:245], v206 offset:16384
ds_read_b64_tr_b16 a[246:247], v206 offset:16896
v_mfma_f32_16x16x32_bf16 v[56:59], a[236:239], a[104:107], v[56:59]
buffer_load_dwordx4 v211, s[28:31], s72 offen offset:2048 lds
v_mfma_f32_16x16x32_bf16 v[60:63], a[236:239], a[108:111], v[60:63]
s_add_u32 s98, s98, s44
s_waitcnt lgkmcnt(2)
v_mfma_f32_16x16x32_bf16 v[0:3], a[240:243], a[112:115], v[0:3]
s_mul_i32 s98, s98, 256
v_mov_b32 v195, 0x7ffffff0
v_mfma_f32_16x16x32_bf16 v[4:7], a[240:243], a[116:119], v[4:7]
s_add_u32 s98, s98, L_flash-L_pc
ds_read_b64_tr_b16 a[248:249], v204 offset:20480
ds_read_b64_tr_b16 a[250:251], v204 offset:20992
v_mfma_f32_16x16x32_bf16 v[8:11], a[240:243], a[120:123], v[8:11]
buffer_load_dwordx4 v212, s[28:31], s72 offen offset:3072 lds
ds_read_b128 a[192:195], v200 offset:49152
ds_read_b128 a[196:199], v200 offset:50176
ds_read_b128 a[200:203], v200 offset:51200
ds_read_b128 a[204:207], v200 offset:52224
ds_read_b128 a[208:211], v201 offset:53248
ds_read_b128 a[212:215], v201 offset:54272
ds_read_b128 a[216:219], v201 offset:55296
ds_read_b128 a[220:223], v201 offset:56320
ds_read_b64_tr_b16 a[252:253], v206 offset:20480
ds_read_b64_tr_b16 a[254:255], v206 offset:20992
v_mfma_f32_16x16x32_bf16 v[12:15], a[240:243], a[124:127], v[12:15]
s_add_u32 m0, s47, 0
s_waitcnt lgkmcnt(11)
v_mfma_f32_16x16x32_bf16 v[16:19], a[244:247], a[112:115], v[16:19]
buffer_load_dwordx4 v182, s[28:31], 0 offen offset:0 lds
v_mfma_f32_16x16x32_bf16 v[20:23], a[244:247], a[116:119], v[20:23]
s_mov_b32 s72, 688128
v_add_u32 v194, s98, v194
v_mfma_f32_16x16x32_bf16 v[24:27], a[244:247], a[120:123], v[24:27]
v_min_u32 v194, s99, v194
s_mov_b32 s99, L_end_main-L_pc
v_mfma_f32_16x16x32_bf16 v[28:31], a[244:247], a[124:127], v[28:31]
s_waitcnt lgkmcnt(5)
v_mfma_f32_16x16x32_bf16 v[32:35], a[248:251], a[112:115], v[32:35]
buffer_load_dwordx4 v183, s[28:31], 0 offen offset:1024 lds
s_waitcnt lgkmcnt(0) vmcnt(10)
s_barrier
v_mfma_f32_16x16x32_bf16 v[36:39], a[248:251], a[116:119], v[36:39]
ds_read_b64_tr_b16 a[224:225], v204 offset:32768
ds_read_b64_tr_b16 a[226:227], v204 offset:33280
v_mfma_f32_16x16x32_bf16 v[40:43], a[248:251], a[120:123], v[40:43]
ds_read_b64_tr_b16 a[228:229], v206 offset:32768
v_mfma_f32_16x16x32_bf16 v[44:47], a[248:251], a[124:127], v[44:47]
ds_read_b64_tr_b16 a[230:231], v206 offset:33280
v_mfma_f32_16x16x32_bf16 v[48:51], a[252:255], a[112:115], v[48:51]
ds_read_b64_tr_b16 a[232:233], v204 offset:36864
v_mfma_f32_16x16x32_bf16 v[52:55], a[252:255], a[116:119], v[52:55]
ds_read_b64_tr_b16 a[234:235], v204 offset:37376
v_mfma_f32_16x16x32_bf16 v[56:59], a[252:255], a[120:123], v[56:59]
ds_read_b64_tr_b16 a[236:237], v206 offset:36864
v_mfma_f32_16x16x32_bf16 v[60:63], a[252:255], a[124:127], v[60:63]
s_lshl_b32 s3, s44, 10
s_add_u32 m0, s3, 8192
ds_read_b64_tr_b16 a[238:239], v206 offset:37376
buffer_load_dwordx4 v199, s[28:31], 0 offen offset:0 lds
s_waitcnt lgkmcnt(6)
v_mfma_f32_16x16x32_bf16 v[0:3], a[224:227], a[128:131], v[0:3]
s_add_u32 m0, s47, 12288
ds_read_b64_tr_b16 a[240:241], v204 offset:49152
v_mfma_f32_16x16x32_bf16 v[4:7], a[224:227], a[132:135], v[4:7]
ds_read_b64_tr_b16 a[242:243], v204 offset:49664
v_mfma_f32_16x16x32_bf16 v[8:11], a[224:227], a[136:139], v[8:11]
ds_read_b64_tr_b16 a[244:245], v206 offset:49152
v_mfma_f32_16x16x32_bf16 v[12:15], a[224:227], a[140:143], v[12:15]
ds_read_b64_tr_b16 a[246:247], v206 offset:49664
s_waitcnt lgkmcnt(7)
v_mfma_f32_16x16x32_bf16 v[16:19], a[228:231], a[128:131], v[16:19]
buffer_load_dwordx4 v182, s[28:31], s73 offen offset:0 lds
v_mfma_f32_16x16x32_bf16 v[20:23], a[228:231], a[132:135], v[20:23]
ds_read_b64_tr_b16 a[248:249], v204 offset:53248
v_mfma_f32_16x16x32_bf16 v[24:27], a[228:231], a[136:139], v[24:27]
ds_read_b64_tr_b16 a[250:251], v204 offset:53760
v_mfma_f32_16x16x32_bf16 v[28:31], a[228:231], a[140:143], v[28:31]
ds_read_b64_tr_b16 a[252:253], v206 offset:53248
s_waitcnt lgkmcnt(7)
v_mfma_f32_16x16x32_bf16 v[32:35], a[232:235], a[128:131], v[32:35]
buffer_load_dwordx4 v183, s[28:31], s73 offen offset:1024 lds
v_mfma_f32_16x16x32_bf16 v[36:39], a[232:235], a[132:135], v[36:39]
ds_read_b64_tr_b16 a[254:255], v206 offset:53760
v_mfma_f32_16x16x32_bf16 v[40:43], a[232:235], a[136:139], v[40:43]
v_mfma_f32_16x16x32_bf16 v[44:47], a[232:235], a[140:143], v[44:47]
v_mfma_f32_16x16x32_bf16 v[48:51], a[236:239], a[128:131], v[48:51]
v_mfma_f32_16x16x32_bf16 v[52:55], a[236:239], a[132:135], v[52:55]
v_mfma_f32_16x16x32_bf16 v[56:59], a[236:239], a[136:139], v[56:59]
v_mfma_f32_16x16x32_bf16 v[60:63], a[236:239], a[140:143], v[60:63]
s_waitcnt lgkmcnt(1)
v_mfma_f32_16x16x32_bf16 v[0:3], a[240:243], a[144:147], v[0:3]
v_mfma_f32_16x16x32_bf16 v[4:7], a[240:243], a[148:151], v[4:7]
v_mfma_f32_16x16x32_bf16 v[8:11], a[240:243], a[152:155], v[8:11]
v_mfma_f32_16x16x32_bf16 v[12:15], a[240:243], a[156:159], v[12:15]
v_mfma_f32_16x16x32_bf16 v[16:19], a[244:247], a[144:147], v[16:19]
s_waitcnt lgkmcnt(0) vmcnt(5)
s_barrier
v_mfma_f32_16x16x32_bf16 v[20:23], a[244:247], a[148:151], v[20:23]
ds_read_b64_tr_b16 a[224:225], v207 offset:0
v_mfma_f32_16x16x32_bf16 v[24:27], a[244:247], a[152:155], v[24:27]
ds_read_b64_tr_b16 a[226:227], v207 offset:512
v_mfma_f32_16x16x32_bf16 v[28:31], a[244:247], a[156:159], v[28:31]
ds_read_b64_tr_b16 a[228:229], v208 offset:0
v_mfma_f32_16x16x32_bf16 v[32:35], a[248:251], a[144:147], v[32:35]
ds_read_b64_tr_b16 a[230:231], v208 offset:512
v_mfma_f32_16x16x32_bf16 v[36:39], a[248:251], a[148:151], v[36:39]
ds_read_b64_tr_b16 a[232:233], v207 offset:4096
v_mfma_f32_16x16x32_bf16 v[40:43], a[248:251], a[152:155], v[40:43]
ds_read_b64_tr_b16 a[234:235], v207 offset:4608
v_mfma_f32_16x16x32_bf16 v[44:47], a[248:251], a[156:159], v[44:47]
ds_read_b64_tr_b16 a[236:237], v208 offset:4096
s_lshl_b32 s3, s44, 10
s_add_u32 m0, s3, 20480
v_mfma_f32_16x16x32_bf16 v[48:51], a[252:255], a[144:147], v[48:51]
buffer_load_dwordx4 v199, s[28:31], s73 offen offset:0 lds
v_mfma_f32_16x16x32_bf16 v[52:55], a[252:255], a[148:151], v[52:55]
s_add_u32 m0, s48, 65536
s_mov_b32 s73, 802816
v_mfma_f32_16x16x32_bf16 v[56:59], a[252:255], a[152:155], v[56:59]
ds_read_b64_tr_b16 a[238:239], v208 offset:4608
v_mfma_f32_16x16x32_bf16 v[60:63], a[252:255], a[156:159], v[60:63]
ds_read_b64_tr_b16 a[240:241], v207 offset:16384
s_waitcnt lgkmcnt(5)
v_mfma_f32_16x16x32_bf16 v[0:3], a[224:227], a[160:163], v[0:3]
buffer_load_dwordx4 v209, s[28:31], s74 offen offset:0 lds
v_mfma_f32_16x16x32_bf16 v[4:7], a[224:227], a[164:167], v[4:7]
ds_read_b64_tr_b16 a[242:243], v207 offset:16896
v_mfma_f32_16x16x32_bf16 v[8:11], a[224:227], a[168:171], v[8:11]
ds_read_b64_tr_b16 a[244:245], v208 offset:16384
v_mfma_f32_16x16x32_bf16 v[12:15], a[224:227], a[172:175], v[12:15]
ds_read_b64_tr_b16 a[246:247], v208 offset:16896
v_mfma_f32_16x16x32_bf16 v[16:19], a[228:231], a[160:163], v[16:19]
buffer_load_dwordx4 v210, s[28:31], s74 offen offset:1024 lds
v_mfma_f32_16x16x32_bf16 v[20:23], a[228:231], a[164:167], v[20:23]
ds_read_b64_tr_b16 a[248:249], v207 offset:20480
v_mfma_f32_16x16x32_bf16 v[24:27], a[228:231], a[168:171], v[24:27]
ds_read_b64_tr_b16 a[250:251], v207 offset:20992
v_mfma_f32_16x16x32_bf16 v[28:31], a[228:231], a[172:175], v[28:31]
ds_read_b64_tr_b16 a[252:253], v208 offset:20480
s_waitcnt lgkmcnt(6)
v_mfma_f32_16x16x32_bf16 v[32:35], a[232:235], a[160:163], v[32:35]
buffer_load_dwordx4 v211, s[28:31], s74 offen offset:2048 lds
v_mfma_f32_16x16x32_bf16 v[36:39], a[232:235], a[164:167], v[36:39]
ds_read_b64_tr_b16 a[254:255], v208 offset:20992
v_mfma_f32_16x16x32_bf16 v[40:43], a[232:235], a[168:171], v[40:43]
v_mfma_f32_16x16x32_bf16 v[44:47], a[232:235], a[172:175], v[44:47]
v_mfma_f32_16x16x32_bf16 v[48:51], a[236:239], a[160:163], v[48:51]
buffer_load_dwordx4 v212, s[28:31], s74 offen offset:3072 lds
s_add_u32 m0, s48, 81920
v_mfma_f32_16x16x32_bf16 v[52:55], a[236:239], a[164:167], v[52:55]
s_mov_b32 s74, 917504
v_mfma_f32_16x16x32_bf16 v[56:59], a[236:239], a[168:171], v[56:59]
v_mfma_f32_16x16x32_bf16 v[60:63], a[236:239], a[172:175], v[60:63]
s_waitcnt lgkmcnt(1)
v_mfma_f32_16x16x32_bf16 v[0:3], a[240:243], a[176:179], v[0:3]
buffer_load_dwordx4 v209, s[28:31], s75 offen offset:0 lds
v_mfma_f32_16x16x32_bf16 v[4:7], a[240:243], a[180:183], v[4:7]
v_mfma_f32_16x16x32_bf16 v[8:11], a[240:243], a[184:187], v[8:11]
v_mfma_f32_16x16x32_bf16 v[12:15], a[240:243], a[188:191], v[12:15]
v_mfma_f32_16x16x32_bf16 v[16:19], a[244:247], a[176:179], v[16:19]
buffer_load_dwordx4 v210, s[28:31], s75 offen offset:1024 lds
v_mfma_f32_16x16x32_bf16 v[20:23], a[244:247], a[180:183], v[20:23]
v_mfma_f32_16x16x32_bf16 v[24:27], a[244:247], a[184:187], v[24:27]
v_mfma_f32_16x16x32_bf16 v[28:31], a[244:247], a[188:191], v[28:31]
v_mfma_f32_16x16x32_bf16 v[32:35], a[248:251], a[176:179], v[32:35]
buffer_load_dwordx4 v211, s[28:31], s75 offen offset:2048 lds
v_mfma_f32_16x16x32_bf16 v[36:39], a[248:251], a[180:183], v[36:39]
v_mfma_f32_16x16x32_bf16 v[40:43], a[248:251], a[184:187], v[40:43]
v_mfma_f32_16x16x32_bf16 v[44:47], a[248:251], a[188:191], v[44:47]
s_waitcnt lgkmcnt(0)
v_mfma_f32_16x16x32_bf16 v[48:51], a[252:255], a[176:179], v[48:51]
buffer_load_dwordx4 v212, s[28:31], s75 offen offset:3072 lds
v_mfma_f32_16x16x32_bf16 v[52:55], a[252:255], a[180:183], v[52:55]
s_add_u32 m0, s47, 24576
s_mov_b32 s75, 1032192
v_mfma_f32_16x16x32_bf16 v[56:59], a[252:255], a[184:187], v[56:59]
v_mfma_f32_16x16x32_bf16 v[60:63], a[252:255], a[188:191], v[60:63]
buffer_load_dwordx4 v182, s[28:31], s76 offen offset:0 lds
buffer_load_dwordx4 v183, s[28:31], s76 offen offset:1024 lds
s_lshl_b32 s3, s44, 10
s_add_u32 m0, s3, 32768
s_nop 0
buffer_load_dwordx4 v199, s[28:31], s76 offen offset:0 lds
s_add_u32 m0, s47, 36864
s_mov_b32 s76, 1146880
buffer_load_dwordx4 v182, s[28:31], s77 offen offset:0 lds
buffer_load_dwordx4 v183, s[28:31], s77 offen offset:1024 lds
s_lshl_b32 s3, s44, 10
s_add_u32 m0, s3, 45056
s_nop 0
buffer_load_dwordx4 v199, s[28:31], s77 offen offset:0 lds
s_add_u32 m0, s47, 49152
s_mov_b32 s77, 1261568
buffer_load_dwordx4 v182, s[28:31], s70 offen offset:0 lds
s_waitcnt vmcnt(7)
s_barrier
ds_read_b64_tr_b16 a[224:225], v204 offset:0
ds_read_b64_tr_b16 a[226:227], v204 offset:512
ds_read_b64_tr_b16 a[228:229], v206 offset:0
buffer_load_dwordx4 v183, s[28:31], s70 offen offset:1024 lds
s_lshl_b32 s3, s44, 10
s_add_u32 m0, s3, 57344
ds_read_b64_tr_b16 a[230:231], v206 offset:512
ds_read_b64_tr_b16 a[232:233], v204 offset:4096
ds_read_b64_tr_b16 a[234:235], v204 offset:4608
ds_read_b64_tr_b16 a[236:237], v206 offset:4096
ds_read_b64_tr_b16 a[238:239], v206 offset:4608
ds_read_b64_tr_b16 a[240:241], v204 offset:16384
buffer_load_dwordx4 v199, s[28:31], s70 offen offset:0 lds
s_add_u32 m0, s47, 0
s_mov_b32 s70, 1376256
ds_read_b64_tr_b16 a[242:243], v204 offset:16896
ds_read_b64_tr_b16 a[244:245], v206 offset:16384
ds_read_b64_tr_b16 a[246:247], v206 offset:16896
ds_read_b64_tr_b16 a[248:249], v204 offset:20480
s_waitcnt lgkmcnt(11)
v_mfma_f32_16x16x32_bf16 v[0:3], a[224:227], a[192:195], v[0:3]
ds_read_b64_tr_b16 a[250:251], v204 offset:20992
v_mfma_f32_16x16x32_bf16 v[4:7], a[224:227], a[196:199], v[4:7]
ds_read_b64_tr_b16 a[252:253], v206 offset:20480
v_mfma_f32_16x16x32_bf16 v[8:11], a[224:227], a[200:203], v[8:11]
ds_read_b64_tr_b16 a[254:255], v206 offset:20992
v_mfma_f32_16x16x32_bf16 v[12:15], a[224:227], a[204:207], v[12:15]
s_waitcnt lgkmcnt(9)
v_mfma_f32_16x16x32_bf16 v[16:19], a[228:231], a[192:195], v[16:19]
v_mfma_f32_16x16x32_bf16 v[20:23], a[228:231], a[196:199], v[20:23]
v_mfma_f32_16x16x32_bf16 v[24:27], a[228:231], a[200:203], v[24:27]
v_mfma_f32_16x16x32_bf16 v[28:31], a[228:231], a[204:207], v[28:31]
v_mfma_f32_16x16x32_bf16 v[32:35], a[232:235], a[192:195], v[32:35]
v_mfma_f32_16x16x32_bf16 v[36:39], a[232:235], a[196:199], v[36:39]
v_mfma_f32_16x16x32_bf16 v[40:43], a[232:235], a[200:203], v[40:43]
v_mfma_f32_16x16x32_bf16 v[44:47], a[232:235], a[204:207], v[44:47]
s_waitcnt lgkmcnt(0)
v_mfma_f32_16x16x32_bf16 v[48:51], a[236:239], a[192:195], v[48:51]
v_mfma_f32_16x16x32_bf16 v[52:55], a[236:239], a[196:199], v[52:55]
v_mfma_f32_16x16x32_bf16 v[56:59], a[236:239], a[200:203], v[56:59]
v_mfma_f32_16x16x32_bf16 v[60:63], a[236:239], a[204:207], v[60:63]
v_mfma_f32_16x16x32_bf16 v[0:3], a[240:243], a[208:211], v[0:3]
v_mfma_f32_16x16x32_bf16 v[4:7], a[240:243], a[212:215], v[4:7]
v_mfma_f32_16x16x32_bf16 v[8:11], a[240:243], a[216:219], v[8:11]
v_mfma_f32_16x16x32_bf16 v[12:15], a[240:243], a[220:223], v[12:15]
v_mfma_f32_16x16x32_bf16 v[16:19], a[244:247], a[208:211], v[16:19]
s_barrier
v_mfma_f32_16x16x32_bf16 v[20:23], a[244:247], a[212:215], v[20:23]
ds_read_b64_tr_b16 a[224:225], v196 offset:0
v_mfma_f32_16x16x32_bf16 v[24:27], a[244:247], a[216:219], v[24:27]
ds_read_b64_tr_b16 a[226:227], v196 offset:512
v_permlane32_swap_b32 v0, v4
v_mfma_f32_16x16x32_bf16 v[28:31], a[244:247], a[220:223], v[28:31]
ds_read_b64_tr_b16 a[228:229], v197 offset:0
v_permlane32_swap_b32 v1, v5
v_mfma_f32_16x16x32_bf16 v[32:35], a[248:251], a[208:211], v[32:35]
ds_read_b64_tr_b16 a[230:231], v197 offset:512
v_permlane32_swap_b32 v2, v6
v_mfma_f32_16x16x32_bf16 v[36:39], a[248:251], a[212:215], v[36:39]
ds_read_b64_tr_b16 a[232:233], v198 offset:0
v_permlane32_swap_b32 v3, v7
v_mfma_f32_16x16x32_bf16 v[40:43], a[248:251], a[216:219], v[40:43]
ds_read_b64_tr_b16 a[234:235], v198 offset:256
v_mul_f32 v176, v0, v0
v_mfma_f32_16x16x32_bf16 v[44:47], a[248:251], a[220:223], v[44:47]
ds_read_b64_tr_b16 a[236:237], v196 offset:12288
v_mul_f32 v177, v1, v1
ds_read_b64_tr_b16 a[238:239], v196 offset:12800
ds_read_b64_tr_b16 a[240:241], v197 offset:12288
ds_read_b64_tr_b16 a[242:243], v197 offset:12800
ds_read_b64_tr_b16 a[244:245], v198 offset:12288
ds_read_b64_tr_b16 a[246:247], v198 offset:12544
v_mfma_f32_16x16x32_bf16 v[48:51], a[252:255], a[208:211], v[48:51]
v_mul_f32 v178, v2, v2
v_mfma_f32_16x16x32_bf16 v[52:55], a[252:255], a[212:215], v[52:55]
v_mul_f32 v179, v3, v3
v_mfma_f32_16x16x32_bf16 v[56:59], a[252:255], a[216:219], v[56:59]
v_fma_f32 v176, v176, s67, v203
v_mfma_f32_16x16x32_bf16 v[60:63], a[252:255], a[220:223], v[60:63]
v_fma_f32 v177, v177, s67, v203
s_waitcnt lgkmcnt(6)
v_mfma_f32_16x16x32_bf16 v[64:67], a[224:227], a[0:3], 0
v_fma_f32 v178, v178, s67, v203
v_mfma_f32_16x16x32_bf16 v[68:71], a[224:227], a[4:7], 0
v_fma_f32 v179, v179, s67, v203
v_mfma_f32_16x16x32_bf16 v[72:75], a[224:227], a[8:11], 0
v_mul_f32 v176, v0, v176
s_waitcnt lgkmcnt(0) vmcnt(3)
s_barrier
buffer_load_dwordx4 v182, s[28:31], s71 offen offset:0 lds
v_mfma_f32_16x16x32_bf16 v[76:79], a[224:227], a[12:15], 0
ds_read_b64_tr_b16 a[248:249], v196 offset:24576
v_mul_f32 v177, v1, v177
v_mfma_f32_16x16x32_bf16 v[80:83], a[228:231], a[0:3], 0
ds_read_b64_tr_b16 a[250:251], v196 offset:25088
v_mul_f32 v178, v2, v178
v_mfma_f32_16x16x32_bf16 v[84:87], a[228:231], a[4:7], 0
ds_read_b64_tr_b16 a[252:253], v197 offset:24576
v_mul_f32 v179, v3, v179
v_mfma_f32_16x16x32_bf16 v[88:91], a[228:231], a[8:11], 0
buffer_load_dwordx4 v183, s[28:31], s71 offen offset:1024 lds
s_lshl_b32 s3, s44, 10
s_add_u32 m0, s3, 8192
v_mfma_f32_16x16x32_bf16 v[92:95], a[228:231], a[12:15], 0
ds_read_b64_tr_b16 a[254:255], v197 offset:25088
v_mul_f32 v4, v0, v4
v_mfma_f32_16x16x32_bf16 v[96:99], a[232:235], a[0:3], 0
ds_read_b64_tr_b16 a[224:225], v198 offset:24576
v_mul_f32 v5, v1, v5
v_mfma_f32_16x16x32_bf16 v[100:103], a[232:235], a[4:7], 0
buffer_load_dwordx4 v199, s[28:31], s71 offen offset:0 lds
v_mfma_f32_16x16x32_bf16 v[104:107], a[232:235], a[8:11], 0
s_add_u32 m0, s47, 12288
s_mov_b32 s71, 0
v_mfma_f32_16x16x32_bf16 v[108:111], a[232:235], a[12:15], 0
ds_read_b64_tr_b16 a[226:227], v198 offset:24832
v_mul_f32 v6, v2, v6
v_mfma_f32_16x16x32_bf16 v[64:67], a[236:239], a[16:19], v[64:67]
ds_read_b64_tr_b16 a[228:229], v196 offset:36864
v_mul_f32 v7, v3, v7
v_mfma_f32_16x16x32_bf16 v[68:71], a[236:239], a[20:23], v[68:71]
buffer_load_dwordx4 v182, s[28:31], s72 offen offset:0 lds
v_mfma_f32_16x16x32_bf16 v[72:75], a[236:239], a[24:27], v[72:75]
ds_read_b64_tr_b16 a[230:231], v196 offset:37376
v_permlane32_swap_b32 v8, v12
v_mfma_f32_16x16x32_bf16 v[76:79], a[236:239], a[28:31], v[76:79]
ds_read_b64_tr_b16 a[232:233], v197 offset:36864
v_permlane32_swap_b32 v9, v13
v_mfma_f32_16x16x32_bf16 v[80:83], a[240:243], a[16:19], v[80:83]
ds_read_b64_tr_b16 a[234:235], v197 offset:37376
v_permlane32_swap_b32 v10, v14
v_mfma_f32_16x16x32_bf16 v[84:87], a[240:243], a[20:23], v[84:87]
buffer_load_dwordx4 v183, s[28:31], s72 offen offset:1024 lds
v_mfma_f32_16x16x32_bf16 v[88:91], a[240:243], a[24:27], v[88:91]
ds_read_b64_tr_b16 a[236:237], v198 offset:36864
v_permlane32_swap_b32 v11, v15
v_mfma_f32_16x16x32_bf16 v[92:95], a[240:243], a[28:31], v[92:95]
ds_read_b64_tr_b16 a[238:239], v198 offset:37120
v_mul_f32 v184, v8, v8
v_mfma_f32_16x16x32_bf16 v[96:99], a[244:247], a[16:19], v[96:99]
v_exp_f32 v176, v176
v_mfma_f32_16x16x32_bf16 v[100:103], a[244:247], a[20:23], v[100:103]
v_exp_f32 v177, v177
v_mfma_f32_16x16x32_bf16 v[104:107], a[244:247], a[24:27], v[104:107]
v_exp_f32 v178, v178
v_mfma_f32_16x16x32_bf16 v[108:111], a[244:247], a[28:31], v[108:111]
v_add_f32 v176, 1.0, v176
s_waitcnt lgkmcnt(2)
v_mfma_f32_16x16x32_bf16 v[64:67], a[248:251], a[32:35], v[64:67]
v_exp_f32 v179, v179
v_mfma_f32_16x16x32_bf16 v[68:71], a[248:251], a[36:39], v[68:71]
v_add_f32 v177, 1.0, v177
v_mfma_f32_16x16x32_bf16 v[72:75], a[248:251], a[40:43], v[72:75]
v_add_f32 v178, 1.0, v178
s_lshl_b32 s3, s44, 10
s_add_u32 m0, s3, 20480
v_mfma_f32_16x16x32_bf16 v[76:79], a[248:251], a[44:47], v[76:79]
buffer_load_dwordx4 v199, s[28:31], s72 offen offset:0 lds
v_mfma_f32_16x16x32_bf16 v[80:83], a[252:255], a[32:35], v[80:83]
s_add_u32 m0, s47, 24576
s_mov_b32 s72, 262144
v_mfma_f32_16x16x32_bf16 v[84:87], a[252:255], a[36:39], v[84:87]
v_add_f32 v179, 1.0, v179
v_mul_f32 v185, v9, v9
v_mfma_f32_16x16x32_bf16 v[88:91], a[252:255], a[40:43], v[88:91]
v_mul_f32 v186, v10, v10
v_mfma_f32_16x16x32_bf16 v[92:95], a[252:255], a[44:47], v[92:95]
v_rcp_f32 v176, v176
v_mfma_f32_16x16x32_bf16 v[96:99], a[224:227], a[32:35], v[96:99]
v_rcp_f32 v177, v177
v_mfma_f32_16x16x32_bf16 v[100:103], a[224:227], a[36:39], v[100:103]
v_rcp_f32 v178, v178
v_mfma_f32_16x16x32_bf16 v[104:107], a[224:227], a[40:43], v[104:107]
s_waitcnt lgkmcnt(0) vmcnt(3)
s_barrier
buffer_load_dwordx4 v182, s[28:31], s73 offen offset:0 lds
v_mfma_f32_16x16x32_bf16 v[108:111], a[224:227], a[44:47], v[108:111]
ds_read_b64_tr_b16 a[240:241], v196 offset:49152
v_mul_f32 v187, v11, v11
v_mfma_f32_16x16x32_bf16 v[64:67], a[228:231], a[48:51], v[64:67]
ds_read_b64_tr_b16 a[242:243], v196 offset:49664
v_fma_f32 v184, v184, s67, v203
v_mfma_f32_16x16x32_bf16 v[68:71], a[228:231], a[52:55], v[68:71]
ds_read_b64_tr_b16 a[244:245], v197 offset:49152
v_fma_f32 v185, v185, s67, v203
v_mfma_f32_16x16x32_bf16 v[72:75], a[228:231], a[56:59], v[72:75]
buffer_load_dwordx4 v183, s[28:31], s73 offen offset:1024 lds
s_lshl_b32 s3, s44, 10
s_add_u32 m0, s3, 32768
v_mfma_f32_16x16x32_bf16 v[76:79], a[228:231], a[60:63], v[76:79]
ds_read_b64_tr_b16 a[246:247], v197 offset:49664
v_fma_f32 v186, v186, s67, v203
v_mfma_f32_16x16x32_bf16 v[80:83], a[232:235], a[48:51], v[80:83]
ds_read_b64_tr_b16 a[248:249], v198 offset:49152
v_fma_f32 v187, v187, s67, v203
v_mfma_f32_16x16x32_bf16 v[84:87], a[232:235], a[52:55], v[84:87]
buffer_load_dwordx4 v199, s[28:31], s73 offen offset:0 lds
v_mfma_f32_16x16x32_bf16 v[88:91], a[232:235], a[56:59], v[88:91]
s_add_u32 m0, s47, 36864
s_mov_b32 s73, 1490944
v_mfma_f32_16x16x32_bf16 v[92:95], a[232:235], a[60:63], v[92:95]
ds_read_b64_tr_b16 a[250:251], v198 offset:49408
v_mul_f32 v176, v4, v176
v_mfma_f32_16x16x32_bf16 v[96:99], a[236:239], a[48:51], v[96:99]
ds_read_b64_tr_b16 a[252:253], v196 offset:0
v_mul_f32 v177, v5, v177
v_mfma_f32_16x16x32_bf16 v[100:103], a[236:239], a[52:55], v[100:103]
buffer_load_dwordx4 v182, s[28:31], s74 offen offset:0 lds
v_mfma_f32_16x16x32_bf16 v[104:107], a[236:239], a[56:59], v[104:107]
ds_read_b64_tr_b16 a[254:255], v196 offset:512
v_mul_f32 v178, v6, v178
v_mfma_f32_16x16x32_bf16 v[108:111], a[236:239], a[60:63], v[108:111]
ds_read_b64_tr_b16 a[224:225], v197 offset:0
s_waitcnt lgkmcnt(4)
v_mfma_f32_16x16x32_bf16 v[64:67], a[240:243], a[64:67], v[64:67]
ds_read_b64_tr_b16 a[226:227], v197 offset:512
v_mul_f32 v184, v8, v184
v_mfma_f32_16x16x32_bf16 v[68:71], a[240:243], a[68:71], v[68:71]
buffer_load_dwordx4 v183, s[28:31], s74 offen offset:1024 lds
ds_read_b64_tr_b16 a[228:229], v198 offset:0
ds_read_b64_tr_b16 a[230:231], v198 offset:256
v_mfma_f32_16x16x32_bf16 v[72:75], a[240:243], a[72:75], v[72:75]
v_rcp_f32 v179, v179
v_mfma_f32_16x16x32_bf16 v[76:79], a[240:243], a[76:79], v[76:79]
v_mul_f32 v179, v7, v179
v_mfma_f32_16x16x32_bf16 v[80:83], a[244:247], a[64:67], v[80:83]
v_mul_f32 v185, v9, v185
v_mfma_f32_16x16x32_bf16 v[84:87], a[244:247], a[68:71], v[84:87]
v_mul_f32 v186, v10, v186
s_lshl_b32 s3, s44, 10
s_add_u32 m0, s3, 45056
v_mfma_f32_16x16x32_bf16 v[88:91], a[244:247], a[72:75], v[88:91]
buffer_load_dwordx4 v199, s[28:31], s74 offen offset:0 lds
v_mfma_f32_16x16x32_bf16 v[92:95], a[244:247], a[76:79], v[92:95]
s_add_u32 m0, s47, 49152
s_waitcnt lgkmcnt(2)
v_mfma_f32_16x16x32_bf16 v[96:99], a[248:251], a[64:67], v[96:99]
s_mov_b32 s74, 524288
v_mul_f32 v187, v11, v187
v_mfma_f32_16x16x32_bf16 v[100:103], a[248:251], a[68:71], v[100:103]
v_exp_f32 v184, v184
v_mfma_f32_16x16x32_bf16 v[104:107], a[248:251], a[72:75], v[104:107]
v_exp_f32 v185, v185
v_mfma_f32_16x16x32_bf16 v[108:111], a[248:251], a[76:79], v[108:111]
v_exp_f32 v186, v186
v_mfma_f32_16x16x32_bf16 v[64:67], a[252:255], a[80:83], v[64:67]
v_exp_f32 v187, v187
v_mfma_f32_16x16x32_bf16 v[68:71], a[252:255], a[84:87], v[68:71]
v_mul_f32 v12, v8, v12
v_mfma_f32_16x16x32_bf16 v[72:75], a[252:255], a[88:91], v[72:75]
v_add_f32 v184, 1.0, v184
v_mfma_f32_16x16x32_bf16 v[76:79], a[252:255], a[92:95], v[76:79]
v_mul_f32 v13, v9, v13
v_mfma_f32_16x16x32_bf16 v[80:83], a[224:227], a[80:83], v[80:83]
v_add_f32 v185, 1.0, v185
v_mfma_f32_16x16x32_bf16 v[84:87], a[224:227], a[84:87], v[84:87]
v_mul_f32 v14, v10, v14
s_waitcnt lgkmcnt(0) vmcnt(3)
s_barrier
buffer_load_dwordx4 v182, s[28:31], s75 offen offset:0 lds
ds_read_b64_tr_b16 a[232:233], v196 offset:12288
ds_read_b64_tr_b16 a[234:235], v196 offset:12800
v_mfma_f32_16x16x32_bf16 v[88:91], a[224:227], a[88:91], v[88:91]
ds_read_b64_tr_b16 a[236:237], v197 offset:12288
v_add_f32 v186, 1.0, v186
v_mfma_f32_16x16x32_bf16 v[92:95], a[224:227], a[92:95], v[92:95]
ds_read_b64_tr_b16 a[238:239], v197 offset:12800
v_mul_f32 v15, v11, v15
v_mfma_f32_16x16x32_bf16 v[96:99], a[228:231], a[80:83], v[96:99]
buffer_load_dwordx4 v183, s[28:31], s75 offen offset:1024 lds
s_lshl_b32 s3, s44, 10
s_add_u32 m0, s3, 57344
v_mfma_f32_16x16x32_bf16 v[100:103], a[228:231], a[84:87], v[100:103]
ds_read_b64_tr_b16 a[240:241], v198 offset:12288
v_add_f32 v187, 1.0, v187
v_mfma_f32_16x16x32_bf16 v[104:107], a[228:231], a[88:91], v[104:107]
ds_read_b64_tr_b16 a[242:243], v198 offset:12544
v_cvt_pk_bf16_f32 v180, v176, v177
v_mfma_f32_16x16x32_bf16 v[108:111], a[228:231], a[92:95], v[108:111]
ds_read_b64_tr_b16 a[244:245], v196 offset:24576
buffer_load_dwordx4 v199, s[28:31], s75 offen offset:0 lds
s_waitcnt lgkmcnt(5)
v_mfma_f32_16x16x32_bf16 v[64:67], a[232:235], a[96:99], v[64:67]
s_add_u32 m0, s47, 0
s_mov_b32 s75, 786432
v_mfma_f32_16x16x32_bf16 v[68:71], a[232:235], a[100:103], v[68:71]
ds_read_b64_tr_b16 a[246:247], v196 offset:25088
v_cvt_pk_bf16_f32 v181, v178, v179
v_mfma_f32_16x16x32_bf16 v[72:75], a[232:235], a[104:107], v[72:75]
ds_read_b64_tr_b16 a[248:249], v197 offset:24576
v_permlane32_swap_b32 v16, v20
v_mfma_f32_16x16x32_bf16 v[76:79], a[232:235], a[108:111], v[76:79]
ds_read_b64_tr_b16 a[250:251], v197 offset:25088
s_waitcnt lgkmcnt(6)
v_mfma_f32_16x16x32_bf16 v[80:83], a[236:239], a[96:99], v[80:83]
buffer_load_dwordx4 v182, s[28:31], s76 offen offset:0 lds
ds_read_b64_tr_b16 a[252:253], v198 offset:24576
ds_read_b64_tr_b16 a[254:255], v198 offset:24832
v_mfma_f32_16x16x32_bf16 v[84:87], a[236:239], a[100:103], v[84:87]
v_rcp_f32 v184, v184
v_mfma_f32_16x16x32_bf16 v[88:91], a[236:239], a[104:107], v[88:91]
v_rcp_f32 v185, v185
v_mfma_f32_16x16x32_bf16 v[92:95], a[236:239], a[108:111], v[92:95]
v_permlane32_swap_b32 v17, v21
s_waitcnt lgkmcnt(5)
v_mfma_f32_16x16x32_bf16 v[96:99], a[240:243], a[96:99], v[96:99]
buffer_load_dwordx4 v183, s[28:31], s76 offen offset:1024 lds
v_mfma_f32_16x16x32_bf16 v[100:103], a[240:243], a[100:103], v[100:103]
v_rcp_f32 v186, v186
v_mfma_f32_16x16x32_bf16 v[104:107], a[240:243], a[104:107], v[104:107]
v_rcp_f32 v187, v187
s_lshl_b32 s3, s44, 10
s_add_u32 m0, s3, 8192
v_mfma_f32_16x16x32_bf16 v[108:111], a[240:243], a[108:111], v[108:111]
v_permlane32_swap_b32 v18, v22
buffer_load_dwordx4 v199, s[28:31], s76 offen offset:0 lds
s_add_u32 m0, s47, 12288
s_waitcnt lgkmcnt(0)
v_mfma_f32_16x16x32_bf16 v[64:67], a[244:247], a[112:115], v[64:67]
s_mov_b32 s76, 1048576
v_permlane32_swap_b32 v19, v23
v_mfma_f32_16x16x32_bf16 v[68:71], a[244:247], a[116:119], v[68:71]
v_mul_f32 v176, v16, v16
v_mfma_f32_16x16x32_bf16 v[72:75], a[244:247], a[120:123], v[72:75]
v_mul_f32 v177, v17, v17
v_mfma_f32_16x16x32_bf16 v[76:79], a[244:247], a[124:127], v[76:79]
v_mul_f32 v178, v18, v18
v_mfma_f32_16x16x32_bf16 v[80:83], a[248:251], a[112:115], v[80:83]
v_mul_f32 v179, v19, v19
v_mfma_f32_16x16x32_bf16 v[84:87], a[248:251], a[116:119], v[84:87]
v_fma_f32 v176, v176, s67, v203
v_mfma_f32_16x16x32_bf16 v[88:91], a[248:251], a[120:123], v[88:91]
v_fma_f32 v177, v177, s67, v203
v_mfma_f32_16x16x32_bf16 v[92:95], a[248:251], a[124:127], v[92:95]
v_fma_f32 v178, v178, s67, v203
v_mfma_f32_16x16x32_bf16 v[96:99], a[252:255], a[112:115], v[96:99]
v_fma_f32 v179, v179, s67, v203
v_mfma_f32_16x16x32_bf16 v[100:103], a[252:255], a[116:119], v[100:103]
v_mul_f32 v184, v12, v184
v_mfma_f32_16x16x32_bf16 v[104:107], a[252:255], a[120:123], v[104:107]
v_mul_f32 v185, v13, v185
v_mfma_f32_16x16x32_bf16 v[108:111], a[252:255], a[124:127], v[108:111]
s_waitcnt vmcnt(3)
s_barrier
buffer_load_dwordx4 v182, s[28:31], s77 offen offset:0 lds
ds_read_b64_tr_b16 a[224:225], v196 offset:36864
ds_read_b64_tr_b16 a[226:227], v196 offset:37376
ds_read_b64_tr_b16 a[228:229], v197 offset:36864
ds_read_b64_tr_b16 a[230:231], v197 offset:37376
ds_read_b64_tr_b16 a[232:233], v198 offset:36864
ds_read_b64_tr_b16 a[234:235], v198 offset:37120
ds_read_b64_tr_b16 a[236:237], v196 offset:49152
buffer_load_dwordx4 v183, s[28:31], s77 offen offset:1024 lds
s_lshl_b32 s3, s44, 10
s_add_u32 m0, s3, 20480
ds_read_b64_tr_b16 a[238:239], v196 offset:49664
ds_read_b64_tr_b16 a[240:241], v197 offset:49152
ds_read_b64_tr_b16 a[242:243], v197 offset:49664
ds_read_b64_tr_b16 a[244:245], v198 offset:49152
ds_read_b64_tr_b16 a[246:247], v198 offset:49408
v_mul_f32 v186, v14, v186
v_mul_f32 v187, v15, v187
buffer_load_dwordx4 v199, s[28:31], s77 offen offset:0 lds
s_add_u32 m0, s47, 24576
s_waitcnt lgkmcnt(10)
v_mfma_f32_16x16x32_bf16 v[64:67], a[224:227], a[128:131], v[64:67]
s_mov_b32 s77, 1310720
v_mul_f32 v176, v16, v176
v_mfma_f32_16x16x32_bf16 v[68:71], a[224:227], a[132:135], v[68:71]
v_mul_f32 v177, v17, v177
v_mfma_f32_16x16x32_bf16 v[72:75], a[224:227], a[136:139], v[72:75]
v_mul_f32 v178, v18, v178
v_mfma_f32_16x16x32_bf16 v[76:79], a[224:227], a[140:143], v[76:79]
v_mul_f32 v179, v19, v179
s_waitcnt lgkmcnt(5)
v_mfma_f32_16x16x32_bf16 v[80:83], a[228:231], a[128:131], v[80:83]
buffer_load_dwordx4 v182, s[28:31], s70 offen offset:0 lds
v_mfma_f32_16x16x32_bf16 v[84:87], a[228:231], a[132:135], v[84:87]
v_exp_f32 v176, v176
v_mfma_f32_16x16x32_bf16 v[88:91], a[228:231], a[136:139], v[88:91]
v_exp_f32 v177, v177
v_mfma_f32_16x16x32_bf16 v[92:95], a[228:231], a[140:143], v[92:95]
v_exp_f32 v178, v178
v_mfma_f32_16x16x32_bf16 v[96:99], a[232:235], a[128:131], v[96:99]
buffer_load_dwordx4 v183, s[28:31], s70 offen offset:1024 lds
v_mfma_f32_16x16x32_bf16 v[100:103], a[232:235], a[132:135], v[100:103]
v_exp_f32 v179, v179
v_mfma_f32_16x16x32_bf16 v[104:107], a[232:235], a[136:139], v[104:107]
v_mul_f32 v20, v16, v20
s_lshl_b32 s3, s44, 10
s_add_u32 m0, s3, 32768
v_mfma_f32_16x16x32_bf16 v[108:111], a[232:235], a[140:143], v[108:111]
v_add_f32 v176, 1.0, v176
s_waitcnt lgkmcnt(0)
v_mfma_f32_16x16x32_bf16 v[64:67], a[236:239], a[144:147], v[64:67]
buffer_load_dwordx4 v199, s[28:31], s70 offen offset:0 lds
s_add_u32 m0, s48, 98304
v_mfma_f32_16x16x32_bf16 v[68:71], a[236:239], a[148:151], v[68:71]
s_mov_b32 s70, 1572864
v_mul_f32 v21, v17, v21
v_mfma_f32_16x16x32_bf16 v[72:75], a[236:239], a[152:155], v[72:75]
v_add_f32 v177, 1.0, v177
v_mfma_f32_16x16x32_bf16 v[76:79], a[236:239], a[156:159], v[76:79]
buffer_load_dwordx4 v217, s[20:23], s71 offen offset:0 lds
v_mfma_f32_16x16x32_bf16 v[80:83], a[240:243], a[144:147], v[80:83]
v_mul_f32 v22, v18, v22
v_add_f32 v178, 1.0, v178
v_mfma_f32_16x16x32_bf16 v[84:87], a[240:243], a[148:151], v[84:87]
v_mul_f32 v23, v19, v23
v_mfma_f32_16x16x32_bf16 v[88:91], a[240:243], a[152:155], v[88:91]
v_add_f32 v179, 1.0, v179
buffer_load_dwordx4 v218, s[20:23], s71 offen offset:1024 lds
v_mfma_f32_16x16x32_bf16 v[92:95], a[240:243], a[156:159], v[92:95]
v_cvt_pk_bf16_f32 v188, v184, v185
v_mfma_f32_16x16x32_bf16 v[96:99], a[244:247], a[144:147], v[96:99]
v_cvt_pk_bf16_f32 v189, v186, v187
v_mfma_f32_16x16x32_bf16 v[100:103], a[244:247], a[148:151], v[100:103]
v_rcp_f32 v176, v176
v_mfma_f32_16x16x32_bf16 v[104:107], a[244:247], a[152:155], v[104:107]
buffer_load_dwordx4 v219, s[20:23], s71 offen offset:2048 lds
v_mfma_f32_16x16x32_bf16 v[108:111], a[244:247], a[156:159], v[108:111]
s_waitcnt vmcnt(6)
s_barrier
ds_read_b64_tr_b16 a[248:249], v196 offset:0
ds_read_b64_tr_b16 a[250:251], v196 offset:512
ds_read_b64_tr_b16 a[252:253], v197 offset:0
ds_read_b64_tr_b16 a[254:255], v197 offset:512
buffer_load_dwordx4 v220, s[20:23], s71 offen offset:3072 lds
s_add_u32 m0, s48, 114688
s_mov_b32 s71, 1835008
ds_read_b64_tr_b16 a[224:225], v198 offset:0
ds_read_b64_tr_b16 a[226:227], v198 offset:256
ds_read_b64_tr_b16 a[228:229], v196 offset:12288
ds_read_b64_tr_b16 a[230:231], v196 offset:12800
ds_read_b64_tr_b16 a[232:233], v197 offset:12288
ds_read_b64_tr_b16 a[234:235], v197 offset:12800
buffer_load_dwordx4 v217, s[20:23], s72 offen offset:0 lds
ds_read_b64_tr_b16 a[236:237], v198 offset:12288
ds_read_b64_tr_b16 a[238:239], v198 offset:12544
v_rcp_f32 v177, v177
v_rcp_f32 v178, v178
s_waitcnt lgkmcnt(10)
v_mfma_f32_16x16x32_bf16 v[64:67], a[248:251], a[160:163], v[64:67]
v_permlane32_swap_b32 v24, v28
v_mfma_f32_16x16x32_bf16 v[68:71], a[248:251], a[164:167], v[68:71]
buffer_load_dwordx4 v218, s[20:23], s72 offen offset:1024 lds
v_mfma_f32_16x16x32_bf16 v[72:75], a[248:251], a[168:171], v[72:75]
v_rcp_f32 v179, v179
v_mfma_f32_16x16x32_bf16 v[76:79], a[248:251], a[172:175], v[76:79]
v_permlane32_swap_b32 v25, v29
s_waitcnt lgkmcnt(4)
v_mfma_f32_16x16x32_bf16 v[80:83], a[252:255], a[160:163], v[80:83]
v_permlane32_swap_b32 v26, v30
buffer_load_dwordx4 v219, s[20:23], s72 offen offset:2048 lds
v_mfma_f32_16x16x32_bf16 v[84:87], a[252:255], a[164:167], v[84:87]
v_permlane32_swap_b32 v27, v31
v_mfma_f32_16x16x32_bf16 v[88:91], a[252:255], a[168:171], v[88:91]
v_mul_f32 v184, v24, v24
v_mfma_f32_16x16x32_bf16 v[92:95], a[252:255], a[172:175], v[92:95]
v_mul_f32 v185, v25, v25
v_mfma_f32_16x16x32_bf16 v[96:99], a[224:227], a[160:163], v[96:99]
buffer_load_dwordx4 v220, s[20:23], s72 offen offset:3072 lds
s_add_u32 m0, s47, 36864
v_mfma_f32_16x16x32_bf16 v[100:103], a[224:227], a[164:167], v[100:103]
s_mov_b32 s72, 2097152
v_mul_f32 v186, v26, v26
v_mfma_f32_16x16x32_bf16 v[104:107], a[224:227], a[168:171], v[104:107]
v_mul_f32 v187, v27, v27
v_mfma_f32_16x16x32_bf16 v[108:111], a[224:227], a[172:175], v[108:111]
buffer_load_dwordx4 v182, s[28:31], s73 offen offset:0 lds
v_mfma_f32_16x16x32_bf16 v[64:67], a[228:231], a[176:179], v[64:67]
v_fma_f32 v184, v184, s67, v203
v_fma_f32 v185, v185, s67, v203
v_mfma_f32_16x16x32_bf16 v[68:71], a[228:231], a[180:183], v[68:71]
v_fma_f32 v186, v186, s67, v203
v_mfma_f32_16x16x32_bf16 v[72:75], a[228:231], a[184:187], v[72:75]
v_fma_f32 v187, v187, s67, v203
buffer_load_dwordx4 v183, s[28:31], s73 offen offset:1024 lds
s_lshl_b32 s3, s44, 10
s_add_u32 m0, s3, 45056
v_mfma_f32_16x16x32_bf16 v[76:79], a[228:231], a[188:191], v[76:79]
v_mul_f32 v176, v20, v176
s_waitcnt lgkmcnt(0)
v_mfma_f32_16x16x32_bf16 v[80:83], a[232:235], a[176:179], v[80:83]
v_mul_f32 v177, v21, v177
v_mfma_f32_16x16x32_bf16 v[84:87], a[232:235], a[180:183], v[84:87]
v_mul_f32 v178, v22, v178
buffer_load_dwordx4 v199, s[28:31], s73 offen offset:0 lds
v_mfma_f32_16x16x32_bf16 v[88:91], a[232:235], a[184:187], v[88:91]
s_add_u32 m0, s48, 131072
s_mov_b32 s73, 2359296
v_mfma_f32_16x16x32_bf16 v[92:95], a[232:235], a[188:191], v[92:95]
s_waitcnt vmcnt(7)
ds_read_b64_tr_b16 a[232:233], v213 offset:0
v_mfma_f32_16x16x32_bf16 v[96:99], a[236:239], a[176:179], v[96:99]
ds_read_b64_tr_b16 a[234:235], v213 offset:512
v_mul_f32 v179, v23, v179
v_mfma_f32_16x16x32_bf16 v[100:103], a[236:239], a[180:183], v[100:103]
buffer_load_dwordx4 v217, s[20:23], s74 offen offset:0 lds
v_mfma_f32_16x16x32_bf16 v[104:107], a[236:239], a[184:187], v[104:107]
v_mul_f32 v184, v24, v184
v_mul_f32 v185, v25, v185
v_mfma_f32_16x16x32_bf16 v[108:111], a[236:239], a[188:191], v[108:111]
ds_read_b64_tr_b16 a[236:237], v214 offset:0
ds_read_b64_tr_b16 a[238:239], v214 offset:512
s_mul_i32 s3, s44, 12288
s_sub_u32 s3, s3, 90112
buffer_load_dwordx4 v218, s[20:23], s74 offen offset:1024 lds
v_add_u32 v199, s3, v216
v_mul_f32 v186, v26, v186
v_mul_f32 v187, v27, v187
v_exp_f32 v184, v184
v_exp_f32 v185, v185
v_exp_f32 v186, v186
v_exp_f32 v187, v187
ds_write_b64 v221, v[180:181] offset:0
v_mul_f32 v28, v24, v28
buffer_load_dwordx4 v219, s[20:23], s74 offen offset:2048 lds
v_add_f32 v184, 1.0, v184
v_mul_f32 v29, v25, v29
v_add_f32 v185, 1.0, v185
v_mul_f32 v30, v26, v30
v_add_f32 v186, 1.0, v186
v_mul_f32 v31, v27, v31
v_add_f32 v187, 1.0, v187
v_cvt_pk_bf16_f32 v180, v176, v177
v_cvt_pk_bf16_f32 v181, v178, v179
v_rcp_f32 v184, v184
v_rcp_f32 v185, v185
buffer_load_dwordx4 v220, s[20:23], s74 offen offset:3072 lds
s_add_u32 m0, s48, 147456
s_mov_b32 s74, 2621440
v_rcp_f32 v186, v186
v_rcp_f32 v187, v187
v_permlane32_swap_b32 v32, v36
v_permlane32_swap_b32 v33, v37
v_permlane32_swap_b32 v34, v38
v_permlane32_swap_b32 v35, v39
v_mul_f32 v176, v32, v32
v_mul_f32 v177, v33, v33
v_mul_f32 v178, v34, v34
buffer_load_dwordx4 v217, s[20:23], s75 offen offset:0 lds
v_mul_f32 v179, v35, v35
v_fma_f32 v176, v176, s67, v203
v_fma_f32 v177, v177, s67, v203
v_fma_f32 v178, v178, s67, v203
v_fma_f32 v179, v179, s67, v203
v_mul_f32 v184, v28, v184
v_mul_f32 v185, v29, v185
v_mul_f32 v186, v30, v186
v_mul_f32 v187, v31, v187
v_mul_f32 v176, v32, v176
v_mul_f32 v177, v33, v177
v_mul_f32 v178, v34, v178
v_mul_f32 v179, v35, v179
buffer_load_dwordx4 v218, s[20:23], s75 offen offset:1024 lds
v_exp_f32 v176, v176
v_exp_f32 v177, v177
v_exp_f32 v178, v178
v_exp_f32 v179, v179
ds_write_b64 v221, v[188:189] offset:2048
v_mul_f32 v36, v32, v36
v_add_f32 v176, 1.0, v176
v_mul_f32 v37, v33, v37
v_add_f32 v177, 1.0, v177
buffer_load_dwordx4 v219, s[20:23], s75 offen offset:2048 lds
v_mul_f32 v38, v34, v38
v_add_f32 v178, 1.0, v178
v_mul_f32 v39, v35, v39
v_add_f32 v179, 1.0, v179
s_waitcnt vmcnt(7)
s_barrier
ds_read_b64_tr_b16 a[240:241], v196 offset:24576
ds_read_b64_tr_b16 a[242:243], v196 offset:25088
ds_read_b64_tr_b16 a[244:245], v197 offset:24576
ds_read_b64_tr_b16 a[246:247], v197 offset:25088
buffer_load_dwordx4 v220, s[20:23], s75 offen offset:3072 lds
s_add_u32 m0, s69, 0
s_mov_b32 s75, 2883584
ds_read_b64_tr_b16 a[248:249], v198 offset:24576
ds_read_b64_tr_b16 a[250:251], v198 offset:24832
ds_read_b64_tr_b16 a[252:253], v196 offset:36864
buffer_load_dword v205, v193, s[12:15], 0 offen
ds_read_b64_tr_b16 a[254:255], v196 offset:37376
ds_read_b64_tr_b16 a[224:225], v197 offset:36864
ds_read_b64_tr_b16 a[226:227], v197 offset:37376
ds_read_b64_tr_b16 a[228:229], v198 offset:36864
buffer_load_dword v205, v193, s[16:19], 0 offen
v_mov_b32 v193, 0
ds_read_b64_tr_b16 a[230:231], v198 offset:37120
v_add_u32 v196, s3, v213
v_add_u32 v197, s3, v214
v_add_u32 v198, s3, v215
s_waitcnt lgkmcnt(10)
v_mfma_f32_16x16x32_bf16 v[64:67], a[240:243], a[192:195], v[64:67]
v_cvt_pk_bf16_f32 v188, v184, v185
v_mfma_f32_16x16x32_bf16 v[68:71], a[240:243], a[196:199], v[68:71]
v_cvt_pk_bf16_f32 v189, v186, v187
v_mfma_f32_16x16x32_bf16 v[72:75], a[240:243], a[200:203], v[72:75]
v_rcp_f32 v176, v176
v_mfma_f32_16x16x32_bf16 v[76:79], a[240:243], a[204:207], v[76:79]
ds_read_b64_tr_b16 a[240:241], v215 offset:0
s_waitcnt lgkmcnt(6)
v_mfma_f32_16x16x32_bf16 v[80:83], a[244:247], a[192:195], v[80:83]
ds_read_b64_tr_b16 a[242:243], v215 offset:512
v_permlane32_swap_b32 v40, v44
v_mfma_f32_16x16x32_bf16 v[84:87], a[244:247], a[196:199], v[84:87]
v_rcp_f32 v177, v177
v_mfma_f32_16x16x32_bf16 v[88:91], a[244:247], a[200:203], v[88:91]
s_waitcnt lgkmcnt(2)
s_barrier
v_mfma_f32_16x16x32_bf16 v[92:95], a[244:247], a[204:207], v[92:95]
buffer_load_dwordx4 v217, s[20:23], s76 offen offset:0 lds
v_mfma_f32_16x16x32_bf16 v[96:99], a[248:251], a[192:195], v[96:99]
ds_read_b64_tr_b16 a[244:245], v216 offset:0
v_permlane32_swap_b32 v41, v45
v_mfma_f32_16x16x32_bf16 v[100:103], a[248:251], a[196:199], v[100:103]
ds_read_b64_tr_b16 a[246:247], v216 offset:512
v_permlane32_swap_b32 v42, v46
v_mfma_f32_16x16x32_bf16 v[104:107], a[248:251], a[200:203], v[104:107]
v_rcp_f32 v178, v178
v_mfma_f32_16x16x32_bf16 v[108:111], a[248:251], a[204:207], v[108:111]
buffer_load_dwordx4 v218, s[20:23], s76 offen offset:1024 lds
v_mfma_f32_16x16x32_bf16 v[64:67], a[252:255], a[208:211], v[64:67]
ds_read_b64_tr_b16 a[248:249], v213 offset:16384
v_permlane32_swap_b32 v43, v47
v_mfma_f32_16x16x32_bf16 v[68:71], a[252:255], a[212:215], v[68:71]
ds_read_b64_tr_b16 a[250:251], v213 offset:16896
v_mul_f32 v184, v40, v40
v_mfma_f32_16x16x32_bf16 v[72:75], a[252:255], a[216:219], v[72:75]
v_rcp_f32 v179, v179
v_mfma_f32_16x16x32_bf16 v[76:79], a[252:255], a[220:223], v[76:79]
buffer_load_dwordx4 v219, s[20:23], s76 offen offset:2048 lds
v_mfma_f32_16x16x32_bf16 v[80:83], a[224:227], a[208:211], v[80:83]
ds_read_b64_tr_b16 a[252:253], v214 offset:16384
v_mul_f32 v185, v41, v41
v_mfma_f32_16x16x32_bf16 v[84:87], a[224:227], a[212:215], v[84:87]
ds_read_b64_tr_b16 a[254:255], v214 offset:16896
v_mul_f32 v186, v42, v42
v_mfma_f32_16x16x32_bf16 v[88:91], a[224:227], a[216:219], v[88:91]
v_mul_f32 v187, v43, v43
v_mfma_f32_16x16x32_bf16 v[92:95], a[224:227], a[220:223], v[92:95]
buffer_load_dwordx4 v220, s[20:23], s76 offen offset:3072 lds
v_mfma_f32_16x16x32_bf16 v[96:99], a[228:231], a[208:211], v[96:99]
s_add_u32 m0, s69, 4096
s_mov_b32 s76, 3145728
v_mfma_f32_16x16x32_bf16 v[100:103], a[228:231], a[212:215], v[100:103]
ds_read_b64_tr_b16 a[224:225], v215 offset:16384
v_fma_f32 v184, v184, s67, v203
v_mfma_f32_16x16x32_bf16 v[104:107], a[228:231], a[216:219], v[104:107]
ds_read_b64_tr_b16 a[226:227], v215 offset:16896
v_fma_f32 v185, v185, s67, v203
v_mfma_f32_16x16x32_bf16 v[108:111], a[228:231], a[220:223], v[108:111]
buffer_load_dwordx4 v217, s[20:23], s77 offen offset:0 lds
v_mfma_f32_16x16x32_bf16 v[112:115], a[232:235], a[0:3], 0
ds_read_b64_tr_b16 a[228:229], v216 offset:16384
v_fma_f32 v186, v186, s67, v203
v_mfma_f32_16x16x32_bf16 v[116:119], a[232:235], a[4:7], 0
ds_read_b64_tr_b16 a[230:231], v216 offset:16896
v_fma_f32 v187, v187, s67, v203
v_mfma_f32_16x16x32_bf16 v[120:123], a[232:235], a[8:11], 0
v_mul_f32 v176, v36, v176
v_mfma_f32_16x16x32_bf16 v[124:127], a[232:235], a[12:15], 0
buffer_load_dwordx4 v218, s[20:23], s77 offen offset:1024 lds
v_mfma_f32_16x16x32_bf16 v[128:131], a[236:239], a[0:3], 0
s_waitcnt vmcnt(12)
ds_read_b64_tr_b16 a[232:233], v213 offset:32768
v_mfma_f32_16x16x32_bf16 v[132:135], a[236:239], a[4:7], 0
ds_read_b64_tr_b16 a[234:235], v213 offset:33280
v_mul_f32 v177, v37, v177
v_mfma_f32_16x16x32_bf16 v[136:139], a[236:239], a[8:11], 0
v_mul_f32 v178, v38, v178
v_mfma_f32_16x16x32_bf16 v[140:143], a[236:239], a[12:15], 0
ds_read_b64_tr_b16 a[236:237], v214 offset:32768
s_waitcnt lgkmcnt(4)
v_mfma_f32_16x16x32_bf16 v[144:147], a[240:243], a[0:3], 0
buffer_load_dwordx4 v219, s[20:23], s77 offen offset:2048 lds
v_mfma_f32_16x16x32_bf16 v[148:151], a[240:243], a[4:7], 0
ds_read_b64_tr_b16 a[238:239], v214 offset:33280
v_mul_f32 v179, v39, v179
v_mfma_f32_16x16x32_bf16 v[152:155], a[240:243], a[8:11], 0
v_mul_f32 v184, v40, v184
v_mfma_f32_16x16x32_bf16 v[156:159], a[240:243], a[12:15], 0
ds_read_b64_tr_b16 a[240:241], v215 offset:32768
v_mul_f32 v185, v41, v185
v_mfma_f32_16x16x32_bf16 v[160:163], a[244:247], a[0:3], 0
buffer_load_dwordx4 v220, s[20:23], s77 offen offset:3072 lds
v_mfma_f32_16x16x32_bf16 v[164:167], a[244:247], a[4:7], 0
s_add_u32 m0, s48, 98304
s_mov_b32 s77, 3407872
v_mfma_f32_16x16x32_bf16 v[168:171], a[244:247], a[8:11], 0
ds_read_b64_tr_b16 a[242:243], v215 offset:33280
v_mul_f32 v186, v42, v186
v_mfma_f32_16x16x32_bf16 v[172:175], a[244:247], a[12:15], 0
ds_read_b64_tr_b16 a[244:245], v216 offset:32768
v_mul_f32 v187, v43, v187
v_mfma_f32_16x16x32_bf16 v[112:115], a[248:251], a[16:19], v[112:115]
buffer_load_dwordx4 v217, s[20:23], s70 offen offset:0 lds
v_mfma_f32_16x16x32_bf16 v[116:119], a[248:251], a[20:23], v[116:119]
ds_read_b64_tr_b16 a[246:247], v216 offset:33280
v_mul_f32 v44, v40, v44
v_mfma_f32_16x16x32_bf16 v[120:123], a[248:251], a[24:27], v[120:123]
v_exp_f32 v184, v184
v_mfma_f32_16x16x32_bf16 v[124:127], a[248:251], a[28:31], v[124:127]
s_waitcnt vmcnt(11)
ds_read_b64_tr_b16 a[248:249], v213 offset:49152
v_mfma_f32_16x16x32_bf16 v[128:131], a[252:255], a[16:19], v[128:131]
buffer_load_dwordx4 v218, s[20:23], s70 offen offset:1024 lds
v_mfma_f32_16x16x32_bf16 v[132:135], a[252:255], a[20:23], v[132:135]
ds_read_b64_tr_b16 a[250:251], v213 offset:49664
v_add_f32 v184, 1.0, v184
v_mfma_f32_16x16x32_bf16 v[136:139], a[252:255], a[24:27], v[136:139]
v_exp_f32 v185, v185
v_mfma_f32_16x16x32_bf16 v[140:143], a[252:255], a[28:31], v[140:143]
ds_read_b64_tr_b16 a[252:253], v214 offset:49152
v_mul_f32 v45, v41, v45
v_mfma_f32_16x16x32_bf16 v[144:147], a[224:227], a[16:19], v[144:147]
buffer_load_dwordx4 v219, s[20:23], s70 offen offset:2048 lds
v_mfma_f32_16x16x32_bf16 v[148:151], a[224:227], a[20:23], v[148:151]
ds_read_b64_tr_b16 a[254:255], v214 offset:49664
v_add_f32 v185, 1.0, v185
v_mfma_f32_16x16x32_bf16 v[152:155], a[224:227], a[24:27], v[152:155]
v_exp_f32 v186, v186
v_mfma_f32_16x16x32_bf16 v[156:159], a[224:227], a[28:31], v[156:159]
ds_read_b64_tr_b16 a[224:225], v215 offset:49152
s_waitcnt lgkmcnt(4)
v_mfma_f32_16x16x32_bf16 v[160:163], a[228:231], a[16:19], v[160:163]
buffer_load_dwordx4 v220, s[20:23], s70 offen offset:3072 lds
v_mfma_f32_16x16x32_bf16 v[164:167], a[228:231], a[20:23], v[164:167]
s_add_u32 m0, s48, 114688
s_mov_b32 s70, 128
v_mfma_f32_16x16x32_bf16 v[168:171], a[228:231], a[24:27], v[168:171]
ds_read_b64_tr_b16 a[226:227], v215 offset:49664
v_mul_f32 v46, v42, v46
v_mfma_f32_16x16x32_bf16 v[172:175], a[228:231], a[28:31], v[172:175]
ds_read_b64_tr_b16 a[228:229], v216 offset:49152
v_add_f32 v186, 1.0, v186
v_mfma_f32_16x16x32_bf16 v[112:115], a[232:235], a[32:35], v[112:115]
buffer_load_dwordx4 v217, s[20:23], s71 offen offset:0 lds
v_mfma_f32_16x16x32_bf16 v[116:119], a[232:235], a[36:39], v[116:119]
ds_read_b64_tr_b16 a[230:231], v216 offset:49664
v_mul_f32 v47, v43, v47
v_mfma_f32_16x16x32_bf16 v[120:123], a[232:235], a[40:43], v[120:123]
v_exp_f32 v187, v187
v_mfma_f32_16x16x32_bf16 v[124:127], a[232:235], a[44:47], v[124:127]
s_waitcnt vmcnt(9)
ds_read_b64_tr_b16 a[232:233], v196 offset:0
v_mfma_f32_16x16x32_bf16 v[128:131], a[236:239], a[32:35], v[128:131]
buffer_load_dwordx4 v218, s[20:23], s71 offen offset:1024 lds
v_mfma_f32_16x16x32_bf16 v[132:135], a[236:239], a[36:39], v[132:135]
ds_read_b64_tr_b16 a[234:235], v196 offset:512
v_add_f32 v187, 1.0, v187
v_mfma_f32_16x16x32_bf16 v[136:139], a[236:239], a[40:43], v[136:139]
ds_write_b64 v221, v[180:181] offset:4096
v_mfma_f32_16x16x32_bf16 v[140:143], a[236:239], a[44:47], v[140:143]
buffer_load_dwordx4 v219, s[20:23], s71 offen offset:2048 lds
v_mfma_f32_16x16x32_bf16 v[144:147], a[240:243], a[32:35], v[144:147]
ds_read_b64_tr_b16 a[236:237], v197 offset:0
v_cvt_pk_bf16_f32 v180, v176, v177
v_mfma_f32_16x16x32_bf16 v[148:151], a[240:243], a[36:39], v[148:151]
ds_read_b64_tr_b16 a[238:239], v197 offset:512
v_cvt_pk_bf16_f32 v181, v178, v179
v_mfma_f32_16x16x32_bf16 v[152:155], a[240:243], a[40:43], v[152:155]
v_rcp_f32 v184, v184
v_mfma_f32_16x16x32_bf16 v[156:159], a[240:243], a[44:47], v[156:159]
buffer_load_dwordx4 v220, s[20:23], s71 offen offset:3072 lds
v_mfma_f32_16x16x32_bf16 v[160:163], a[244:247], a[32:35], v[160:163]
s_add_u32 m0, s48, 131072
s_mov_b32 s71, 262272
v_mfma_f32_16x16x32_bf16 v[164:167], a[244:247], a[36:39], v[164:167]
ds_read_b64_tr_b16 a[240:241], v198 offset:0
v_permlane32_swap_b32 v48, v52
v_mfma_f32_16x16x32_bf16 v[168:171], a[244:247], a[40:43], v[168:171]
ds_read_b64_tr_b16 a[242:243], v198 offset:512
v_permlane32_swap_b32 v49, v53
v_mfma_f32_16x16x32_bf16 v[172:175], a[244:247], a[44:47], v[172:175]
ds_read_b64_tr_b16 a[244:245], v199 offset:0
s_waitcnt lgkmcnt(4)
v_mfma_f32_16x16x32_bf16 v[112:115], a[248:251], a[48:51], v[112:115]
buffer_load_dwordx4 v217, s[20:23], s72 offen offset:0 lds
v_mfma_f32_16x16x32_bf16 v[116:119], a[248:251], a[52:55], v[116:119]
ds_read_b64_tr_b16 a[246:247], v199 offset:512
v_permlane32_swap_b32 v50, v54
v_mfma_f32_16x16x32_bf16 v[120:123], a[248:251], a[56:59], v[120:123]
v_rcp_f32 v185, v185
v_mfma_f32_16x16x32_bf16 v[124:127], a[248:251], a[60:63], v[124:127]
s_waitcnt vmcnt(9)
ds_read_b64_tr_b16 a[248:249], v196 offset:4096
v_mfma_f32_16x16x32_bf16 v[128:131], a[252:255], a[48:51], v[128:131]
buffer_load_dwordx4 v218, s[20:23], s72 offen offset:1024 lds
v_mfma_f32_16x16x32_bf16 v[132:135], a[252:255], a[52:55], v[132:135]
ds_read_b64_tr_b16 a[250:251], v196 offset:4608
v_permlane32_swap_b32 v51, v55
v_mfma_f32_16x16x32_bf16 v[136:139], a[252:255], a[56:59], v[136:139]
v_rcp_f32 v186, v186
v_mfma_f32_16x16x32_bf16 v[140:143], a[252:255], a[60:63], v[140:143]
ds_read_b64_tr_b16 a[252:253], v197 offset:4096
v_mul_f32 v176, v48, v48
v_mfma_f32_16x16x32_bf16 v[144:147], a[224:227], a[48:51], v[144:147]
buffer_load_dwordx4 v219, s[20:23], s72 offen offset:2048 lds
v_mfma_f32_16x16x32_bf16 v[148:151], a[224:227], a[52:55], v[148:151]
ds_read_b64_tr_b16 a[254:255], v197 offset:4608
v_mul_f32 v177, v49, v49
v_mfma_f32_16x16x32_bf16 v[152:155], a[224:227], a[56:59], v[152:155]
v_rcp_f32 v187, v187
v_mfma_f32_16x16x32_bf16 v[156:159], a[224:227], a[60:63], v[156:159]
ds_read_b64_tr_b16 a[224:225], v198 offset:4096
v_mul_f32 v178, v50, v50
v_mfma_f32_16x16x32_bf16 v[160:163], a[228:231], a[48:51], v[160:163]
buffer_load_dwordx4 v220, s[20:23], s72 offen offset:3072 lds
v_mfma_f32_16x16x32_bf16 v[164:167], a[228:231], a[52:55], v[164:167]
s_add_u32 m0, s48, 147456
s_mov_b32 s72, 524416
v_mfma_f32_16x16x32_bf16 v[168:171], a[228:231], a[56:59], v[168:171]
ds_read_b64_tr_b16 a[226:227], v198 offset:4608
v_mul_f32 v179, v51, v51
v_mfma_f32_16x16x32_bf16 v[172:175], a[228:231], a[60:63], v[172:175]
ds_read_b64_tr_b16 a[228:229], v199 offset:4096
v_fma_f32 v176, v176, s67, v203
v_mfma_f32_16x16x32_bf16 v[112:115], a[232:235], a[64:67], v[112:115]
buffer_load_dwordx4 v217, s[20:23], s73 offen offset:0 lds
v_mfma_f32_16x16x32_bf16 v[116:119], a[232:235], a[68:71], v[116:119]
ds_read_b64_tr_b16 a[230:231], v199 offset:4608
v_fma_f32 v177, v177, s67, v203
v_mfma_f32_16x16x32_bf16 v[120:123], a[232:235], a[72:75], v[120:123]
v_fma_f32 v178, v178, s67, v203
v_mfma_f32_16x16x32_bf16 v[124:127], a[232:235], a[76:79], v[124:127]
s_waitcnt vmcnt(9)
ds_read_b64_tr_b16 a[232:233], v213 offset:0
s_waitcnt lgkmcnt(4)
v_mfma_f32_16x16x32_bf16 v[128:131], a[236:239], a[64:67], v[128:131]
buffer_load_dwordx4 v218, s[20:23], s73 offen offset:1024 lds
v_mfma_f32_16x16x32_bf16 v[132:135], a[236:239], a[68:71], v[132:135]
ds_read_b64_tr_b16 a[234:235], v213 offset:512
v_fma_f32 v179, v179, s67, v203
v_mfma_f32_16x16x32_bf16 v[136:139], a[236:239], a[72:75], v[136:139]
v_mul_f32 v184, v44, v184
v_mfma_f32_16x16x32_bf16 v[140:143], a[236:239], a[76:79], v[140:143]
ds_read_b64_tr_b16 a[236:237], v214 offset:0
v_mul_f32 v185, v45, v185
v_mfma_f32_16x16x32_bf16 v[144:147], a[240:243], a[64:67], v[144:147]
buffer_load_dwordx4 v219, s[20:23], s73 offen offset:2048 lds
v_mfma_f32_16x16x32_bf16 v[148:151], a[240:243], a[68:71], v[148:151]
ds_read_b64_tr_b16 a[238:239], v214 offset:512
v_mul_f32 v186, v46, v186
v_mfma_f32_16x16x32_bf16 v[152:155], a[240:243], a[72:75], v[152:155]
v_mul_f32 v187, v47, v187
v_mfma_f32_16x16x32_bf16 v[156:159], a[240:243], a[76:79], v[156:159]
ds_read_b64_tr_b16 a[240:241], v215 offset:0
v_mul_f32 v176, v48, v176
v_mfma_f32_16x16x32_bf16 v[160:163], a[244:247], a[64:67], v[160:163]
buffer_load_dwordx4 v220, s[20:23], s73 offen offset:3072 lds
v_mfma_f32_16x16x32_bf16 v[164:167], a[244:247], a[68:71], v[164:167]
s_add_u32 m0, s69, 0
s_mov_b32 s73, 786560
v_mfma_f32_16x16x32_bf16 v[168:171], a[244:247], a[72:75], v[168:171]
ds_read_b64_tr_b16 a[242:243], v215 offset:512
v_mul_f32 v177, v49, v177
v_mfma_f32_16x16x32_bf16 v[172:175], a[244:247], a[76:79], v[172:175]
ds_read_b64_tr_b16 a[244:245], v216 offset:0
v_mul_f32 v178, v50, v178
v_mfma_f32_16x16x32_bf16 v[112:115], a[248:251], a[80:83], v[112:115]
buffer_load_dwordx4 v217, s[20:23], s74 offen offset:0 lds
v_mfma_f32_16x16x32_bf16 v[116:119], a[248:251], a[84:87], v[116:119]
ds_read_b64_tr_b16 a[246:247], v216 offset:512
v_mul_f32 v179, v51, v179
v_mfma_f32_16x16x32_bf16 v[120:123], a[248:251], a[88:91], v[120:123]
v_exp_f32 v176, v176
v_mfma_f32_16x16x32_bf16 v[124:127], a[248:251], a[92:95], v[124:127]
s_waitcnt vmcnt(9)
ds_read_b64_tr_b16 a[248:249], v213 offset:16384
v_mfma_f32_16x16x32_bf16 v[128:131], a[252:255], a[80:83], v[128:131]
buffer_load_dwordx4 v218, s[20:23], s74 offen offset:1024 lds
v_mfma_f32_16x16x32_bf16 v[132:135], a[252:255], a[84:87], v[132:135]
ds_read_b64_tr_b16 a[250:251], v213 offset:16896
v_mul_f32 v52, v48, v52
v_mfma_f32_16x16x32_bf16 v[136:139], a[252:255], a[88:91], v[136:139]
v_exp_f32 v177, v177
v_mfma_f32_16x16x32_bf16 v[140:143], a[252:255], a[92:95], v[140:143]
ds_read_b64_tr_b16 a[252:253], v214 offset:16384
s_waitcnt lgkmcnt(4)
v_mfma_f32_16x16x32_bf16 v[144:147], a[224:227], a[80:83], v[144:147]
buffer_load_dwordx4 v219, s[20:23], s74 offen offset:2048 lds
v_mfma_f32_16x16x32_bf16 v[148:151], a[224:227], a[84:87], v[148:151]
ds_read_b64_tr_b16 a[254:255], v214 offset:16896
v_add_f32 v176, 1.0, v176
v_mfma_f32_16x16x32_bf16 v[152:155], a[224:227], a[88:91], v[152:155]
v_exp_f32 v178, v178
v_mfma_f32_16x16x32_bf16 v[156:159], a[224:227], a[92:95], v[156:159]
ds_read_b64_tr_b16 a[224:225], v215 offset:16384
v_mul_f32 v53, v49, v53
v_mfma_f32_16x16x32_bf16 v[160:163], a[228:231], a[80:83], v[160:163]
buffer_load_dwordx4 v220, s[20:23], s74 offen offset:3072 lds
v_mfma_f32_16x16x32_bf16 v[164:167], a[228:231], a[84:87], v[164:167]
s_add_u32 m0, s69, 4096
s_mov_b32 s74, 1048704
v_mfma_f32_16x16x32_bf16 v[168:171], a[228:231], a[88:91], v[168:171]
ds_read_b64_tr_b16 a[226:227], v215 offset:16896
v_add_f32 v177, 1.0, v177
v_mfma_f32_16x16x32_bf16 v[172:175], a[228:231], a[92:95], v[172:175]
ds_read_b64_tr_b16 a[228:229], v216 offset:16384
v_mul_f32 v54, v50, v54
v_mfma_f32_16x16x32_bf16 v[112:115], a[232:235], a[96:99], v[112:115]
buffer_load_dwordx4 v217, s[20:23], s75 offen offset:0 lds
v_mfma_f32_16x16x32_bf16 v[116:119], a[232:235], a[100:103], v[116:119]
ds_read_b64_tr_b16 a[230:231], v216 offset:16896
v_add_f32 v178, 1.0, v178
v_mfma_f32_16x16x32_bf16 v[120:123], a[232:235], a[104:107], v[120:123]
v_exp_f32 v179, v179
v_mfma_f32_16x16x32_bf16 v[124:127], a[232:235], a[108:111], v[124:127]
s_waitcnt vmcnt(9)
ds_read_b64_tr_b16 a[232:233], v213 offset:32768
v_mfma_f32_16x16x32_bf16 v[128:131], a[236:239], a[96:99], v[128:131]
buffer_load_dwordx4 v218, s[20:23], s75 offen offset:1024 lds
v_mfma_f32_16x16x32_bf16 v[132:135], a[236:239], a[100:103], v[132:135]
ds_read_b64_tr_b16 a[234:235], v213 offset:33280
v_mul_f32 v55, v51, v55
v_mfma_f32_16x16x32_bf16 v[136:139], a[236:239], a[104:107], v[136:139]
ds_write_b64 v221, v[188:189] offset:6144
v_mfma_f32_16x16x32_bf16 v[140:143], a[236:239], a[108:111], v[140:143]
buffer_load_dwordx4 v219, s[20:23], s75 offen offset:2048 lds
v_mfma_f32_16x16x32_bf16 v[144:147], a[240:243], a[96:99], v[144:147]
ds_read_b64_tr_b16 a[236:237], v214 offset:32768
v_add_f32 v179, 1.0, v179
v_mfma_f32_16x16x32_bf16 v[148:151], a[240:243], a[100:103], v[148:151]
ds_read_b64_tr_b16 a[238:239], v214 offset:33280
v_cvt_pk_bf16_f32 v188, v184, v185
v_mfma_f32_16x16x32_bf16 v[152:155], a[240:243], a[104:107], v[152:155]
v_cvt_pk_bf16_f32 v189, v186, v187
v_mfma_f32_16x16x32_bf16 v[156:159], a[240:243], a[108:111], v[156:159]
ds_read_b64_tr_b16 a[240:241], v215 offset:32768
s_waitcnt lgkmcnt(5)
v_mfma_f32_16x16x32_bf16 v[160:163], a[244:247], a[96:99], v[160:163]
buffer_load_dwordx4 v220, s[20:23], s75 offen offset:3072 lds
v_mfma_f32_16x16x32_bf16 v[164:167], a[244:247], a[100:103], v[164:167]
s_add_u32 m0, s48, 98304
s_mov_b32 s75, 1310848
v_mfma_f32_16x16x32_bf16 v[168:171], a[244:247], a[104:107], v[168:171]
ds_read_b64_tr_b16 a[242:243], v215 offset:33280
v_permlane32_swap_b32 v56, v60
v_mfma_f32_16x16x32_bf16 v[172:175], a[244:247], a[108:111], v[172:175]
ds_read_b64_tr_b16 a[244:245], v216 offset:32768
v_permlane32_swap_b32 v57, v61
v_mfma_f32_16x16x32_bf16 v[112:115], a[248:251], a[112:115], v[112:115]
buffer_load_dwordx4 v217, s[20:23], s76 offen offset:0 lds
v_mfma_f32_16x16x32_bf16 v[116:119], a[248:251], a[116:119], v[116:119]
ds_read_b64_tr_b16 a[246:247], v216 offset:33280
v_permlane32_swap_b32 v58, v62
v_mfma_f32_16x16x32_bf16 v[120:123], a[248:251], a[120:123], v[120:123]
v_rcp_f32 v176, v176
v_mfma_f32_16x16x32_bf16 v[124:127], a[248:251], a[124:127], v[124:127]
s_waitcnt vmcnt(9)
ds_read_b64_tr_b16 a[248:249], v213 offset:49152
v_mfma_f32_16x16x32_bf16 v[128:131], a[252:255], a[112:115], v[128:131]
buffer_load_dwordx4 v218, s[20:23], s76 offen offset:1024 lds
v_mfma_f32_16x16x32_bf16 v[132:135], a[252:255], a[116:119], v[132:135]
ds_read_b64_tr_b16 a[250:251], v213 offset:49664
v_permlane32_swap_b32 v59, v63
v_mfma_f32_16x16x32_bf16 v[136:139], a[252:255], a[120:123], v[136:139]
v_rcp_f32 v177, v177
v_mfma_f32_16x16x32_bf16 v[140:143], a[252:255], a[124:127], v[140:143]
ds_read_b64_tr_b16 a[252:253], v214 offset:49152
v_mul_f32 v184, v56, v56
v_mfma_f32_16x16x32_bf16 v[144:147], a[224:227], a[112:115], v[144:147]
buffer_load_dwordx4 v219, s[20:23], s76 offen offset:2048 lds
v_mfma_f32_16x16x32_bf16 v[148:151], a[224:227], a[116:119], v[148:151]
ds_read_b64_tr_b16 a[254:255], v214 offset:49664
v_mul_f32 v185, v57, v57
v_mfma_f32_16x16x32_bf16 v[152:155], a[224:227], a[120:123], v[152:155]
v_rcp_f32 v178, v178
v_mfma_f32_16x16x32_bf16 v[156:159], a[224:227], a[124:127], v[156:159]
ds_read_b64_tr_b16 a[224:225], v215 offset:49152
v_mul_f32 v186, v58, v58
v_mfma_f32_16x16x32_bf16 v[160:163], a[228:231], a[112:115], v[160:163]
buffer_load_dwordx4 v220, s[20:23], s76 offen offset:3072 lds
v_mfma_f32_16x16x32_bf16 v[164:167], a[228:231], a[116:119], v[164:167]
s_add_u32 m0, s48, 114688
s_mov_b32 s76, 1572992
v_mfma_f32_16x16x32_bf16 v[168:171], a[228:231], a[120:123], v[168:171]
ds_read_b64_tr_b16 a[226:227], v215 offset:49664
v_mul_f32 v187, v59, v59
v_mfma_f32_16x16x32_bf16 v[172:175], a[228:231], a[124:127], v[172:175]
ds_read_b64_tr_b16 a[228:229], v216 offset:49152
s_waitcnt lgkmcnt(4)
v_mfma_f32_16x16x32_bf16 v[112:115], a[232:235], a[128:131], v[112:115]
buffer_load_dwordx4 v217, s[20:23], s77 offen offset:0 lds
v_mfma_f32_16x16x32_bf16 v[116:119], a[232:235], a[132:135], v[116:119]
ds_read_b64_tr_b16 a[230:231], v216 offset:49664
v_fma_f32 v184, v184, s67, v203
v_mfma_f32_16x16x32_bf16 v[120:123], a[232:235], a[136:139], v[120:123]
v_rcp_f32 v179, v179
v_mfma_f32_16x16x32_bf16 v[124:127], a[232:235], a[140:143], v[124:127]
s_waitcnt vmcnt(9)
ds_read_b64_tr_b16 a[232:233], v196 offset:0
v_mfma_f32_16x16x32_bf16 v[128:131], a[236:239], a[128:131], v[128:131]
buffer_load_dwordx4 v218, s[20:23], s77 offen offset:1024 lds
v_mfma_f32_16x16x32_bf16 v[132:135], a[236:239], a[132:135], v[132:135]
ds_read_b64_tr_b16 a[234:235], v196 offset:512
v_fma_f32 v185, v185, s67, v203
v_mfma_f32_16x16x32_bf16 v[136:139], a[236:239], a[136:139], v[136:139]
v_fma_f32 v186, v186, s67, v203
v_mfma_f32_16x16x32_bf16 v[140:143], a[236:239], a[140:143], v[140:143]
ds_read_b64_tr_b16 a[236:237], v197 offset:0
v_fma_f32 v187, v187, s67, v203
v_mfma_f32_16x16x32_bf16 v[144:147], a[240:243], a[128:131], v[144:147]
buffer_load_dwordx4 v219, s[20:23], s77 offen offset:2048 lds
v_mfma_f32_16x16x32_bf16 v[148:151], a[240:243], a[132:135], v[148:151]
ds_read_b64_tr_b16 a[238:239], v197 offset:512
v_mul_f32 v176, v52, v176
v_mfma_f32_16x16x32_bf16 v[152:155], a[240:243], a[136:139], v[152:155]
v_mul_f32 v177, v53, v177
v_mfma_f32_16x16x32_bf16 v[156:159], a[240:243], a[140:143], v[156:159]
ds_read_b64_tr_b16 a[240:241], v198 offset:0
v_mul_f32 v178, v54, v178
v_mfma_f32_16x16x32_bf16 v[160:163], a[244:247], a[128:131], v[160:163]
buffer_load_dwordx4 v220, s[20:23], s77 offen offset:3072 lds
v_mfma_f32_16x16x32_bf16 v[164:167], a[244:247], a[132:135], v[164:167]
s_add_u32 m0, s48, 131072
s_mov_b32 s77, 1835136
v_mfma_f32_16x16x32_bf16 v[168:171], a[244:247], a[136:139], v[168:171]
ds_read_b64_tr_b16 a[242:243], v198 offset:512
v_mul_f32 v179, v55, v179
v_mfma_f32_16x16x32_bf16 v[172:175], a[244:247], a[140:143], v[172:175]
ds_read_b64_tr_b16 a[244:245], v199 offset:0
v_mul_f32 v184, v56, v184
v_mfma_f32_16x16x32_bf16 v[112:115], a[248:251], a[144:147], v[112:115]
buffer_load_dwordx4 v217, s[20:23], s70 offen offset:0 lds
v_mfma_f32_16x16x32_bf16 v[116:119], a[248:251], a[148:151], v[116:119]
ds_read_b64_tr_b16 a[246:247], v199 offset:512
v_mul_f32 v185, v57, v185
v_mfma_f32_16x16x32_bf16 v[120:123], a[248:251], a[152:155], v[120:123]
v_mul_f32 v186, v58, v186
v_mfma_f32_16x16x32_bf16 v[124:127], a[248:251], a[156:159], v[124:127]
s_waitcnt vmcnt(9)
ds_read_b64_tr_b16 a[248:249], v196 offset:4096
s_waitcnt lgkmcnt(4)
v_mfma_f32_16x16x32_bf16 v[128:131], a[252:255], a[144:147], v[128:131]
buffer_load_dwordx4 v218, s[20:23], s70 offen offset:1024 lds
v_mfma_f32_16x16x32_bf16 v[132:135], a[252:255], a[148:151], v[132:135]
ds_read_b64_tr_b16 a[250:251], v196 offset:4608
v_mul_f32 v187, v59, v187
v_mfma_f32_16x16x32_bf16 v[136:139], a[252:255], a[152:155], v[136:139]
v_exp_f32 v184, v184
v_mfma_f32_16x16x32_bf16 v[140:143], a[252:255], a[156:159], v[140:143]
ds_read_b64_tr_b16 a[252:253], v197 offset:4096
v_mul_f32 v60, v56, v60
v_mfma_f32_16x16x32_bf16 v[144:147], a[224:227], a[144:147], v[144:147]
buffer_load_dwordx4 v219, s[20:23], s70 offen offset:2048 lds
v_mfma_f32_16x16x32_bf16 v[148:151], a[224:227], a[148:151], v[148:151]
ds_read_b64_tr_b16 a[254:255], v197 offset:4608
v_add_f32 v184, 1.0, v184
v_mfma_f32_16x16x32_bf16 v[152:155], a[224:227], a[152:155], v[152:155]
v_exp_f32 v185, v185
v_mfma_f32_16x16x32_bf16 v[156:159], a[224:227], a[156:159], v[156:159]
ds_read_b64_tr_b16 a[224:225], v198 offset:4096
v_mul_f32 v61, v57, v61
v_mfma_f32_16x16x32_bf16 v[160:163], a[228:231], a[144:147], v[160:163]
buffer_load_dwordx4 v220, s[20:23], s70 offen offset:3072 lds
v_mfma_f32_16x16x32_bf16 v[164:167], a[228:231], a[148:151], v[164:167]
s_add_u32 m0, s48, 147456
s_mov_b32 s70, 2097280
v_mfma_f32_16x16x32_bf16 v[168:171], a[228:231], a[152:155], v[168:171]
ds_read_b64_tr_b16 a[226:227], v198 offset:4608
v_add_f32 v185, 1.0, v185
v_mfma_f32_16x16x32_bf16 v[172:175], a[228:231], a[156:159], v[172:175]
ds_read_b64_tr_b16 a[228:229], v199 offset:4096
v_mul_f32 v62, v58, v62
v_mfma_f32_16x16x32_bf16 v[112:115], a[232:235], a[160:163], v[112:115]
buffer_load_dwordx4 v217, s[20:23], s71 offen offset:0 lds
v_mfma_f32_16x16x32_bf16 v[116:119], a[232:235], a[164:167], v[116:119]
ds_read_b64_tr_b16 a[230:231], v199 offset:4608
v_mul_f32 v63, v59, v63
v_mfma_f32_16x16x32_bf16 v[120:123], a[232:235], a[168:171], v[120:123]
v_exp_f32 v186, v186
v_mfma_f32_16x16x32_bf16 v[124:127], a[232:235], a[172:175], v[124:127]
s_waitcnt vmcnt(9)
ds_read_b64_tr_b16 a[232:233], v213 offset:0
v_mfma_f32_16x16x32_bf16 v[128:131], a[236:239], a[160:163], v[128:131]
buffer_load_dwordx4 v218, s[20:23], s71 offen offset:1024 lds
v_mfma_f32_16x16x32_bf16 v[132:135], a[236:239], a[164:167], v[132:135]
ds_read_b64_tr_b16 a[234:235], v213 offset:512
v_add_f32 v186, 1.0, v186
v_mfma_f32_16x16x32_bf16 v[136:139], a[236:239], a[168:171], v[136:139]
v_exp_f32 v187, v187
v_mfma_f32_16x16x32_bf16 v[140:143], a[236:239], a[172:175], v[140:143]
ds_read_b64_tr_b16 a[236:237], v214 offset:0
s_waitcnt lgkmcnt(4)
v_mfma_f32_16x16x32_bf16 v[144:147], a[240:243], a[160:163], v[144:147]
buffer_load_dwordx4 v219, s[20:23], s71 offen offset:2048 lds
v_mfma_f32_16x16x32_bf16 v[148:151], a[240:243], a[164:167], v[148:151]
ds_read_b64_tr_b16 a[238:239], v214 offset:512
v_add_f32 v187, 1.0, v187
v_mfma_f32_16x16x32_bf16 v[152:155], a[240:243], a[168:171], v[152:155]
v_rcp_f32 v184, v184
v_mfma_f32_16x16x32_bf16 v[156:159], a[240:243], a[172:175], v[156:159]
ds_read_b64_tr_b16 a[240:241], v215 offset:0
v_mul_f32 v184, v60, v184
v_mfma_f32_16x16x32_bf16 v[160:163], a[244:247], a[160:163], v[160:163]
buffer_load_dwordx4 v220, s[20:23], s71 offen offset:3072 lds
v_mfma_f32_16x16x32_bf16 v[164:167], a[244:247], a[164:167], v[164:167]
s_add_u32 m0, s69, 0
s_mov_b32 s71, 2359424
v_mfma_f32_16x16x32_bf16 v[168:171], a[244:247], a[168:171], v[168:171]
ds_read_b64_tr_b16 a[242:243], v215 offset:512
v_permlane32_swap_b32 v64, v68
v_mfma_f32_16x16x32_bf16 v[172:175], a[244:247], a[172:175], v[172:175]
ds_read_b64_tr_b16 a[244:245], v216 offset:0
v_permlane32_swap_b32 v65, v69
v_mfma_f32_16x16x32_bf16 v[112:115], a[248:251], a[176:179], v[112:115]
buffer_load_dwordx4 v217, s[20:23], s72 offen offset:0 lds
v_mfma_f32_16x16x32_bf16 v[116:119], a[248:251], a[180:183], v[116:119]
ds_read_b64_tr_b16 a[246:247], v216 offset:512
v_permlane32_swap_b32 v66, v70
v_mfma_f32_16x16x32_bf16 v[120:123], a[248:251], a[184:187], v[120:123]
v_rcp_f32 v185, v185
v_mfma_f32_16x16x32_bf16 v[124:127], a[248:251], a[188:191], v[124:127]
s_waitcnt vmcnt(9)
ds_read_b64_tr_b16 a[248:249], v213 offset:16384
v_mfma_f32_16x16x32_bf16 v[128:131], a[252:255], a[176:179], v[128:131]
buffer_load_dwordx4 v218, s[20:23], s72 offen offset:1024 lds
v_mfma_f32_16x16x32_bf16 v[132:135], a[252:255], a[180:183], v[132:135]
ds_read_b64_tr_b16 a[250:251], v213 offset:16896
v_mul_f32 v185, v61, v185
v_mfma_f32_16x16x32_bf16 v[136:139], a[252:255], a[184:187], v[136:139]
v_rcp_f32 v186, v186
v_mfma_f32_16x16x32_bf16 v[140:143], a[252:255], a[188:191], v[140:143]
ds_read_b64_tr_b16 a[252:253], v214 offset:16384
v_mul_f32 v186, v62, v186
v_mfma_f32_16x16x32_bf16 v[144:147], a[224:227], a[176:179], v[144:147]
buffer_load_dwordx4 v219, s[20:23], s72 offen offset:2048 lds
v_mfma_f32_16x16x32_bf16 v[148:151], a[224:227], a[180:183], v[148:151]
ds_read_b64_tr_b16 a[254:255], v214 offset:16896
v_permlane32_swap_b32 v67, v71
v_mfma_f32_16x16x32_bf16 v[152:155], a[224:227], a[184:187], v[152:155]
v_rcp_f32 v187, v187
v_mfma_f32_16x16x32_bf16 v[156:159], a[224:227], a[188:191], v[156:159]
ds_read_b64_tr_b16 a[224:225], v215 offset:16384
s_waitcnt lgkmcnt(4)
v_mfma_f32_16x16x32_bf16 v[160:163], a[228:231], a[176:179], v[160:163]
buffer_load_dwordx4 v220, s[20:23], s72 offen offset:3072 lds
v_mfma_f32_16x16x32_bf16 v[164:167], a[228:231], a[180:183], v[164:167]
s_add_u32 m0, s69, 4096
s_mov_b32 s72, 2621568
v_mfma_f32_16x16x32_bf16 v[168:171], a[228:231], a[184:187], v[168:171]
s_mov_b64 exec, 3
global_load_dword v205, v194, s[94:95]
s_mov_b64 exec, -1
v_mfma_f32_16x16x32_bf16 v[172:175], a[228:231], a[188:191], v[172:175]
ds_read_b64_tr_b16 a[226:227], v215 offset:16896
v_mul_f32 v187, v63, v187
v_mfma_f32_16x16x32_bf16 v[112:115], a[232:235], a[192:195], v[112:115]
ds_read_b64_tr_b16 a[228:229], v216 offset:16384
v_permlane32_swap_b32 v72, v76
v_mfma_f32_16x16x32_bf16 v[116:119], a[232:235], a[196:199], v[116:119]
ds_read_b64_tr_b16 a[230:231], v216 offset:16896
v_permlane32_swap_b32 v73, v77
v_mfma_f32_16x16x32_bf16 v[120:123], a[232:235], a[200:203], v[120:123]
buffer_load_dwordx4 v217, s[20:23], s73 offen offset:0 lds
v_mfma_f32_16x16x32_bf16 v[124:127], a[232:235], a[204:207], v[124:127]
s_waitcnt vmcnt(10)
ds_read_b64_tr_b16 a[232:233], v213 offset:32768
v_mfma_f32_16x16x32_bf16 v[128:131], a[236:239], a[192:195], v[128:131]
ds_read_b64_tr_b16 a[234:235], v213 offset:33280
v_permlane32_swap_b32 v74, v78
v_mfma_f32_16x16x32_bf16 v[132:135], a[236:239], a[196:199], v[132:135]
ds_write_b64 v221, v[180:181] offset:8192
v_mfma_f32_16x16x32_bf16 v[136:139], a[236:239], a[200:203], v[136:139]
buffer_load_dwordx4 v218, s[20:23], s73 offen offset:1024 lds
v_mfma_f32_16x16x32_bf16 v[140:143], a[236:239], a[204:207], v[140:143]
ds_read_b64_tr_b16 a[236:237], v214 offset:32768
v_cvt_pk_bf16_f32 v180, v176, v177
v_mfma_f32_16x16x32_bf16 v[144:147], a[240:243], a[192:195], v[144:147]
ds_read_b64_tr_b16 a[238:239], v214 offset:33280
v_cvt_pk_bf16_f32 v181, v178, v179
v_mfma_f32_16x16x32_bf16 v[148:151], a[240:243], a[196:199], v[148:151]
ds_write_b64 v221, v[188:189] offset:10240
v_mfma_f32_16x16x32_bf16 v[152:155], a[240:243], a[200:203], v[152:155]
buffer_load_dwordx4 v219, s[20:23], s73 offen offset:2048 lds
v_mfma_f32_16x16x32_bf16 v[156:159], a[240:243], a[204:207], v[156:159]
ds_read_b64_tr_b16 a[240:241], v215 offset:32768
v_cvt_pk_bf16_f32 v188, v184, v185
v_mfma_f32_16x16x32_bf16 v[160:163], a[244:247], a[192:195], v[160:163]
ds_read_b64_tr_b16 a[242:243], v215 offset:33280
v_cvt_pk_bf16_f32 v189, v186, v187
v_mfma_f32_16x16x32_bf16 v[164:167], a[244:247], a[196:199], v[164:167]
v_permlane32_swap_b32 v75, v79
v_mfma_f32_16x16x32_bf16 v[168:171], a[244:247], a[200:203], v[168:171]
buffer_load_dwordx4 v220, s[20:23], s73 offen offset:3072 lds
v_mfma_f32_16x16x32_bf16 v[172:175], a[244:247], a[204:207], v[172:175]
s_add_u32 m0, s48, 98304
s_waitcnt lgkmcnt(2)
v_mfma_f32_16x16x32_bf16 v[112:115], a[248:251], a[208:211], v[112:115]
s_mov_b32 s73, 2883712
ds_read_b64_tr_b16 a[244:245], v216 offset:32768
v_mfma_f32_16x16x32_bf16 v[116:119], a[248:251], a[212:215], v[116:119]
ds_read_b64_tr_b16 a[246:247], v216 offset:33280
v_mul_f32 v176, v64, v64
v_mfma_f32_16x16x32_bf16 v[120:123], a[248:251], a[216:219], v[120:123]
buffer_load_dwordx4 v217, s[20:23], s74 offen offset:0 lds
v_mfma_f32_16x16x32_bf16 v[124:127], a[248:251], a[220:223], v[124:127]
s_waitcnt vmcnt(10)
ds_read_b64_tr_b16 a[248:249], v213 offset:49152
v_mfma_f32_16x16x32_bf16 v[128:131], a[252:255], a[208:211], v[128:131]
ds_read_b64_tr_b16 a[250:251], v213 offset:49664
v_mul_f32 v177, v65, v65
v_mfma_f32_16x16x32_bf16 v[132:135], a[252:255], a[212:215], v[132:135]
v_mul_f32 v178, v66, v66
v_mfma_f32_16x16x32_bf16 v[136:139], a[252:255], a[216:219], v[136:139]
buffer_load_dwordx4 v218, s[20:23], s74 offen offset:1024 lds
v_mfma_f32_16x16x32_bf16 v[140:143], a[252:255], a[220:223], v[140:143]
ds_read_b64_tr_b16 a[252:253], v214 offset:49152
v_mul_f32 v179, v67, v67
v_mfma_f32_16x16x32_bf16 v[144:147], a[224:227], a[208:211], v[144:147]
ds_read_b64_tr_b16 a[254:255], v214 offset:49664
v_mul_f32 v184, v72, v72
v_mfma_f32_16x16x32_bf16 v[148:151], a[224:227], a[212:215], v[148:151]
v_mul_f32 v185, v73, v73
v_mfma_f32_16x16x32_bf16 v[152:155], a[224:227], a[216:219], v[152:155]
buffer_load_dwordx4 v219, s[20:23], s74 offen offset:2048 lds
v_mfma_f32_16x16x32_bf16 v[156:159], a[224:227], a[220:223], v[156:159]
ds_read_b64_tr_b16 a[224:225], v215 offset:49152
v_mul_f32 v186, v74, v74
v_mfma_f32_16x16x32_bf16 v[160:163], a[228:231], a[208:211], v[160:163]
ds_read_b64_tr_b16 a[226:227], v215 offset:49664
v_mul_f32 v187, v75, v75
v_mfma_f32_16x16x32_bf16 v[164:167], a[228:231], a[212:215], v[164:167]
v_fma_f32 v176, v176, s67, v203
v_mfma_f32_16x16x32_bf16 v[168:171], a[228:231], a[216:219], v[168:171]
buffer_load_dwordx4 v220, s[20:23], s74 offen offset:3072 lds
v_mfma_f32_16x16x32_bf16 v[172:175], a[228:231], a[220:223], v[172:175]
s_add_u32 m0, s48, 114688
s_mov_b32 s74, 3145856
v_mfma_f32_16x16x32_bf16 v[0:3], a[232:235], a[0:3], 0
ds_read_b64_tr_b16 a[228:229], v216 offset:49152
v_fma_f32 v177, v177, s67, v203
v_mfma_f32_16x16x32_bf16 v[4:7], a[232:235], a[4:7], 0
ds_read_b64_tr_b16 a[230:231], v216 offset:49664
v_fma_f32 v178, v178, s67, v203
v_mfma_f32_16x16x32_bf16 v[8:11], a[232:235], a[8:11], 0
buffer_load_dwordx4 v217, s[20:23], s75 offen offset:0 lds
v_mfma_f32_16x16x32_bf16 v[12:15], a[232:235], a[12:15], 0
s_waitcnt vmcnt(10)
ds_read_b64_tr_b16 a[232:233], v196 offset:0
v_mfma_f32_16x16x32_bf16 v[16:19], a[236:239], a[0:3], 0
ds_read_b64_tr_b16 a[234:235], v196 offset:512
v_fma_f32 v179, v179, s67, v203
v_mfma_f32_16x16x32_bf16 v[20:23], a[236:239], a[4:7], 0
v_fma_f32 v184, v184, s67, v203
v_mfma_f32_16x16x32_bf16 v[24:27], a[236:239], a[8:11], 0
buffer_load_dwordx4 v218, s[20:23], s75 offen offset:1024 lds
v_mfma_f32_16x16x32_bf16 v[28:31], a[236:239], a[12:15], 0
ds_read_b64_tr_b16 a[236:237], v197 offset:0
s_waitcnt lgkmcnt(4)
v_mfma_f32_16x16x32_bf16 v[32:35], a[240:243], a[0:3], 0
ds_read_b64_tr_b16 a[238:239], v197 offset:512
v_fma_f32 v185, v185, s67, v203
v_mfma_f32_16x16x32_bf16 v[36:39], a[240:243], a[4:7], 0
v_fma_f32 v186, v186, s67, v203
v_mfma_f32_16x16x32_bf16 v[40:43], a[240:243], a[8:11], 0
buffer_load_dwordx4 v219, s[20:23], s75 offen offset:2048 lds
v_mfma_f32_16x16x32_bf16 v[44:47], a[240:243], a[12:15], 0
ds_read_b64_tr_b16 a[240:241], v198 offset:0
v_fma_f32 v187, v187, s67, v203
v_mfma_f32_16x16x32_bf16 v[48:51], a[244:247], a[0:3], 0
ds_read_b64_tr_b16 a[242:243], v198 offset:512
v_mul_f32 v176, v64, v176
v_mfma_f32_16x16x32_bf16 v[52:55], a[244:247], a[4:7], 0
v_mul_f32 v177, v65, v177
v_mfma_f32_16x16x32_bf16 v[56:59], a[244:247], a[8:11], 0
buffer_load_dwordx4 v220, s[20:23], s75 offen offset:3072 lds
v_mfma_f32_16x16x32_bf16 v[60:63], a[244:247], a[12:15], 0
s_add_u32 m0, s48, 131072
s_mov_b32 s75, 3408000
v_mfma_f32_16x16x32_bf16 v[0:3], a[248:251], a[16:19], v[0:3]
ds_read_b64_tr_b16 a[244:245], v199 offset:0
v_mul_f32 v178, v66, v178
v_mfma_f32_16x16x32_bf16 v[4:7], a[248:251], a[20:23], v[4:7]
ds_read_b64_tr_b16 a[246:247], v199 offset:512
v_mul_f32 v179, v67, v179
v_mfma_f32_16x16x32_bf16 v[8:11], a[248:251], a[24:27], v[8:11]
buffer_load_dwordx4 v217, s[20:23], s76 offen offset:0 lds
v_mfma_f32_16x16x32_bf16 v[12:15], a[248:251], a[28:31], v[12:15]
s_waitcnt vmcnt(9)
ds_read_b64_tr_b16 a[248:249], v196 offset:4096
v_mfma_f32_16x16x32_bf16 v[16:19], a[252:255], a[16:19], v[16:19]
ds_read_b64_tr_b16 a[250:251], v196 offset:4608
v_mul_f32 v184, v72, v184
v_mfma_f32_16x16x32_bf16 v[20:23], a[252:255], a[20:23], v[20:23]
v_mul_f32 v185, v73, v185
v_mfma_f32_16x16x32_bf16 v[24:27], a[252:255], a[24:27], v[24:27]
buffer_load_dwordx4 v218, s[20:23], s76 offen offset:1024 lds
v_mfma_f32_16x16x32_bf16 v[28:31], a[252:255], a[28:31], v[28:31]
ds_read_b64_tr_b16 a[252:253], v197 offset:4096
v_mul_f32 v186, v74, v186
v_mfma_f32_16x16x32_bf16 v[32:35], a[224:227], a[16:19], v[32:35]
ds_read_b64_tr_b16 a[254:255], v197 offset:4608
v_mul_f32 v187, v75, v187
v_mfma_f32_16x16x32_bf16 v[36:39], a[224:227], a[20:23], v[36:39]
v_exp_f32 v176, v176
v_mfma_f32_16x16x32_bf16 v[40:43], a[224:227], a[24:27], v[40:43]
buffer_load_dwordx4 v219, s[20:23], s76 offen offset:2048 lds
v_mfma_f32_16x16x32_bf16 v[44:47], a[224:227], a[28:31], v[44:47]
ds_read_b64_tr_b16 a[224:225], v198 offset:4096
s_waitcnt lgkmcnt(3)
v_mfma_f32_16x16x32_bf16 v[48:51], a[228:231], a[16:19], v[48:51]
ds_read_b64_tr_b16 a[226:227], v198 offset:4608
v_add_f32 v176, 1.0, v176
v_mfma_f32_16x16x32_bf16 v[52:55], a[228:231], a[20:23], v[52:55]
v_exp_f32 v177, v177
v_mfma_f32_16x16x32_bf16 v[56:59], a[228:231], a[24:27], v[56:59]
buffer_load_dwordx4 v220, s[20:23], s76 offen offset:3072 lds
v_mfma_f32_16x16x32_bf16 v[60:63], a[228:231], a[28:31], v[60:63]
s_add_u32 m0, s48, 147456
s_mov_b32 s76, 16384
v_mfma_f32_16x16x32_bf16 v[0:3], a[232:235], a[32:35], v[0:3]
ds_read_b64_tr_b16 a[228:229], v199 offset:4096
v_add_f32 v177, 1.0, v177
v_mfma_f32_16x16x32_bf16 v[4:7], a[232:235], a[36:39], v[4:7]
ds_read_b64_tr_b16 a[230:231], v199 offset:4608
v_mul_f32 v68, v64, v68
v_mfma_f32_16x16x32_bf16 v[8:11], a[232:235], a[40:43], v[8:11]
buffer_load_dwordx4 v217, s[20:23], s77 offen offset:0 lds
v_mfma_f32_16x16x32_bf16 v[12:15], a[232:235], a[44:47], v[12:15]
s_waitcnt vmcnt(9)
ds_read_b64_tr_b16 a[232:233], v213 offset:0
v_mfma_f32_16x16x32_bf16 v[16:19], a[236:239], a[32:35], v[16:19]
ds_read_b64_tr_b16 a[234:235], v213 offset:512
v_mul_f32 v69, v65, v69
v_mfma_f32_16x16x32_bf16 v[20:23], a[236:239], a[36:39], v[20:23]
v_exp_f32 v178, v178
v_mfma_f32_16x16x32_bf16 v[24:27], a[236:239], a[40:43], v[24:27]
buffer_load_dwordx4 v218, s[20:23], s77 offen offset:1024 lds
v_mfma_f32_16x16x32_bf16 v[28:31], a[236:239], a[44:47], v[28:31]
ds_read_b64_tr_b16 a[236:237], v214 offset:0
v_add_f32 v178, 1.0, v178
v_mfma_f32_16x16x32_bf16 v[32:35], a[240:243], a[32:35], v[32:35]
ds_read_b64_tr_b16 a[238:239], v214 offset:512
v_mul_f32 v70, v66, v70
v_mfma_f32_16x16x32_bf16 v[36:39], a[240:243], a[36:39], v[36:39]
v_exp_f32 v179, v179
v_mfma_f32_16x16x32_bf16 v[40:43], a[240:243], a[40:43], v[40:43]
buffer_load_dwordx4 v219, s[20:23], s77 offen offset:2048 lds
v_mfma_f32_16x16x32_bf16 v[44:47], a[240:243], a[44:47], v[44:47]
ds_read_b64_tr_b16 a[240:241], v215 offset:0
v_add_f32 v179, 1.0, v179
v_mfma_f32_16x16x32_bf16 v[48:51], a[244:247], a[32:35], v[48:51]
ds_read_b64_tr_b16 a[242:243], v215 offset:512
v_mul_f32 v71, v67, v71
v_mfma_f32_16x16x32_bf16 v[52:55], a[244:247], a[36:39], v[52:55]
v_exp_f32 v184, v184
v_mfma_f32_16x16x32_bf16 v[56:59], a[244:247], a[40:43], v[56:59]
buffer_load_dwordx4 v220, s[20:23], s77 offen offset:3072 lds
v_mfma_f32_16x16x32_bf16 v[60:63], a[244:247], a[44:47], v[60:63]
s_add_u32 m0, s69, 0
s_mov_b32 s77, 32768
v_mfma_f32_16x16x32_bf16 v[0:3], a[248:251], a[48:51], v[0:3]
ds_read_b64_tr_b16 a[244:245], v216 offset:0
v_add_f32 v184, 1.0, v184
v_mfma_f32_16x16x32_bf16 v[4:7], a[248:251], a[52:55], v[4:7]
ds_read_b64_tr_b16 a[246:247], v216 offset:512
v_mul_f32 v76, v72, v76
v_mfma_f32_16x16x32_bf16 v[8:11], a[248:251], a[56:59], v[8:11]
buffer_load_dwordx4 v217, s[20:23], s70 offen offset:0 lds
v_mfma_f32_16x16x32_bf16 v[12:15], a[248:251], a[60:63], v[12:15]
s_waitcnt vmcnt(9)
ds_read_b64_tr_b16 a[248:249], v213 offset:16384
s_waitcnt lgkmcnt(3)
v_mfma_f32_16x16x32_bf16 v[16:19], a[252:255], a[48:51], v[16:19]
ds_read_b64_tr_b16 a[250:251], v213 offset:16896
v_mul_f32 v77, v73, v77
v_mfma_f32_16x16x32_bf16 v[20:23], a[252:255], a[52:55], v[20:23]
buffer_load_dwordx4 v218, s[20:23], s70 offen offset:1024 lds
v_mfma_f32_16x16x32_bf16 v[24:27], a[252:255], a[56:59], v[24:27]
v_exp_f32 v185, v185
v_mfma_f32_16x16x32_bf16 v[28:31], a[252:255], a[60:63], v[28:31]
ds_read_b64_tr_b16 a[252:253], v214 offset:16384
v_add_f32 v185, 1.0, v185
v_mfma_f32_16x16x32_bf16 v[32:35], a[224:227], a[48:51], v[32:35]
ds_read_b64_tr_b16 a[254:255], v214 offset:16896
v_mul_f32 v78, v74, v78
v_mfma_f32_16x16x32_bf16 v[36:39], a[224:227], a[52:55], v[36:39]
buffer_load_dwordx4 v219, s[20:23], s70 offen offset:2048 lds
v_mfma_f32_16x16x32_bf16 v[40:43], a[224:227], a[56:59], v[40:43]
v_exp_f32 v186, v186
v_mfma_f32_16x16x32_bf16 v[44:47], a[224:227], a[60:63], v[44:47]
ds_read_b64_tr_b16 a[224:225], v215 offset:16384
v_add_f32 v186, 1.0, v186
v_mfma_f32_16x16x32_bf16 v[48:51], a[228:231], a[48:51], v[48:51]
ds_read_b64_tr_b16 a[226:227], v215 offset:16896
v_mul_f32 v79, v75, v79
v_mfma_f32_16x16x32_bf16 v[52:55], a[228:231], a[52:55], v[52:55]
buffer_load_dwordx4 v220, s[20:23], s70 offen offset:3072 lds
v_mfma_f32_16x16x32_bf16 v[56:59], a[228:231], a[56:59], v[56:59]
s_add_u32 m0, s69, 4096
s_mov_b32 s70, 49152
v_mfma_f32_16x16x32_bf16 v[60:63], a[228:231], a[60:63], v[60:63]
s_and_b32 s69, s46, 15
ds_read_b64_tr_b16 a[228:229], v216 offset:16384
v_mfma_f32_16x16x32_bf16 v[0:3], a[232:235], a[64:67], v[0:3]
s_lshl_b32 s98, s69, 2
ds_read_b64_tr_b16 a[230:231], v216 offset:16896
v_mfma_f32_16x16x32_bf16 v[4:7], a[232:235], a[68:71], v[4:7]
buffer_load_dwordx4 v217, s[20:23], s71 offen offset:0 lds
v_mfma_f32_16x16x32_bf16 v[8:11], a[232:235], a[72:75], v[8:11]
s_add_u32 s98, s98, s44
v_exp_f32 v187, v187
v_mfma_f32_16x16x32_bf16 v[12:15], a[232:235], a[76:79], v[12:15]
s_mul_i32 s98, s98, 3200
v_add_f32 v187, 1.0, v187
v_mfma_f32_16x16x32_bf16 v[16:19], a[236:239], a[64:67], v[16:19]
buffer_load_dwordx4 v218, s[20:23], s71 offen offset:1024 lds
v_mfma_f32_16x16x32_bf16 v[20:23], a[236:239], a[68:71], v[20:23]
s_waitcnt vmcnt(10)
ds_read_b64_tr_b16 a[232:233], v213 offset:32768
v_mfma_f32_16x16x32_bf16 v[24:27], a[236:239], a[72:75], v[24:27]
ds_read_b64_tr_b16 a[234:235], v213 offset:33280
v_permlane32_swap_b32 v80, v84
v_mfma_f32_16x16x32_bf16 v[28:31], a[236:239], a[76:79], v[28:31]
ds_read_b64_tr_b16 a[236:237], v214 offset:32768
v_permlane32_swap_b32 v81, v85
v_mfma_f32_16x16x32_bf16 v[32:35], a[240:243], a[64:67], v[32:35]
buffer_load_dwordx4 v219, s[20:23], s71 offen offset:2048 lds
v_mfma_f32_16x16x32_bf16 v[36:39], a[240:243], a[68:71], v[36:39]
ds_read_b64_tr_b16 a[238:239], v214 offset:33280
v_permlane32_swap_b32 v82, v86
v_mfma_f32_16x16x32_bf16 v[40:43], a[240:243], a[72:75], v[40:43]
v_rcp_f32 v176, v176
v_mfma_f32_16x16x32_bf16 v[44:47], a[240:243], a[76:79], v[44:47]
ds_read_b64_tr_b16 a[240:241], v215 offset:32768
s_waitcnt lgkmcnt(5)
v_mfma_f32_16x16x32_bf16 v[48:51], a[244:247], a[64:67], v[48:51]
buffer_load_dwordx4 v220, s[20:23], s71 offen offset:3072 lds
v_mfma_f32_16x16x32_bf16 v[52:55], a[244:247], a[68:71], v[52:55]
s_add_u32 m0, s48, 98304
s_mov_b32 s71, 16384
v_mfma_f32_16x16x32_bf16 v[56:59], a[244:247], a[72:75], v[56:59]
ds_read_b64_tr_b16 a[242:243], v215 offset:33280
v_mul_f32 v176, v68, v176
v_mfma_f32_16x16x32_bf16 v[60:63], a[244:247], a[76:79], v[60:63]
ds_read_b64_tr_b16 a[244:245], v216 offset:32768
v_permlane32_swap_b32 v83, v87
v_mfma_f32_16x16x32_bf16 v[0:3], a[248:251], a[80:83], v[0:3]
buffer_load_dwordx4 v217, s[20:23], s72 offen offset:0 lds
v_mfma_f32_16x16x32_bf16 v[4:7], a[248:251], a[84:87], v[4:7]
ds_read_b64_tr_b16 a[246:247], v216 offset:33280
v_permlane32_swap_b32 v88, v92
v_mfma_f32_16x16x32_bf16 v[8:11], a[248:251], a[88:91], v[8:11]
v_rcp_f32 v177, v177
v_mfma_f32_16x16x32_bf16 v[12:15], a[248:251], a[92:95], v[12:15]
s_waitcnt vmcnt(9)
ds_read_b64_tr_b16 a[248:249], v213 offset:49152
v_mfma_f32_16x16x32_bf16 v[16:19], a[252:255], a[80:83], v[16:19]
buffer_load_dwordx4 v218, s[20:23], s72 offen offset:1024 lds
v_mfma_f32_16x16x32_bf16 v[20:23], a[252:255], a[84:87], v[20:23]
ds_read_b64_tr_b16 a[250:251], v213 offset:49664
v_mul_f32 v177, v69, v177
v_mfma_f32_16x16x32_bf16 v[24:27], a[252:255], a[88:91], v[24:27]
v_rcp_f32 v178, v178
v_mfma_f32_16x16x32_bf16 v[28:31], a[252:255], a[92:95], v[28:31]
ds_read_b64_tr_b16 a[252:253], v214 offset:49152
v_mul_f32 v178, v70, v178
v_mfma_f32_16x16x32_bf16 v[32:35], a[224:227], a[80:83], v[32:35]
buffer_load_dwordx4 v219, s[20:23], s72 offen offset:2048 lds
v_mfma_f32_16x16x32_bf16 v[36:39], a[224:227], a[84:87], v[36:39]
ds_read_b64_tr_b16 a[254:255], v214 offset:49664
v_permlane32_swap_b32 v89, v93
v_mfma_f32_16x16x32_bf16 v[40:43], a[224:227], a[88:91], v[40:43]
v_rcp_f32 v179, v179
v_mfma_f32_16x16x32_bf16 v[44:47], a[224:227], a[92:95], v[44:47]
ds_read_b64_tr_b16 a[224:225], v215 offset:49152
v_mul_f32 v179, v71, v179
v_mfma_f32_16x16x32_bf16 v[48:51], a[228:231], a[80:83], v[48:51]
buffer_load_dwordx4 v220, s[20:23], s72 offen offset:3072 lds
v_mfma_f32_16x16x32_bf16 v[52:55], a[228:231], a[84:87], v[52:55]
s_add_u32 m0, s48, 114688
s_mov_b32 s72, 32768
v_mfma_f32_16x16x32_bf16 v[56:59], a[228:231], a[88:91], v[56:59]
ds_read_b64_tr_b16 a[226:227], v215 offset:49664
v_permlane32_swap_b32 v90, v94
v_mfma_f32_16x16x32_bf16 v[60:63], a[228:231], a[92:95], v[60:63]
ds_read_b64_tr_b16 a[228:229], v216 offset:49152
s_waitcnt lgkmcnt(4)
v_mfma_f32_16x16x32_bf16 v[0:3], a[232:235], a[96:99], v[0:3]
buffer_load_dwordx4 v217, s[20:23], s73 offen offset:0 lds
v_mfma_f32_16x16x32_bf16 v[4:7], a[232:235], a[100:103], v[4:7]
ds_read_b64_tr_b16 a[230:231], v216 offset:49664
v_permlane32_swap_b32 v91, v95
v_mfma_f32_16x16x32_bf16 v[8:11], a[232:235], a[104:107], v[8:11]
v_rcp_f32 v184, v184
v_mfma_f32_16x16x32_bf16 v[12:15], a[232:235], a[108:111], v[12:15]
s_waitcnt vmcnt(9)
ds_read_b64_tr_b16 a[232:233], v196 offset:0
v_mfma_f32_16x16x32_bf16 v[16:19], a[236:239], a[96:99], v[16:19]
buffer_load_dwordx4 v218, s[20:23], s73 offen offset:1024 lds
v_mfma_f32_16x16x32_bf16 v[20:23], a[236:239], a[100:103], v[20:23]
ds_read_b64_tr_b16 a[234:235], v196 offset:512
v_mul_f32 v184, v76, v184
v_mfma_f32_16x16x32_bf16 v[24:27], a[236:239], a[104:107], v[24:27]
v_rcp_f32 v185, v185
v_mfma_f32_16x16x32_bf16 v[28:31], a[236:239], a[108:111], v[28:31]
ds_read_b64_tr_b16 a[236:237], v197 offset:0
v_mul_f32 v185, v77, v185
v_mfma_f32_16x16x32_bf16 v[32:35], a[240:243], a[96:99], v[32:35]
buffer_load_dwordx4 v219, s[20:23], s73 offen offset:2048 lds
v_mfma_f32_16x16x32_bf16 v[36:39], a[240:243], a[100:103], v[36:39]
ds_read_b64_tr_b16 a[238:239], v197 offset:512
v_mul_f32 v84, v80, v84
v_mfma_f32_16x16x32_bf16 v[40:43], a[240:243], a[104:107], v[40:43]
v_rcp_f32 v186, v186
v_mfma_f32_16x16x32_bf16 v[44:47], a[240:243], a[108:111], v[44:47]
ds_read_b64_tr_b16 a[240:241], v198 offset:0
v_mul_f32 v186, v78, v186
v_mfma_f32_16x16x32_bf16 v[48:51], a[244:247], a[96:99], v[48:51]
buffer_load_dwordx4 v220, s[20:23], s73 offen offset:3072 lds
v_mfma_f32_16x16x32_bf16 v[52:55], a[244:247], a[100:103], v[52:55]
s_add_u32 m0, s48, 131072
s_mov_b32 s73, 65536
v_mfma_f32_16x16x32_bf16 v[56:59], a[244:247], a[104:107], v[56:59]
ds_read_b64_tr_b16 a[242:243], v198 offset:512
v_mul_f32 v85, v81, v85
v_mfma_f32_16x16x32_bf16 v[60:63], a[244:247], a[108:111], v[60:63]
ds_read_b64_tr_b16 a[244:245], v199 offset:0
v_mul_f32 v86, v82, v86
v_mfma_f32_16x16x32_bf16 v[0:3], a[248:251], a[112:115], v[0:3]
buffer_load_dwordx4 v217, s[20:23], s74 offen offset:0 lds
v_mfma_f32_16x16x32_bf16 v[4:7], a[248:251], a[116:119], v[4:7]
ds_read_b64_tr_b16 a[246:247], v199 offset:512
v_mul_f32 v87, v83, v87
v_mfma_f32_16x16x32_bf16 v[8:11], a[248:251], a[120:123], v[8:11]
v_rcp_f32 v187, v187
v_mfma_f32_16x16x32_bf16 v[12:15], a[248:251], a[124:127], v[12:15]
s_waitcnt vmcnt(9)
ds_read_b64_tr_b16 a[248:249], v196 offset:4096
s_waitcnt lgkmcnt(4)
v_mfma_f32_16x16x32_bf16 v[16:19], a[252:255], a[112:115], v[16:19]
buffer_load_dwordx4 v218, s[20:23], s74 offen offset:1024 lds
v_mfma_f32_16x16x32_bf16 v[20:23], a[252:255], a[116:119], v[20:23]
ds_read_b64_tr_b16 a[250:251], v196 offset:4608
v_mov_b32 v196, 0x3f803f80
v_mfma_f32_16x16x32_bf16 v[24:27], a[252:255], a[120:123], v[24:27]
ds_write_b64 v221, v[180:181] offset:12288
v_mfma_f32_16x16x32_bf16 v[28:31], a[252:255], a[124:127], v[28:31]
buffer_load_dwordx4 v219, s[20:23], s74 offen offset:2048 lds
v_mfma_f32_16x16x32_bf16 v[32:35], a[224:227], a[112:115], v[32:35]
ds_read_b64_tr_b16 a[252:253], v197 offset:4096
v_mul_f32 v187, v79, v187
v_mfma_f32_16x16x32_bf16 v[36:39], a[224:227], a[116:119], v[36:39]
ds_read_b64_tr_b16 a[254:255], v197 offset:4608
v_mov_b32 v197, 0x3f803f80
v_mfma_f32_16x16x32_bf16 v[40:43], a[224:227], a[120:123], v[40:43]
ds_write_b64 v221, v[188:189] offset:14336
v_mfma_f32_16x16x32_bf16 v[44:47], a[224:227], a[124:127], v[44:47]
buffer_load_dwordx4 v220, s[20:23], s74 offen offset:3072 lds
v_mfma_f32_16x16x32_bf16 v[48:51], a[228:231], a[112:115], v[48:51]
s_add_u32 m0, s48, 147456
s_mov_b32 s74, 81920
v_mfma_f32_16x16x32_bf16 v[52:55], a[228:231], a[116:119], v[52:55]
ds_read_b64_tr_b16 a[224:225], v198 offset:4096
v_cvt_pk_bf16_f32 v180, v176, v177
v_mfma_f32_16x16x32_bf16 v[56:59], a[228:231], a[120:123], v[56:59]
ds_read_b64_tr_b16 a[226:227], v198 offset:4608
v_mov_b32 v198, 0x3f803f80
v_mfma_f32_16x16x32_bf16 v[60:63], a[228:231], a[124:127], v[60:63]
buffer_load_dwordx4 v217, s[20:23], s75 offen offset:0 lds
v_mfma_f32_16x16x32_bf16 v[0:3], a[232:235], a[128:131], v[0:3]
ds_read_b64_tr_b16 a[228:229], v199 offset:4096
v_cvt_pk_bf16_f32 v181, v178, v179
v_mfma_f32_16x16x32_bf16 v[4:7], a[232:235], a[132:135], v[4:7]
ds_read_b64_tr_b16 a[230:231], v199 offset:4608
v_mov_b32 v199, 0x3f803f80
v_mfma_f32_16x16x32_bf16 v[8:11], a[232:235], a[136:139], v[8:11]
v_cvt_pk_bf16_f32 v188, v184, v185
v_mfma_f32_16x16x32_bf16 v[12:15], a[232:235], a[140:143], v[12:15]
buffer_load_dwordx4 v218, s[20:23], s75 offen offset:1024 lds
v_mfma_f32_16x16x32_bf16 v[16:19], a[236:239], a[128:131], v[16:19]
s_waitcnt vmcnt(10)
ds_read_b64_tr_b16 a[232:233], v213 offset:0
v_mfma_f32_16x16x32_bf16 v[20:23], a[236:239], a[132:135], v[20:23]
ds_read_b64_tr_b16 a[234:235], v213 offset:512
v_cvt_pk_bf16_f32 v189, v186, v187
v_mfma_f32_16x16x32_bf16 v[24:27], a[236:239], a[136:139], v[24:27]
v_mul_f32 v176, v80, v80
v_mfma_f32_16x16x32_bf16 v[28:31], a[236:239], a[140:143], v[28:31]
ds_read_b64_tr_b16 a[236:237], v214 offset:0
s_waitcnt lgkmcnt(4)
v_mfma_f32_16x16x32_bf16 v[32:35], a[240:243], a[128:131], v[32:35]
buffer_load_dwordx4 v219, s[20:23], s75 offen offset:2048 lds
v_mfma_f32_16x16x32_bf16 v[36:39], a[240:243], a[132:135], v[36:39]
ds_read_b64_tr_b16 a[238:239], v214 offset:512
v_mul_f32 v177, v81, v81
v_mfma_f32_16x16x32_bf16 v[40:43], a[240:243], a[136:139], v[40:43]
v_mul_f32 v178, v82, v82
v_mfma_f32_16x16x32_bf16 v[44:47], a[240:243], a[140:143], v[44:47]
ds_read_b64_tr_b16 a[240:241], v215 offset:0
v_mul_f32 v179, v83, v83
v_mfma_f32_16x16x32_bf16 v[48:51], a[244:247], a[128:131], v[48:51]
buffer_load_dwordx4 v220, s[20:23], s75 offen offset:3072 lds
v_mfma_f32_16x16x32_bf16 v[52:55], a[244:247], a[132:135], v[52:55]
s_add_u32 m0, s48, 98304
s_mov_b32 s75, 49152
v_mfma_f32_16x16x32_bf16 v[56:59], a[244:247], a[136:139], v[56:59]
ds_read_b64_tr_b16 a[242:243], v215 offset:512
v_mul_f32 v184, v88, v88
v_mfma_f32_16x16x32_bf16 v[60:63], a[244:247], a[140:143], v[60:63]
ds_read_b64_tr_b16 a[244:245], v216 offset:0
v_mul_f32 v185, v89, v89
v_mfma_f32_16x16x32_bf16 v[0:3], a[248:251], a[144:147], v[0:3]
ds_read_b64_tr_b16 a[246:247], v216 offset:512
v_mul_f32 v186, v90, v90
v_mfma_f32_16x16x32_bf16 v[4:7], a[248:251], a[148:151], v[4:7]
v_mul_f32 v187, v91, v91
v_mfma_f32_16x16x32_bf16 v[8:11], a[248:251], a[152:155], v[8:11]
v_fma_f32 v176, v176, s67, v203
v_mfma_f32_16x16x32_bf16 v[12:15], a[248:251], a[156:159], v[12:15]
s_waitcnt vmcnt(8)
ds_read_b64_tr_b16 a[248:249], v213 offset:16384
v_mfma_f32_16x16x32_bf16 v[16:19], a[252:255], a[144:147], v[16:19]
ds_read_b64_tr_b16 a[250:251], v213 offset:16896
v_fma_f32 v177, v177, s67, v203
v_mfma_f32_16x16x32_bf16 v[20:23], a[252:255], a[148:151], v[20:23]
v_fma_f32 v178, v178, s67, v203
v_mfma_f32_16x16x32_bf16 v[24:27], a[252:255], a[152:155], v[24:27]
v_fma_f32 v179, v179, s67, v203
v_mfma_f32_16x16x32_bf16 v[28:31], a[252:255], a[156:159], v[28:31]
ds_read_b64_tr_b16 a[252:253], v214 offset:16384
v_fma_f32 v184, v184, s67, v203
v_mfma_f32_16x16x32_bf16 v[32:35], a[224:227], a[144:147], v[32:35]
ds_read_b64_tr_b16 a[254:255], v214 offset:16896
v_fma_f32 v185, v185, s67, v203
v_mfma_f32_16x16x32_bf16 v[36:39], a[224:227], a[148:151], v[36:39]
v_fma_f32 v186, v186, s67, v203
v_mfma_f32_16x16x32_bf16 v[40:43], a[224:227], a[152:155], v[40:43]
v_fma_f32 v187, v187, s67, v203
v_mfma_f32_16x16x32_bf16 v[44:47], a[224:227], a[156:159], v[44:47]
ds_read_b64_tr_b16 a[224:225], v215 offset:16384
s_waitcnt lgkmcnt(4)
v_mfma_f32_16x16x32_bf16 v[48:51], a[228:231], a[144:147], v[48:51]
ds_read_b64_tr_b16 a[226:227], v215 offset:16896
v_mul_f32 v176, v80, v176
v_mfma_f32_16x16x32_bf16 v[52:55], a[228:231], a[148:151], v[52:55]
v_mul_f32 v177, v81, v177
v_mfma_f32_16x16x32_bf16 v[56:59], a[228:231], a[152:155], v[56:59]
v_mul_f32 v178, v82, v178
v_mfma_f32_16x16x32_bf16 v[60:63], a[228:231], a[156:159], v[60:63]
ds_read_b64_tr_b16 a[228:229], v216 offset:16384
v_mul_f32 v179, v83, v179
v_mfma_f32_16x16x32_bf16 v[0:3], a[232:235], a[160:163], v[0:3]
ds_read_b64_tr_b16 a[230:231], v216 offset:16896
v_mul_f32 v184, v88, v184
v_mfma_f32_16x16x32_bf16 v[4:7], a[232:235], a[164:167], v[4:7]
v_mul_f32 v185, v89, v185
v_mfma_f32_16x16x32_bf16 v[8:11], a[232:235], a[168:171], v[8:11]
v_mul_f32 v186, v90, v186
v_mfma_f32_16x16x32_bf16 v[12:15], a[232:235], a[172:175], v[12:15]
s_waitcnt vmcnt(4)
ds_read_b64_tr_b16 a[232:233], v213 offset:32768
v_mfma_f32_16x16x32_bf16 v[16:19], a[236:239], a[160:163], v[16:19]
ds_read_b64_tr_b16 a[234:235], v213 offset:33280
v_mul_f32 v187, v91, v187
v_mfma_f32_16x16x32_bf16 v[20:23], a[236:239], a[164:167], v[20:23]
v_exp_f32 v176, v176
v_mfma_f32_16x16x32_bf16 v[24:27], a[236:239], a[168:171], v[24:27]
v_exp_f32 v177, v177
v_mfma_f32_16x16x32_bf16 v[28:31], a[236:239], a[172:175], v[28:31]
ds_read_b64_tr_b16 a[236:237], v214 offset:32768
v_add_f32 v176, 1.0, v176
v_mfma_f32_16x16x32_bf16 v[32:35], a[240:243], a[160:163], v[32:35]
ds_read_b64_tr_b16 a[238:239], v214 offset:33280
v_add_f32 v177, 1.0, v177
v_mfma_f32_16x16x32_bf16 v[36:39], a[240:243], a[164:167], v[36:39]
v_exp_f32 v178, v178
v_mfma_f32_16x16x32_bf16 v[40:43], a[240:243], a[168:171], v[40:43]
v_exp_f32 v179, v179
v_mfma_f32_16x16x32_bf16 v[44:47], a[240:243], a[172:175], v[44:47]
ds_read_b64_tr_b16 a[240:241], v215 offset:32768
v_add_f32 v178, 1.0, v178
v_mfma_f32_16x16x32_bf16 v[48:51], a[244:247], a[160:163], v[48:51]
ds_read_b64_tr_b16 a[242:243], v215 offset:33280
v_add_f32 v179, 1.0, v179
v_mfma_f32_16x16x32_bf16 v[52:55], a[244:247], a[164:167], v[52:55]
v_exp_f32 v184, v184
v_mfma_f32_16x16x32_bf16 v[56:59], a[244:247], a[168:171], v[56:59]
v_exp_f32 v185, v185
v_mfma_f32_16x16x32_bf16 v[60:63], a[244:247], a[172:175], v[60:63]
ds_read_b64_tr_b16 a[244:245], v216 offset:32768
s_waitcnt lgkmcnt(4)
v_mfma_f32_16x16x32_bf16 v[0:3], a[248:251], a[176:179], v[0:3]
buffer_load_dwordx4 v223, s[12:15], 0 offen offset:0 lds
v_mfma_f32_16x16x32_bf16 v[4:7], a[248:251], a[180:183], v[4:7]
ds_read_b64_tr_b16 a[246:247], v216 offset:33280
v_add_f32 v184, 1.0, v184
v_mfma_f32_16x16x32_bf16 v[8:11], a[248:251], a[184:187], v[8:11]
v_exp_f32 v186, v186
v_mfma_f32_16x16x32_bf16 v[12:15], a[248:251], a[188:191], v[12:15]
s_waitcnt vmcnt(1)
ds_read_b64_tr_b16 a[248:249], v213 offset:49152
v_mfma_f32_16x16x32_bf16 v[16:19], a[252:255], a[176:179], v[16:19]
ds_read_b64_tr_b16 a[250:251], v213 offset:49664
v_add_f32 v185, 1.0, v185
v_mfma_f32_16x16x32_bf16 v[20:23], a[252:255], a[180:183], v[20:23]
v_exp_f32 v187, v187
v_mfma_f32_16x16x32_bf16 v[24:27], a[252:255], a[184:187], v[24:27]
v_add_f32 v186, 1.0, v186
v_mfma_f32_16x16x32_bf16 v[28:31], a[252:255], a[188:191], v[28:31]
buffer_load_dwordx4 v224, s[12:15], 0 offen offset:1024 lds
v_mfma_f32_16x16x32_bf16 v[32:35], a[224:227], a[176:179], v[32:35]
ds_read_b64_tr_b16 a[252:253], v214 offset:49152
v_add_f32 v187, 1.0, v187
v_mfma_f32_16x16x32_bf16 v[36:39], a[224:227], a[180:183], v[36:39]
ds_read_b64_tr_b16 a[254:255], v214 offset:49664
v_mul_f32 v92, v88, v92
v_mfma_f32_16x16x32_bf16 v[40:43], a[224:227], a[184:187], v[40:43]
v_rcp_f32 v176, v176
v_mfma_f32_16x16x32_bf16 v[44:47], a[224:227], a[188:191], v[44:47]
v_rcp_f32 v177, v177
v_mfma_f32_16x16x32_bf16 v[48:51], a[228:231], a[176:179], v[48:51]
v_rcp_f32 v178, v178
v_mfma_f32_16x16x32_bf16 v[52:55], a[228:231], a[180:183], v[52:55]
v_rcp_f32 v179, v179
v_mfma_f32_16x16x32_bf16 v[56:59], a[228:231], a[184:187], v[56:59]
buffer_load_dwordx4 v225, s[12:15], 0 offen offset:2048 lds
v_mfma_f32_16x16x32_bf16 v[60:63], a[228:231], a[188:191], v[60:63]
v_rcp_f32 v184, v184
v_mfma_f32_16x16x32_bf16 v[0:3], a[232:235], a[192:195], v[0:3]
v_rcp_f32 v185, v185
v_mfma_f32_16x16x32_bf16 v[4:7], a[232:235], a[196:199], v[4:7]
v_rcp_f32 v186, v186
v_mfma_f32_16x16x32_bf16 v[8:11], a[232:235], a[200:203], v[8:11]
v_rcp_f32 v187, v187
v_mfma_f32_16x16x32_bf16 v[12:15], a[232:235], a[204:207], v[12:15]
ds_read_b64_tr_b16 a[224:225], v215 offset:49152
s_waitcnt lgkmcnt(1)
v_mfma_f32_16x16x32_bf16 v[16:19], a[236:239], a[192:195], v[16:19]
ds_write_b64 v221, v[180:181] offset:16384
buffer_load_dwordx4 v226, s[12:15], 0 offen offset:3072 lds
v_mfma_f32_16x16x32_bf16 v[20:23], a[236:239], a[196:199], v[20:23]
s_add_u32 m0, s48, 114688
ds_write_b64 v221, v[188:189] offset:18432
v_mfma_f32_16x16x32_bf16 v[24:27], a[236:239], a[200:203], v[24:27]
ds_read_b64_tr_b16 a[226:227], v215 offset:49664
v_mul_f32 v93, v89, v93
v_mfma_f32_16x16x32_bf16 v[28:31], a[236:239], a[204:207], v[28:31]
v_mul_f32 v94, v90, v94
v_mfma_f32_16x16x32_bf16 v[32:35], a[240:243], a[192:195], v[32:35]
v_mul_f32 v95, v91, v95
v_mfma_f32_16x16x32_bf16 v[36:39], a[240:243], a[196:199], v[36:39]
v_mul_f32 v176, v84, v176
v_mfma_f32_16x16x32_bf16 v[40:43], a[240:243], a[200:203], v[40:43]
v_mul_f32 v177, v85, v177
v_mfma_f32_16x16x32_bf16 v[44:47], a[240:243], a[204:207], v[44:47]
buffer_load_dwordx4 v223, s[12:15], s76 offen offset:0 lds
v_mfma_f32_16x16x32_bf16 v[48:51], a[244:247], a[192:195], v[48:51]
v_mul_f32 v178, v86, v178
v_mul_f32 v179, v87, v179
v_mfma_f32_16x16x32_bf16 v[52:55], a[244:247], a[196:199], v[52:55]
v_mul_f32 v184, v92, v184
v_mfma_f32_16x16x32_bf16 v[56:59], a[244:247], a[200:203], v[56:59]
v_mul_f32 v185, v93, v185
v_mfma_f32_16x16x32_bf16 v[60:63], a[244:247], a[204:207], v[60:63]
v_mul_f32 v186, v94, v186
v_mfma_f32_16x16x32_bf16 v[0:3], a[248:251], a[208:211], v[0:3]
v_mul_f32 v187, v95, v187
v_cvt_pk_bf16_f32 v180, v176, v177
v_mfma_f32_16x16x32_bf16 v[4:7], a[248:251], a[212:215], v[4:7]
v_cvt_pk_bf16_f32 v181, v178, v179
v_cvt_pk_bf16_f32 v188, v184, v185
v_cvt_pk_bf16_f32 v189, v186, v187
v_permlane32_swap_b32 v96, v100
v_permlane32_swap_b32 v97, v101
v_permlane32_swap_b32 v98, v102
v_permlane32_swap_b32 v99, v103
v_permlane32_swap_b32 v104, v108
v_permlane32_swap_b32 v105, v109
v_permlane32_swap_b32 v106, v110
v_permlane32_swap_b32 v107, v111
v_mfma_f32_16x16x32_bf16 v[8:11], a[248:251], a[216:219], v[8:11]
buffer_load_dwordx4 v224, s[12:15], s76 offen offset:1024 lds
ds_read_b64_tr_b16 a[228:229], v216 offset:49152
ds_read_b64_tr_b16 a[230:231], v216 offset:49664
v_mul_f32 v176, v96, v96
v_mul_f32 v177, v97, v97
v_mul_f32 v178, v98, v98
v_mul_f32 v179, v99, v99
v_mul_f32 v184, v104, v104
v_mul_f32 v185, v105, v105
v_mul_f32 v186, v106, v106
v_mul_f32 v187, v107, v107
v_fma_f32 v176, v176, s67, v203
v_fma_f32 v177, v177, s67, v203
v_fma_f32 v178, v178, s67, v203
v_fma_f32 v179, v179, s67, v203
v_fma_f32 v184, v184, s67, v203
v_fma_f32 v185, v185, s67, v203
v_fma_f32 v186, v186, s67, v203
v_fma_f32 v187, v187, s67, v203
v_mul_f32 v176, v96, v176
v_mul_f32 v177, v97, v177
v_mul_f32 v178, v98, v178
v_mul_f32 v179, v99, v179
v_mul_f32 v184, v104, v184
v_mul_f32 v185, v105, v185
v_mul_f32 v186, v106, v186
v_mul_f32 v187, v107, v187
v_exp_f32 v176, v176
v_exp_f32 v177, v177
v_exp_f32 v178, v178
v_exp_f32 v179, v179
v_exp_f32 v184, v184
v_exp_f32 v185, v185
v_exp_f32 v186, v186
v_exp_f32 v187, v187
v_mfma_f32_16x16x32_bf16 v[12:15], a[248:251], a[220:223], v[12:15]
buffer_load_dwordx4 v225, s[12:15], s76 offen offset:2048 lds
v_add_f32 v176, 1.0, v176
v_add_f32 v177, 1.0, v177
v_add_f32 v178, 1.0, v178
v_add_f32 v179, 1.0, v179
v_add_f32 v184, 1.0, v184
v_add_f32 v185, 1.0, v185
v_add_f32 v186, 1.0, v186
v_add_f32 v187, 1.0, v187
v_rcp_f32 v176, v176
v_rcp_f32 v177, v177
v_rcp_f32 v178, v178
v_rcp_f32 v179, v179
v_rcp_f32 v184, v184
v_rcp_f32 v185, v185
v_rcp_f32 v186, v186
v_rcp_f32 v187, v187
v_mfma_f32_16x16x32_bf16 v[16:19], a[252:255], a[208:211], v[16:19]
buffer_load_dwordx4 v226, s[12:15], s76 offen offset:3072 lds
ds_write_b64 v221, v[180:181] offset:20480
ds_write_b64 v221, v[188:189] offset:22528
v_mul_f32 v100, v96, v100
v_mul_f32 v101, v97, v101
v_mul_f32 v102, v98, v102
v_mul_f32 v103, v99, v103
v_mul_f32 v108, v104, v108
v_mul_f32 v109, v105, v109
v_mul_f32 v110, v106, v110
v_mul_f32 v111, v107, v111
v_mul_f32 v112, s68, v112
v_mul_f32 v113, s68, v113
v_mul_f32 v116, s68, v116
v_mul_f32 v117, s68, v117
v_mul_f32 v120, s68, v120
v_mul_f32 v121, s68, v121
v_mul_f32 v124, s68, v124
v_mul_f32 v125, s68, v125
v_mul_f32 v128, s68, v128
v_mul_f32 v129, s68, v129
v_mul_f32 v132, s68, v132
v_mul_f32 v133, s68, v133
v_mul_f32 v136, s68, v136
v_mul_f32 v137, s68, v137
v_mul_f32 v140, s68, v140
v_mul_f32 v141, s68, v141
v_mul_f32 v144, s68, v144
v_mul_f32 v145, s68, v145
v_mul_f32 v148, s68, v148
v_mul_f32 v149, s68, v149
v_mul_f32 v152, s68, v152
v_mul_f32 v153, s68, v153
v_mul_f32 v156, s68, v156
v_mul_f32 v157, s68, v157
v_mul_f32 v160, s68, v160
v_mul_f32 v161, s68, v161
v_mul_f32 v164, s68, v164
v_mul_f32 v165, s68, v165
v_mul_f32 v168, s68, v168
v_mul_f32 v169, s68, v169
v_mul_f32 v172, s68, v172
v_mul_f32 v173, s68, v173
v_mul_f32 v0, s68, v0
v_mul_f32 v1, s68, v1
v_mul_f32 v4, s68, v4
v_mul_f32 v5, s68, v5
v_mul_f32 v8, s68, v8
v_mul_f32 v9, s68, v9
v_mul_f32 v12, s68, v12
v_mul_f32 v13, s68, v13
v_mul_f32 v16, s68, v16
v_mul_f32 v17, s68, v17
v_mul_f32 v176, v100, v176
v_mul_f32 v177, v101, v177
v_mul_f32 v178, v102, v178
v_mul_f32 v179, v103, v179
v_mul_f32 v184, v108, v184
v_mul_f32 v185, v109, v185
v_mul_f32 v186, v110, v186
v_mul_f32 v187, v111, v187
v_mul_f32 v114, s68, v114
v_mul_f32 v115, s68, v115
v_cvt_pk_bf16_f32 v112, v112, v113
v_mul_f32 v118, s68, v118
v_mul_f32 v119, s68, v119
v_cvt_pk_bf16_f32 v116, v116, v117
v_mul_f32 v122, s68, v122
v_mul_f32 v123, s68, v123
v_cvt_pk_bf16_f32 v120, v120, v121
v_mul_f32 v126, s68, v126
v_mul_f32 v127, s68, v127
v_cvt_pk_bf16_f32 v124, v124, v125
v_mul_f32 v130, s68, v130
v_mul_f32 v131, s68, v131
v_cvt_pk_bf16_f32 v128, v128, v129
v_mul_f32 v134, s68, v134
v_mul_f32 v135, s68, v135
v_cvt_pk_bf16_f32 v132, v132, v133
v_mul_f32 v138, s68, v138
v_mul_f32 v139, s68, v139
v_cvt_pk_bf16_f32 v136, v136, v137
v_mul_f32 v142, s68, v142
v_mul_f32 v143, s68, v143
v_cvt_pk_bf16_f32 v140, v140, v141
v_mul_f32 v146, s68, v146
v_mul_f32 v147, s68, v147
v_cvt_pk_bf16_f32 v144, v144, v145
v_mul_f32 v150, s68, v150
v_mul_f32 v151, s68, v151
v_cvt_pk_bf16_f32 v148, v148, v149
v_mul_f32 v154, s68, v154
v_mul_f32 v155, s68, v155
v_cvt_pk_bf16_f32 v152, v152, v153
v_mul_f32 v158, s68, v158
v_mul_f32 v159, s68, v159
v_cvt_pk_bf16_f32 v156, v156, v157
v_mul_f32 v162, s68, v162
v_mul_f32 v163, s68, v163
v_cvt_pk_bf16_f32 v160, v160, v161
v_mul_f32 v166, s68, v166
v_mul_f32 v167, s68, v167
v_cvt_pk_bf16_f32 v164, v164, v165
v_mul_f32 v170, s68, v170
v_mul_f32 v171, s68, v171
v_cvt_pk_bf16_f32 v168, v168, v169
v_mul_f32 v174, s68, v174
v_mul_f32 v175, s68, v175
v_cvt_pk_bf16_f32 v172, v172, v173
v_mul_f32 v2, s68, v2
v_mul_f32 v3, s68, v3
v_cvt_pk_bf16_f32 v0, v0, v1
v_mul_f32 v6, s68, v6
v_mul_f32 v7, s68, v7
v_cvt_pk_bf16_f32 v4, v4, v5
v_mul_f32 v10, s68, v10
v_mul_f32 v11, s68, v11
v_cvt_pk_bf16_f32 v8, v8, v9
v_mul_f32 v14, s68, v14
v_mul_f32 v15, s68, v15
v_cvt_pk_bf16_f32 v12, v12, v13
v_mul_f32 v18, s68, v18
v_mul_f32 v19, s68, v19
v_cvt_pk_bf16_f32 v16, v16, v17
v_cvt_pk_bf16_f32 v180, v176, v177
v_cvt_pk_bf16_f32 v181, v178, v179
v_cvt_pk_bf16_f32 v188, v184, v185
v_cvt_pk_bf16_f32 v189, v186, v187
v_cvt_pk_bf16_f32 v113, v114, v115
v_cvt_pk_bf16_f32 v117, v118, v119
v_cvt_pk_bf16_f32 v121, v122, v123
v_cvt_pk_bf16_f32 v125, v126, v127
v_cvt_pk_bf16_f32 v129, v130, v131
v_cvt_pk_bf16_f32 v133, v134, v135
v_cvt_pk_bf16_f32 v137, v138, v139
v_cvt_pk_bf16_f32 v141, v142, v143
v_cvt_pk_bf16_f32 v145, v146, v147
v_cvt_pk_bf16_f32 v149, v150, v151
v_cvt_pk_bf16_f32 v153, v154, v155
v_cvt_pk_bf16_f32 v157, v158, v159
v_cvt_pk_bf16_f32 v161, v162, v163
v_cvt_pk_bf16_f32 v165, v166, v167
v_cvt_pk_bf16_f32 v169, v170, v171
v_cvt_pk_bf16_f32 v173, v174, v175
v_cvt_pk_bf16_f32 v1, v2, v3
v_cvt_pk_bf16_f32 v5, v6, v7
v_cvt_pk_bf16_f32 v9, v10, v11
v_cvt_pk_bf16_f32 v13, v14, v15
v_cvt_pk_bf16_f32 v17, v18, v19
v_mfma_f32_16x16x32_bf16 v[20:23], a[252:255], a[212:215], v[20:23]
s_add_u32 m0, s48, 131072
s_mov_b32 s76, 98304
ds_write_b64 v191, v[180:181] offset:0
ds_write_b64 v191, v[188:189] offset:2048
ds_write_b64 v222, v[112:113] offset:0
ds_write_b64 v222, v[116:117] offset:1024
ds_write_b64 v222, v[120:121] offset:2048
ds_write_b64 v222, v[124:125] offset:3072
v_mul_f32 v20, s68, v20
v_mul_f32 v21, s68, v21
v_mul_f32 v22, s68, v22
v_mul_f32 v23, s68, v23
v_cvt_pk_bf16_f32 v20, v20, v21
v_cvt_pk_bf16_f32 v21, v22, v23
ds_write_b64 v222, v[128:129] offset:512
ds_write_b64 v222, v[132:133] offset:1536
ds_write_b64 v222, v[136:137] offset:2560
ds_write_b64 v222, v[140:141] offset:3584
ds_write_b64 v222, v[144:145] offset:4096
ds_write_b64 v222, v[148:149] offset:5120
ds_write_b64 v222, v[152:153] offset:6144
ds_write_b64 v222, v[156:157] offset:7168
ds_write_b64 v222, v[160:161] offset:4608
ds_write_b64 v222, v[164:165] offset:5632
ds_write_b64 v222, v[168:169] offset:6656
ds_write_b64 v222, v[172:173] offset:7680
ds_write_b64 v222, v[0:1] offset:8192
ds_write_b64 v222, v[4:5] offset:9216
ds_write_b64 v222, v[8:9] offset:10240
ds_write_b64 v222, v[12:13] offset:11264
ds_write_b64 v222, v[16:17] offset:8704
ds_write_b64 v222, v[20:21] offset:9728
v_mfma_f32_16x16x32_bf16 v[24:27], a[252:255], a[216:219], v[24:27]
v_mfma_f32_16x16x32_bf16 v[28:31], a[252:255], a[220:223], v[28:31]
s_waitcnt lgkmcnt(4)
v_mfma_f32_16x16x32_bf16 v[32:35], a[224:227], a[208:211], v[32:35]
v_mfma_f32_16x16x32_bf16 v[36:39], a[224:227], a[212:215], v[36:39]
v_mfma_f32_16x16x32_bf16 v[40:43], a[224:227], a[216:219], v[40:43]
v_mfma_f32_16x16x32_bf16 v[44:47], a[224:227], a[220:223], v[44:47]
v_mfma_f32_16x16x32_bf16 v[48:51], a[228:231], a[208:211], v[48:51]
v_mfma_f32_16x16x32_bf16 v[52:55], a[228:231], a[212:215], v[52:55]
v_mul_f32 v24, s68, v24
v_mul_f32 v25, s68, v25
v_mul_f32 v28, s68, v28
v_mul_f32 v29, s68, v29
v_mul_f32 v32, s68, v32
v_mul_f32 v33, s68, v33
v_mul_f32 v36, s68, v36
v_mul_f32 v37, s68, v37
v_mul_f32 v40, s68, v40
v_mul_f32 v41, s68, v41
v_mul_f32 v44, s68, v44
v_mul_f32 v45, s68, v45
v_mul_f32 v48, s68, v48
v_mul_f32 v49, s68, v49
v_mul_f32 v52, s68, v52
v_mul_f32 v53, s68, v53
v_mul_f32 v26, s68, v26
v_mul_f32 v27, s68, v27
v_cvt_pk_bf16_f32 v24, v24, v25
v_mul_f32 v30, s68, v30
v_mul_f32 v31, s68, v31
v_cvt_pk_bf16_f32 v28, v28, v29
v_mul_f32 v34, s68, v34
v_mul_f32 v35, s68, v35
v_cvt_pk_bf16_f32 v32, v32, v33
v_mul_f32 v38, s68, v38
v_mul_f32 v39, s68, v39
v_cvt_pk_bf16_f32 v36, v36, v37
v_mul_f32 v42, s68, v42
v_mul_f32 v43, s68, v43
v_cvt_pk_bf16_f32 v40, v40, v41
v_mul_f32 v46, s68, v46
v_mul_f32 v47, s68, v47
v_cvt_pk_bf16_f32 v44, v44, v45
v_mul_f32 v50, s68, v50
v_mul_f32 v51, s68, v51
v_cvt_pk_bf16_f32 v48, v48, v49
v_mul_f32 v54, s68, v54
v_mul_f32 v55, s68, v55
v_cvt_pk_bf16_f32 v52, v52, v53
v_cvt_pk_bf16_f32 v25, v26, v27
v_cvt_pk_bf16_f32 v29, v30, v31
v_cvt_pk_bf16_f32 v33, v34, v35
v_cvt_pk_bf16_f32 v37, v38, v39
v_cvt_pk_bf16_f32 v41, v42, v43
v_cvt_pk_bf16_f32 v45, v46, v47
v_cvt_pk_bf16_f32 v49, v50, v51
v_cvt_pk_bf16_f32 v53, v54, v55
ds_write_b64 v222, v[24:25] offset:10752
ds_write_b64 v222, v[28:29] offset:11776
ds_write_b64 v222, v[32:33] offset:12288
ds_write_b64 v222, v[36:37] offset:13312
ds_write_b64 v222, v[40:41] offset:14336
ds_write_b64 v222, v[44:45] offset:15360
ds_write_b64 v222, v[48:49] offset:12800
ds_write_b64 v222, v[52:53] offset:13824
v_mfma_f32_16x16x32_bf16 v[56:59], a[228:231], a[216:219], v[56:59]
v_mfma_f32_16x16x32_bf16 v[60:63], a[228:231], a[220:223], v[60:63]
s_nop 6
v_mul_f32 v56, s68, v56
v_mul_f32 v57, s68, v57
v_cvt_pk_bf16_f32 v56, v56, v57
v_mul_f32 v60, s68, v60
v_mul_f32 v61, s68, v61
v_cvt_pk_bf16_f32 v60, v60, v61
v_mul_f32 v58, s68, v58
v_mul_f32 v59, s68, v59
v_mul_f32 v62, s68, v62
v_mul_f32 v63, s68, v63
v_cvt_pk_bf16_f32 v57, v58, v59
v_cvt_pk_bf16_f32 v61, v62, v63
ds_write_b64 v222, v[56:57] offset:14848
ds_write_b64 v222, v[60:61] offset:15872
s_mul_i32 s67, s45, 252
s_add_u32 s67, s67, s66
s_lshl_b32 s3, s45, 14
s_sub_u32 s68, s65, s3
s_cmp_eq_u32 s45, 7
s_cselect_b32 s68, 0x7ff00000, s68
v_mov_b32 v222, 0x41a00000
s_waitcnt lgkmcnt(0) vmcnt(4)
s_barrier
buffer_load_dwordx4 v223, s[12:15], s77 offen offset:0 lds
ds_read_b128 a[112:115], v254 offset:0
ds_read_b128 a[176:179], v231 offset:0
ds_read_b128 a[116:119], v254 offset:1024
ds_read_b128 a[120:123], v254 offset:4096
ds_read_b128 a[180:183], v232 offset:0
ds_read_b128 a[124:127], v254 offset:5120
ds_read_b128 a[128:131], v254 offset:8192
ds_read_b128 a[184:187], v233 offset:0
ds_read_b128 a[132:135], v254 offset:9216
ds_read_b128 a[136:139], v254 offset:12288
ds_read_b128 a[188:191], v234 offset:0
ds_read_b128 a[140:143], v254 offset:13312
ds_read_b128 a[144:147], v254 offset:16384
ds_read_b128 a[192:195], v231 offset:256
buffer_load_dwordx4 v224, s[12:15], s77 offen offset:1024 lds
ds_read_b128 a[148:151], v254 offset:17408
s_waitcnt lgkmcnt(13)
L_flash:
v_mfma_f32_16x16x32_bf16 v[128:131], a[176:179], a[112:115], 0
ds_read_b128 a[152:155], v254 offset:20480
s_waitcnt lgkmcnt(13)
v_mfma_f32_16x16x32_bf16 v[132:135], a[176:179], a[116:119], 0
ds_read_b128 a[196:199], v232 offset:256
s_waitcnt lgkmcnt(12)
v_mfma_f32_16x16x32_bf16 v[128:131], a[180:183], a[120:123], v[128:131]
ds_read_b128 a[156:159], v254 offset:21504
s_waitcnt lgkmcnt(12)
v_mfma_f32_16x16x32_bf16 v[132:135], a[180:183], a[124:127], v[132:135]
ds_read_b128 a[160:163], v254 offset:24576
s_waitcnt lgkmcnt(11)
v_mfma_f32_16x16x32_bf16 v[128:131], a[184:187], a[128:131], v[128:131]
ds_read_b128 a[200:203], v233 offset:256
s_waitcnt lgkmcnt(10)
v_mfma_f32_16x16x32_bf16 v[132:135], a[184:187], a[132:135], v[132:135]
ds_read_b128 a[164:167], v254 offset:25600
s_waitcnt lgkmcnt(9)
v_mfma_f32_16x16x32_bf16 v[128:131], a[188:191], a[136:139], v[128:131]
buffer_load_dwordx4 v225, s[12:15], s77 offen offset:2048 lds
v_mfma_f32_16x16x32_bf16 v[132:135], a[188:191], a[140:143], v[132:135]
ds_read_b128 a[168:171], v254 offset:28672
ds_read_b128 a[204:207], v234 offset:256
s_waitcnt lgkmcnt(7)
v_mfma_f32_16x16x32_bf16 v[128:131], a[192:195], a[144:147], v[128:131]
ds_read_b128 a[172:175], v254 offset:29696
ds_read_b128 a[208:211], v231 offset:8192
v_mfma_f32_16x16x32_bf16 v[132:135], a[192:195], a[148:151], v[132:135]
ds_read_b128 a[212:215], v232 offset:8192
s_waitcnt lgkmcnt(8)
v_mfma_f32_16x16x32_bf16 v[128:131], a[196:199], a[152:155], v[128:131]
ds_read_b128 a[216:219], v233 offset:8192
v_mfma_f32_16x16x32_bf16 v[132:135], a[196:199], a[156:159], v[132:135]
ds_read_b128 a[220:223], v234 offset:8192
s_waitcnt lgkmcnt(8)
v_mfma_f32_16x16x32_bf16 v[128:131], a[200:203], a[160:163], v[128:131]
ds_read_b128 a[224:227], v231 offset:8448
s_waitcnt lgkmcnt(8)
v_mfma_f32_16x16x32_bf16 v[132:135], a[200:203], a[164:167], v[132:135]
ds_read_b128 a[228:231], v232 offset:8448
s_waitcnt lgkmcnt(7)
v_mfma_f32_16x16x32_bf16 v[128:131], a[204:207], a[168:171], v[128:131]
ds_read_b128 a[232:235], v233 offset:8448
s_waitcnt lgkmcnt(7)
v_mfma_f32_16x16x32_bf16 v[132:135], a[204:207], a[172:175], v[132:135]
ds_read_b128 a[236:239], v234 offset:8448
s_waitcnt lgkmcnt(7)
v_mfma_f32_16x16x32_bf16 v[136:139], a[208:211], a[112:115], 0
buffer_load_dwordx4 v226, s[12:15], s77 offen offset:3072 lds
v_mfma_f32_16x16x32_bf16 v[140:143], a[208:211], a[116:119], 0
s_add_u32 m0, s48, 147456
s_waitcnt lgkmcnt(5)
v_mfma_f32_16x16x32_bf16 v[136:139], a[212:215], a[120:123], v[136:139]
s_mov_b32 s77, 65536
v_max3_f32 v200, v128, v129, v130
v_mfma_f32_16x16x32_bf16 v[140:143], a[212:215], a[124:127], v[140:143]
v_max3_f32 v201, v132, v133, v134
v_mfma_f32_16x16x32_bf16 v[136:139], a[216:219], a[128:131], v[136:139]
ds_read_b128 a[0:3], v252 offset:0
v_mfma_f32_16x16x32_bf16 v[140:143], a[216:219], a[132:135], v[140:143]
ds_read_b128 a[4:7], v252 offset:1024
s_waitcnt lgkmcnt(3)
v_mfma_f32_16x16x32_bf16 v[136:139], a[220:223], a[136:139], v[136:139]
s_waitcnt lgkmcnt(2) vmcnt(4)
s_barrier
v_mfma_f32_16x16x32_bf16 v[140:143], a[220:223], a[140:143], v[140:143]
buffer_load_dwordx4 v223, s[12:15], s70 offen offset:0 lds
v_mfma_f32_16x16x32_bf16 v[136:139], a[224:227], a[144:147], v[136:139]
ds_read_b128 a[240:243], v231 offset:16384
v_mfma_f32_16x16x32_bf16 v[140:143], a[224:227], a[148:151], v[140:143]
ds_read_b128 a[244:247], v232 offset:16384
v_mfma_f32_16x16x32_bf16 v[136:139], a[228:231], a[152:155], v[136:139]
ds_read_b128 a[248:251], v233 offset:16384
v_mfma_f32_16x16x32_bf16 v[140:143], a[228:231], a[156:159], v[140:143]
ds_read_b128 a[252:255], v234 offset:16384
v_mfma_f32_16x16x32_bf16 v[136:139], a[232:235], a[160:163], v[136:139]
ds_read_b128 a[176:179], v231 offset:16640
v_mfma_f32_16x16x32_bf16 v[140:143], a[232:235], a[164:167], v[140:143]
ds_read_b128 a[180:183], v232 offset:16640
v_mfma_f32_16x16x32_bf16 v[136:139], a[236:239], a[168:171], v[136:139]
buffer_load_dwordx4 v224, s[12:15], s70 offen offset:1024 lds
v_mfma_f32_16x16x32_bf16 v[140:143], a[236:239], a[172:175], v[140:143]
ds_read_b128 a[184:187], v233 offset:16640
s_waitcnt lgkmcnt(6)
v_mfma_f32_16x16x32_bf16 v[144:147], a[240:243], a[112:115], 0
ds_read_b128 a[188:191], v234 offset:16640
v_mfma_f32_16x16x32_bf16 v[148:151], a[240:243], a[116:119], 0
ds_read_b128 a[192:195], v231 offset:24576
s_waitcnt lgkmcnt(6)
v_mfma_f32_16x16x32_bf16 v[144:147], a[244:247], a[120:123], v[144:147]
ds_read_b128 a[196:199], v232 offset:24576
v_max3_f32 v200, v200, v131, v136
v_mfma_f32_16x16x32_bf16 v[148:151], a[244:247], a[124:127], v[148:151]
ds_read_b128 a[200:203], v233 offset:24576
v_max3_f32 v200, v200, v137, v138
v_mfma_f32_16x16x32_bf16 v[144:147], a[248:251], a[128:131], v[144:147]
ds_read_b128 a[204:207], v234 offset:24576
v_max_f32 v200, v200, v139
v_mfma_f32_16x16x32_bf16 v[148:151], a[248:251], a[132:135], v[148:151]
ds_read_b128 a[208:211], v231 offset:24832
buffer_load_dwordx4 v225, s[12:15], s70 offen offset:2048 lds
s_waitcnt lgkmcnt(7)
v_mfma_f32_16x16x32_bf16 v[144:147], a[252:255], a[136:139], v[144:147]
ds_read_b128 a[212:215], v232 offset:24832
v_mov_b32 v202, v200
v_mfma_f32_16x16x32_bf16 v[148:151], a[252:255], a[140:143], v[148:151]
ds_read_b128 a[216:219], v233 offset:24832
v_max3_f32 v201, v201, v135, v140
v_mfma_f32_16x16x32_bf16 v[144:147], a[176:179], a[144:147], v[144:147]
ds_read_b128 a[220:223], v234 offset:24832
v_max3_f32 v201, v201, v141, v142
v_mfma_f32_16x16x32_bf16 v[148:151], a[176:179], a[148:151], v[148:151]
v_permlane16_swap_b32 v200, v202
v_mfma_f32_16x16x32_bf16 v[144:147], a[180:183], a[152:155], v[144:147]
v_max_f32 v201, v201, v143
v_mfma_f32_16x16x32_bf16 v[148:151], a[180:183], a[156:159], v[148:151]
v_max_f32 v200, v200, v202
s_waitcnt lgkmcnt(4)
v_mfma_f32_16x16x32_bf16 v[144:147], a[184:187], a[160:163], v[144:147]
buffer_load_dwordx4 v226, s[12:15], s70 offen offset:3072 lds
s_add_u32 m0, s48, 0
v_mfma_f32_16x16x32_bf16 v[148:151], a[184:187], a[164:167], v[148:151]
s_add_u32 s70, s50, s52
v_mov_b32 v203, v201
v_mfma_f32_16x16x32_bf16 v[144:147], a[188:191], a[168:171], v[144:147]
v_mov_b32 v202, v200
v_mfma_f32_16x16x32_bf16 v[148:151], a[188:191], a[172:175], v[148:151]
v_permlane16_swap_b32 v201, v203
v_mfma_f32_16x16x32_bf16 v[152:155], a[192:195], a[112:115], 0
v_permlane32_swap_b32 v200, v202
v_mfma_f32_16x16x32_bf16 v[156:159], a[192:195], a[116:119], 0
v_max_f32 v200, v200, v202
v_mfma_f32_16x16x32_bf16 v[152:155], a[196:199], a[120:123], v[152:155]
v_sub_f32 v184, 0, v200
buffer_load_dwordx4 v227, s[16:19], 0 offen offset:0 lds
v_mfma_f32_16x16x32_bf16 v[156:159], a[196:199], a[124:127], v[156:159]
v_add_f32 v144, v144, v184
v_mfma_f32_16x16x32_bf16 v[152:155], a[200:203], a[128:131], v[152:155]
v_add_f32 v145, v145, v184
v_mfma_f32_16x16x32_bf16 v[156:159], a[200:203], a[132:135], v[156:159]
v_add_f32 v146, v146, v184
v_mfma_f32_16x16x32_bf16 v[152:155], a[204:207], a[136:139], v[152:155]
v_add_f32 v147, v147, v184
v_mfma_f32_16x16x32_bf16 v[156:159], a[204:207], a[140:143], v[156:159]
v_max3_f32 v192, v192, v144, v145
s_waitcnt lgkmcnt(0)
v_mfma_f32_16x16x32_bf16 v[152:155], a[208:211], a[144:147], v[152:155]
v_max3_f32 v192, v192, v146, v147
v_mfma_f32_16x16x32_bf16 v[156:159], a[208:211], a[148:151], v[156:159]
v_sub_f32 v185, 0, v200
buffer_load_dwordx4 v228, s[16:19], 0 offen offset:1024 lds
v_mfma_f32_16x16x32_bf16 v[152:155], a[212:215], a[152:155], v[152:155]
v_sub_f32 v186, 0, v200
v_mfma_f32_16x16x32_bf16 v[156:159], a[212:215], a[156:159], v[156:159]
v_sub_f32 v187, 0, v200
v_mfma_f32_16x16x32_bf16 v[152:155], a[216:219], a[160:163], v[152:155]
v_max_f32 v201, v201, v203
v_mov_b32 v203, v201
v_mfma_f32_16x16x32_bf16 v[156:159], a[216:219], a[164:167], v[156:159]
v_sub_f32 v128, v128, v200
v_sub_f32 v129, v129, v200
v_mfma_f32_16x16x32_bf16 v[152:155], a[220:223], a[168:171], v[152:155]
v_sub_f32 v130, v130, v200
v_sub_f32 v131, v131, v200
v_mfma_f32_16x16x32_bf16 v[156:159], a[220:223], a[172:175], v[156:159]
v_exp_f32 v128, v128
v_exp_f32 v129, v129
v_exp_f32 v130, v130
buffer_load_dwordx4 v229, s[16:19], 0 offen offset:2048 lds
v_exp_f32 v131, v131
v_add_f32 v152, v152, v184
v_add_f32 v153, v153, v184
v_add_f32 v154, v154, v184
v_add_f32 v155, v155, v184
v_max3_f32 v192, v192, v152, v153
v_max3_f32 v192, v192, v154, v155
v_permlane32_swap_b32 v201, v203
v_max_f32 v201, v201, v203
v_sub_f32 v188, 0, v201
v_add_f32 v148, v148, v188
v_add_f32 v149, v149, v188
v_add_f32 v150, v150, v188
v_add_f32 v151, v151, v188
v_max3_f32 v193, v193, v148, v149
v_add_f32 v156, v156, v188
v_add_f32 v157, v157, v188
v_max3_f32 v193, v193, v150, v151
v_add_f32 v158, v158, v188
v_add_f32 v159, v159, v188
v_max3_f32 v193, v193, v156, v157
v_max3_f32 v193, v193, v158, v159
v_sub_f32 v189, 0, v201
v_sub_f32 v190, 0, v201
v_sub_f32 v191, 0, v201
v_sub_f32 v132, v132, v201
buffer_load_dwordx4 v230, s[16:19], 0 offen offset:3072 lds
s_add_u32 m0, s48, 16384
v_sub_f32 v133, v133, v201
v_sub_f32 v134, v134, v201
v_sub_f32 v135, v135, v201
v_cvt_pk_bf16_f32 v160, v128, v129
v_cvt_pk_bf16_f32 v161, v130, v131
v_exp_f32 v132, v132
v_exp_f32 v133, v133
v_exp_f32 v134, v134
v_exp_f32 v135, v135
v_cvt_pk_bf16_f32 v164, v132, v133
v_cvt_pk_bf16_f32 v165, v134, v135
v_sub_f32 v136, v136, v200
v_sub_f32 v137, v137, v200
v_sub_f32 v138, v138, v200
v_sub_f32 v139, v139, v200
v_lshlrev_b32 v200, 7, v255
v_add_u32 v200, s98, v200
s_lshl_b32 s98, s69, 2
s_add_u32 s98, s98, s44
s_mul_i32 s98, s98, 7168
v_cndmask_b32 v200, v195, v200, vcc
v_cmp_gt_u32 vcc, 56, v255
buffer_load_dwordx4 v227, s[16:19], s71 offen offset:0 lds
v_exp_f32 v136, v136
v_exp_f32 v137, v137
v_exp_f32 v138, v138
v_exp_f32 v139, v139
v_sub_f32 v140, v140, v201
v_sub_f32 v141, v141, v201
v_sub_f32 v142, v142, v201
v_sub_f32 v143, v143, v201
v_lshlrev_b32 v201, 7, v255
v_add_u32 v201, s98, v201
s_lshr_b32 s98, s2, 3
s_lshl_b32 s98, s98, 2
s_add_u32 s98, s98, s44
s_mul_i32 s98, s98, 256
s_add_u32 s98, s98, L_final-L_pc
v_cndmask_b32 v201, v195, v201, vcc
v_min_u32 v195, 1, v255
v_lshlrev_b32 v195, 7, v195
v_add_u32 v195, s98, v195
v_min_u32 v195, s99, v195
s_lshl_b32 s98, s44, 2
s_add_u32 s98, s98, 126976
v_cvt_pk_bf16_f32 v162, v136, v137
buffer_load_dwordx4 v228, s[16:19], s71 offen offset:1024 lds
v_cvt_pk_bf16_f32 v163, v138, v139
v_exp_f32 v140, v140
v_exp_f32 v141, v141
v_exp_f32 v142, v142
v_exp_f32 v143, v143
v_cvt_pk_bf16_f32 v166, v140, v141
v_cvt_pk_bf16_f32 v167, v142, v143
ds_read_b128 a[8:11], v252 offset:2048
ds_read_b128 a[12:15], v252 offset:3072
ds_read_b128 a[16:19], v252 offset:4096
ds_read_b128 a[20:23], v252 offset:5120
ds_read_b128 a[24:27], v252 offset:6144
ds_read_b128 a[28:31], v252 offset:7168
ds_read_b128 a[32:35], v252 offset:8192
ds_read_b128 a[36:39], v252 offset:9216
ds_read_b128 a[40:43], v252 offset:10240
buffer_load_dwordx4 v229, s[16:19], s71 offen offset:2048 lds
ds_read_b128 a[44:47], v252 offset:11264
ds_read_b128 a[48:51], v252 offset:12288
ds_read_b128 a[52:55], v252 offset:13312
ds_read_b128 a[56:59], v252 offset:14336
ds_read_b128 a[60:63], v252 offset:15360
ds_read_b128 a[64:67], v252 offset:16384
ds_read_b128 a[68:71], v252 offset:17408
ds_read_b128 a[72:75], v252 offset:18432
ds_read_b128 a[76:79], v252 offset:19456
ds_read_b128 a[80:83], v252 offset:20480
s_waitcnt vmcnt(3)
s_barrier
ds_read_b128 a[224:227], v231 offset:32768
ds_read_b128 a[228:231], v232 offset:32768
ds_read_b128 a[232:235], v233 offset:32768
buffer_load_dwordx4 v230, s[16:19], s71 offen offset:3072 lds
s_add_u32 m0, s48, 32768
s_add_u32 s71, s70, 28672
ds_read_b128 a[236:239], v234 offset:32768
ds_read_b128 a[240:243], v231 offset:33024
ds_read_b128 a[244:247], v232 offset:33024
ds_read_b128 a[248:251], v233 offset:33024
ds_read_b128 a[252:255], v234 offset:33024
ds_read_b128 a[176:179], v231 offset:40960
ds_read_b128 a[180:183], v232 offset:40960
ds_read_b128 a[184:187], v233 offset:40960
ds_read_b128 a[188:191], v234 offset:40960
ds_read_b128 a[192:195], v231 offset:41216
s_waitcnt lgkmcnt(12)
v_mfma_f32_16x16x32_bf16 v[128:131], a[224:227], a[112:115], v[184:187]
ds_read_b128 a[196:199], v232 offset:41216
v_mfma_f32_16x16x32_bf16 v[132:135], a[224:227], a[116:119], v[188:191]
ds_read_b128 a[200:203], v233 offset:41216
s_waitcnt lgkmcnt(12)
v_mfma_f32_16x16x32_bf16 v[128:131], a[228:231], a[120:123], v[128:131]
buffer_load_dwordx4 v227, s[16:19], s72 offen offset:0 lds
v_mfma_f32_16x16x32_bf16 v[132:135], a[228:231], a[124:127], v[132:135]
ds_read_b128 a[204:207], v234 offset:41216
v_mfma_f32_16x16x32_bf16 v[128:131], a[232:235], a[128:131], v[128:131]
ds_read_b64_tr_b16 a[208:209], v236 offset:0
v_mfma_f32_16x16x32_bf16 v[132:135], a[232:235], a[132:135], v[132:135]
ds_read_b64_tr_b16 a[210:211], v236 offset:8192
s_waitcnt lgkmcnt(7)
v_mfma_f32_16x16x32_bf16 v[128:131], a[236:239], a[136:139], v[128:131]
ds_read_b64_tr_b16 a[212:213], v237 offset:0
v_mfma_f32_16x16x32_bf16 v[132:135], a[236:239], a[140:143], v[132:135]
ds_read_b64_tr_b16 a[214:215], v237 offset:8192
v_mfma_f32_16x16x32_bf16 v[128:131], a[240:243], a[144:147], v[128:131]
ds_read_b64_tr_b16 a[216:217], v238 offset:0
v_mfma_f32_16x16x32_bf16 v[132:135], a[240:243], a[148:151], v[132:135]
buffer_load_dwordx4 v228, s[16:19], s72 offen offset:1024 lds
v_mfma_f32_16x16x32_bf16 v[128:131], a[244:247], a[152:155], v[128:131]
ds_read_b64_tr_b16 a[218:219], v238 offset:8192
v_mfma_f32_16x16x32_bf16 v[132:135], a[244:247], a[156:159], v[132:135]
ds_read_b64_tr_b16 a[220:221], v239 offset:0
v_mfma_f32_16x16x32_bf16 v[128:131], a[248:251], a[160:163], v[128:131]
ds_read_b64_tr_b16 a[222:223], v239 offset:8192
v_mfma_f32_16x16x32_bf16 v[132:135], a[248:251], a[164:167], v[132:135]
ds_read_b64_tr_b16 a[224:225], v240 offset:0
v_mfma_f32_16x16x32_bf16 v[128:131], a[252:255], a[168:171], v[128:131]
ds_read_b64_tr_b16 a[226:227], v240 offset:8192
v_mfma_f32_16x16x32_bf16 v[132:135], a[252:255], a[172:175], v[132:135]
ds_read_b64_tr_b16 a[228:229], v241 offset:0
v_mfma_f32_16x16x32_bf16 v[136:139], a[176:179], a[112:115], v[184:187]
buffer_load_dwordx4 v229, s[16:19], s72 offen offset:2048 lds
v_mfma_f32_16x16x32_bf16 v[140:143], a[176:179], a[116:119], v[188:191]
ds_read_b64_tr_b16 a[230:231], v241 offset:8192
v_mfma_f32_16x16x32_bf16 v[136:139], a[180:183], a[120:123], v[136:139]
v_max3_f32 v192, v192, v128, v129
v_max3_f32 v192, v192, v130, v131
v_mfma_f32_16x16x32_bf16 v[140:143], a[180:183], a[124:127], v[140:143]
v_max3_f32 v193, v193, v132, v133
v_mfma_f32_16x16x32_bf16 v[136:139], a[184:187], a[128:131], v[136:139]
v_max3_f32 v193, v193, v134, v135
v_mfma_f32_16x16x32_bf16 v[140:143], a[184:187], a[132:135], v[140:143]
ds_read_b64_tr_b16 a[232:233], v242 offset:0
s_waitcnt lgkmcnt(3)
v_mfma_f32_16x16x32_bf16 v[136:139], a[188:191], a[136:139], v[136:139]
ds_read_b64_tr_b16 a[234:235], v242 offset:8192
v_mfma_f32_16x16x32_bf16 v[140:143], a[188:191], a[140:143], v[140:143]
buffer_load_dwordx4 v230, s[16:19], s72 offen offset:3072 lds
v_mfma_f32_16x16x32_bf16 v[136:139], a[192:195], a[144:147], v[136:139]
s_add_u32 m0, s48, 98304
s_mov_b32 s72, 114688
v_mfma_f32_16x16x32_bf16 v[140:143], a[192:195], a[148:151], v[140:143]
ds_read_b64_tr_b16 a[236:237], v243 offset:0
v_mfma_f32_16x16x32_bf16 v[136:139], a[196:199], a[152:155], v[136:139]
ds_read_b64_tr_b16 a[238:239], v243 offset:8192
v_mfma_f32_16x16x32_bf16 v[140:143], a[196:199], a[156:159], v[140:143]
ds_read_b64_tr_b16 a[240:241], v236 offset:256
v_mfma_f32_16x16x32_bf16 v[136:139], a[200:203], a[160:163], v[136:139]
ds_read_b64_tr_b16 a[242:243], v236 offset:8448
v_mfma_f32_16x16x32_bf16 v[140:143], a[200:203], a[164:167], v[140:143]
ds_read_b64_tr_b16 a[244:245], v237 offset:256
v_mfma_f32_16x16x32_bf16 v[136:139], a[204:207], a[168:171], v[136:139]
buffer_load_dwordx4 v223, s[12:15], s73 offen offset:0 lds
v_mfma_f32_16x16x32_bf16 v[140:143], a[204:207], a[172:175], v[140:143]
ds_read_b64_tr_b16 a[246:247], v237 offset:8448
v_mfma_f32_16x16x32_bf16 v[0:3], a[208:211], v[160:163], 0
ds_read_b64_tr_b16 a[248:249], v238 offset:256
v_mfma_f32_16x16x32_bf16 v[4:7], a[208:211], v[164:167], 0
ds_read_b64_tr_b16 a[250:251], v238 offset:8448
v_mfma_f32_16x16x32_bf16 v[8:11], a[212:215], v[160:163], 0
v_max3_f32 v192, v192, v136, v137
v_max3_f32 v192, v192, v138, v139
v_mfma_f32_16x16x32_bf16 v[12:15], a[212:215], v[164:167], 0
v_max3_f32 v193, v193, v140, v141
v_mfma_f32_16x16x32_bf16 v[16:19], a[216:219], v[160:163], 0
v_max3_f32 v193, v193, v142, v143
v_mfma_f32_16x16x32_bf16 v[20:23], a[216:219], v[164:167], 0
buffer_load_dwordx4 v224, s[12:15], s73 offen offset:1024 lds
v_mfma_f32_16x16x32_bf16 v[24:27], a[220:223], v[160:163], 0
ds_read_b64_tr_b16 a[252:253], v239 offset:256
v_mfma_f32_16x16x32_bf16 v[28:31], a[220:223], v[164:167], 0
ds_read_b64_tr_b16 a[254:255], v239 offset:8448
v_mfma_f32_16x16x32_bf16 v[32:35], a[224:227], v[160:163], 0
ds_read_b64_tr_b16 a[176:177], v240 offset:256
v_mfma_f32_16x16x32_bf16 v[36:39], a[224:227], v[164:167], 0
ds_read_b64_tr_b16 a[178:179], v240 offset:8448
s_waitcnt lgkmcnt(4)
v_mfma_f32_16x16x32_bf16 v[40:43], a[228:231], v[160:163], 0
ds_read_b64_tr_b16 a[180:181], v241 offset:256
v_mfma_f32_16x16x32_bf16 v[44:47], a[228:231], v[164:167], 0
ds_read_b64_tr_b16 a[182:183], v241 offset:8448
v_mfma_f32_16x16x32_bf16 v[48:51], a[232:235], v[160:163], 0
buffer_load_dwordx4 v225, s[12:15], s73 offen offset:2048 lds
v_mfma_f32_16x16x32_bf16 v[52:55], a[232:235], v[164:167], 0
ds_read_b128 a[84:87], v252 offset:21504
v_mfma_f32_16x16x32_bf16 v[56:59], a[236:239], v[160:163], 0
ds_read_b128 a[88:91], v252 offset:22528
v_mfma_f32_16x16x32_bf16 v[60:63], a[236:239], v[164:167], 0
ds_read_b128 a[92:95], v252 offset:23552
v_mfma_f32_16x16x32_bf16 v[64:67], a[240:243], v[160:163], 0
ds_read_b128 a[96:99], v252 offset:24576
v_mfma_f32_16x16x32_bf16 v[68:71], a[240:243], v[164:167], 0
ds_read_b128 a[100:103], v252 offset:25600
v_mfma_f32_16x16x32_bf16 v[72:75], a[244:247], v[160:163], 0
ds_read_b128 a[104:107], v252 offset:26624
ds_read_b128 a[108:111], v252 offset:27648
v_mfma_f32_16x16x32_bf16 v[76:79], a[244:247], v[164:167], 0
buffer_load_dwordx4 v226, s[12:15], s73 offen offset:3072 lds
v_mfma_f32_16x16x32_bf16 v[80:83], a[248:251], v[160:163], 0
s_add_u32 m0, s48, 114688
s_mov_b32 s73, 81920
ds_read_b64_tr_b16 a[184:185], v242 offset:256
ds_read_b64_tr_b16 a[186:187], v242 offset:8448
ds_read_b64_tr_b16 a[188:189], v243 offset:256
ds_read_b64_tr_b16 a[190:191], v243 offset:8448
v_mfma_f32_16x16x32_bf16 v[84:87], a[248:251], v[164:167], 0
s_waitcnt lgkmcnt(7)
v_mfma_f32_16x16x32_bf16 v[88:91], a[252:255], v[160:163], 0
v_exp_f32 v144, v144
v_mfma_f32_16x16x32_bf16 v[92:95], a[252:255], v[164:167], 0
v_exp_f32 v145, v145
v_mfma_f32_16x16x32_bf16 v[96:99], a[176:179], v[160:163], 0
buffer_load_dwordx4 v223, s[12:15], s74 offen offset:0 lds
v_mfma_f32_16x16x32_bf16 v[100:103], a[176:179], v[164:167], 0
v_exp_f32 v146, v146
v_mfma_f32_16x16x32_bf16 v[104:107], a[180:183], v[160:163], 0
v_exp_f32 v147, v147
s_cmp_eq_u32 s79, 0
s_cbranch_scc0 L_sig0
s_lshl_b32 s3, s46, 2
s_add_u32 s3, s3, 128
v_mov_b32 v194, 1
s_mov_b64 exec, 1
buffer_atomic_add v194, off, s[4:7], s3
s_mov_b64 exec, -1
L_sig0:
s_waitcnt lgkmcnt(0) vmcnt(9)
s_barrier
v_mfma_f32_16x16x32_bf16 v[108:111], a[180:183], v[164:167], 0
ds_read_b128 a[192:195], v231 offset:49152
v_cvt_pk_bf16_f32 v168, v144, v145
v_mfma_f32_16x16x32_bf16 v[112:115], a[184:187], v[160:163], 0
ds_read_b128 a[196:199], v232 offset:49152
v_cvt_pk_bf16_f32 v169, v146, v147
v_mfma_f32_16x16x32_bf16 v[116:119], a[184:187], v[164:167], 0
ds_read_b128 a[200:203], v233 offset:49152
v_mfma_f32_16x16x32_bf16 v[120:123], a[188:191], v[160:163], 0
buffer_load_dwordx4 v224, s[12:15], s74 offen offset:1024 lds
v_mfma_f32_16x16x32_bf16 v[124:127], a[188:191], v[164:167], 0
ds_read_b128 a[204:207], v234 offset:49152
v_mfma_f32_16x16x32_bf16 v[176:179], v[196:199], v[160:163], 0
v_exp_f32 v148, v148
v_mfma_f32_16x16x32_bf16 v[180:183], v[196:199], v[164:167], 0
ds_read_b128 a[208:211], v231 offset:49408
v_exp_f32 v149, v149
s_waitcnt lgkmcnt(4)
v_mfma_f32_16x16x32_bf16 v[144:147], a[192:195], a[112:115], v[184:187]
v_exp_f32 v150, v150
v_exp_f32 v151, v151
v_cvt_pk_bf16_f32 v172, v148, v149
v_cvt_pk_bf16_f32 v173, v150, v151
v_mfma_f32_16x16x32_bf16 v[148:151], a[192:195], a[116:119], v[188:191]
ds_read_b128 a[212:215], v232 offset:49408
s_waitcnt lgkmcnt(3)
v_mfma_f32_16x16x32_bf16 v[144:147], a[196:199], a[120:123], v[144:147]
buffer_load_dwordx4 v225, s[12:15], s74 offen offset:2048 lds
v_mfma_f32_16x16x32_bf16 v[148:151], a[196:199], a[124:127], v[148:151]
ds_read_b128 a[216:219], v233 offset:49408
v_mfma_f32_16x16x32_bf16 v[144:147], a[200:203], a[128:131], v[144:147]
ds_read_b128 a[220:223], v234 offset:49408
v_mfma_f32_16x16x32_bf16 v[148:151], a[200:203], a[132:135], v[148:151]
ds_read_b128 a[224:227], v231 offset:57344
s_waitcnt lgkmcnt(4)
v_mfma_f32_16x16x32_bf16 v[144:147], a[204:207], a[136:139], v[144:147]
ds_read_b128 a[228:231], v232 offset:57344
v_mfma_f32_16x16x32_bf16 v[148:151], a[204:207], a[140:143], v[148:151]
ds_read_b128 a[232:235], v233 offset:57344
v_mfma_f32_16x16x32_bf16 v[144:147], a[208:211], a[144:147], v[144:147]
v_exp_f32 v152, v152
v_mfma_f32_16x16x32_bf16 v[148:151], a[208:211], a[148:151], v[148:151]
ds_read_b128 a[236:239], v234 offset:57344
s_waitcnt lgkmcnt(6)
v_mfma_f32_16x16x32_bf16 v[144:147], a[212:215], a[152:155], v[144:147]
buffer_load_dwordx4 v226, s[12:15], s74 offen offset:3072 lds
v_mfma_f32_16x16x32_bf16 v[148:151], a[212:215], a[156:159], v[148:151]
s_add_u32 m0, s48, 49152
s_waitcnt lgkmcnt(4)
v_mfma_f32_16x16x32_bf16 v[144:147], a[216:219], a[160:163], v[144:147]
s_mov_b32 s74, 131072
v_exp_f32 v153, v153
v_mfma_f32_16x16x32_bf16 v[148:151], a[216:219], a[164:167], v[148:151]
v_exp_f32 v154, v154
v_mfma_f32_16x16x32_bf16 v[144:147], a[220:223], a[168:171], v[144:147]
v_exp_f32 v155, v155
v_mfma_f32_16x16x32_bf16 v[148:151], a[220:223], a[172:175], v[148:151]
v_cvt_pk_bf16_f32 v170, v152, v153
v_cvt_pk_bf16_f32 v171, v154, v155
s_waitcnt lgkmcnt(1)
v_mfma_f32_16x16x32_bf16 v[152:155], a[224:227], a[112:115], v[184:187]
v_exp_f32 v156, v156
buffer_load_dwordx4 v227, s[16:19], s75 offen offset:0 lds
v_max3_f32 v192, v192, v144, v145
v_max3_f32 v192, v192, v146, v147
v_max3_f32 v193, v193, v148, v149
v_max3_f32 v193, v193, v150, v151
v_exp_f32 v157, v157
v_exp_f32 v158, v158
v_exp_f32 v159, v159
v_cvt_pk_bf16_f32 v174, v156, v157
v_cvt_pk_bf16_f32 v175, v158, v159
v_mfma_f32_16x16x32_bf16 v[156:159], a[224:227], a[116:119], v[188:191]
ds_read_b128 a[240:243], v231 offset:57600
ds_read_b128 a[244:247], v232 offset:57600
v_mfma_f32_16x16x32_bf16 v[152:155], a[228:231], a[120:123], v[152:155]
ds_read_b128 a[248:251], v233 offset:57600
v_mfma_f32_16x16x32_bf16 v[156:159], a[228:231], a[124:127], v[156:159]
ds_read_b128 a[252:255], v234 offset:57600
v_mfma_f32_16x16x32_bf16 v[152:155], a[232:235], a[128:131], v[152:155]
buffer_load_dwordx4 v228, s[16:19], s75 offen offset:1024 lds
v_mfma_f32_16x16x32_bf16 v[156:159], a[232:235], a[132:135], v[156:159]
ds_read_b64_tr_b16 a[176:177], v236 offset:16384
s_waitcnt lgkmcnt(5)
v_mfma_f32_16x16x32_bf16 v[152:155], a[236:239], a[136:139], v[152:155]
ds_read_b64_tr_b16 a[178:179], v236 offset:24576
v_mfma_f32_16x16x32_bf16 v[156:159], a[236:239], a[140:143], v[156:159]
ds_read_b64_tr_b16 a[180:181], v237 offset:16384
s_waitcnt lgkmcnt(6)
v_mfma_f32_16x16x32_bf16 v[152:155], a[240:243], a[144:147], v[152:155]
ds_read_b64_tr_b16 a[182:183], v237 offset:24576
v_mfma_f32_16x16x32_bf16 v[156:159], a[240:243], a[148:151], v[156:159]
ds_read_b64_tr_b16 a[184:185], v238 offset:16384
s_waitcnt lgkmcnt(6)
v_mfma_f32_16x16x32_bf16 v[152:155], a[244:247], a[152:155], v[152:155]
ds_read_b64_tr_b16 a[186:187], v238 offset:24576
v_mfma_f32_16x16x32_bf16 v[156:159], a[244:247], a[156:159], v[156:159]
buffer_load_dwordx4 v229, s[16:19], s75 offen offset:2048 lds
v_mfma_f32_16x16x32_bf16 v[152:155], a[248:251], a[160:163], v[152:155]
ds_read_b64_tr_b16 a[188:189], v239 offset:16384
v_mfma_f32_16x16x32_bf16 v[156:159], a[248:251], a[164:167], v[156:159]
ds_read_b64_tr_b16 a[190:191], v239 offset:24576
s_waitcnt lgkmcnt(6)
v_mfma_f32_16x16x32_bf16 v[152:155], a[252:255], a[168:171], v[152:155]
ds_read_b64_tr_b16 a[192:193], v240 offset:16384
v_mfma_f32_16x16x32_bf16 v[156:159], a[252:255], a[172:175], v[156:159]
ds_read_b64_tr_b16 a[194:195], v240 offset:24576
v_mfma_f32_16x16x32_bf16 v[0:3], a[176:179], v[168:171], v[0:3]
ds_read_b64_tr_b16 a[196:197], v241 offset:16384
v_mfma_f32_16x16x32_bf16 v[4:7], a[176:179], v[172:175], v[4:7]
ds_read_b64_tr_b16 a[198:199], v241 offset:24576
s_waitcnt lgkmcnt(6)
v_mfma_f32_16x16x32_bf16 v[8:11], a[180:183], v[168:171], v[8:11]
buffer_load_dwordx4 v230, s[16:19], s75 offen offset:3072 lds
v_mfma_f32_16x16x32_bf16 v[12:15], a[180:183], v[172:175], v[12:15]
s_add_u32 m0, s48, 131072
s_mov_b32 s75, 98304
v_mfma_f32_16x16x32_bf16 v[16:19], a[184:187], v[168:171], v[16:19]
buffer_load_dword v205, v200, s[32:35], 0 offen
v_mfma_f32_16x16x32_bf16 v[20:23], a[184:187], v[172:175], v[20:23]
v_max3_f32 v192, v192, v152, v153
ds_read_b64_tr_b16 a[200:201], v242 offset:16384
ds_read_b64_tr_b16 a[202:203], v242 offset:24576
s_waitcnt lgkmcnt(4)
v_mfma_f32_16x16x32_bf16 v[24:27], a[188:191], v[168:171], v[24:27]
v_max3_f32 v193, v193, v156, v157
v_mfma_f32_16x16x32_bf16 v[28:31], a[188:191], v[172:175], v[28:31]
v_max3_f32 v192, v192, v154, v155
ds_read_b64_tr_b16 a[204:205], v243 offset:16384
ds_read_b64_tr_b16 a[206:207], v243 offset:24576
v_mfma_f32_16x16x32_bf16 v[32:35], a[192:195], v[168:171], v[32:35]
v_max3_f32 v193, v193, v158, v159
ds_read_b64_tr_b16 a[208:209], v236 offset:16640
v_mfma_f32_16x16x32_bf16 v[36:39], a[192:195], v[172:175], v[36:39]
ds_read_b64_tr_b16 a[210:211], v236 offset:24832
s_waitcnt lgkmcnt(6)
v_mfma_f32_16x16x32_bf16 v[40:43], a[196:199], v[168:171], v[40:43]
buffer_load_dwordx4 v223, s[12:15], s76 offen offset:0 lds
v_mfma_f32_16x16x32_bf16 v[44:47], a[196:199], v[172:175], v[44:47]
ds_read_b64_tr_b16 a[212:213], v237 offset:16640
ds_read_b64_tr_b16 a[214:215], v237 offset:24832
s_waitcnt lgkmcnt(6)
v_mfma_f32_16x16x32_bf16 v[48:51], a[200:203], v[168:171], v[48:51]
ds_read_b64_tr_b16 a[216:217], v238 offset:16640
ds_read_b64_tr_b16 a[218:219], v238 offset:24832
v_mfma_f32_16x16x32_bf16 v[52:55], a[200:203], v[172:175], v[52:55]
ds_read_b64_tr_b16 a[220:221], v239 offset:16640
s_waitcnt lgkmcnt(7)
v_mfma_f32_16x16x32_bf16 v[56:59], a[204:207], v[168:171], v[56:59]
ds_read_b64_tr_b16 a[222:223], v239 offset:24832
v_mfma_f32_16x16x32_bf16 v[60:63], a[204:207], v[172:175], v[60:63]
ds_read_b64_tr_b16 a[224:225], v240 offset:16640
s_waitcnt lgkmcnt(7)
v_mfma_f32_16x16x32_bf16 v[64:67], a[208:211], v[168:171], v[64:67]
buffer_load_dwordx4 v224, s[12:15], s76 offen offset:1024 lds
v_mfma_f32_16x16x32_bf16 v[68:71], a[208:211], v[172:175], v[68:71]
ds_read_b64_tr_b16 a[226:227], v240 offset:24832
s_waitcnt lgkmcnt(6)
v_mfma_f32_16x16x32_bf16 v[72:75], a[212:215], v[168:171], v[72:75]
ds_read_b64_tr_b16 a[228:229], v241 offset:16640
ds_read_b64_tr_b16 a[230:231], v241 offset:24832
v_mfma_f32_16x16x32_bf16 v[76:79], a[212:215], v[172:175], v[76:79]
ds_read_b64_tr_b16 a[232:233], v242 offset:16640
s_waitcnt lgkmcnt(7)
v_mfma_f32_16x16x32_bf16 v[80:83], a[216:219], v[168:171], v[80:83]
ds_read_b64_tr_b16 a[234:235], v242 offset:24832
ds_read_b64_tr_b16 a[236:237], v243 offset:16640
ds_read_b64_tr_b16 a[238:239], v243 offset:24832
v_mfma_f32_16x16x32_bf16 v[84:87], a[216:219], v[172:175], v[84:87]
s_waitcnt lgkmcnt(7)
v_mfma_f32_16x16x32_bf16 v[88:91], a[220:223], v[168:171], v[88:91]
buffer_load_dwordx4 v225, s[12:15], s76 offen offset:2048 lds
v_mfma_f32_16x16x32_bf16 v[92:95], a[220:223], v[172:175], v[92:95]
s_waitcnt lgkmcnt(6)
v_mfma_f32_16x16x32_bf16 v[96:99], a[224:227], v[168:171], v[96:99]
v_exp_f32 v128, v128
v_mfma_f32_16x16x32_bf16 v[100:103], a[224:227], v[172:175], v[100:103]
s_cmp_eq_u32 s79, 1
s_cbranch_scc0 L_sig1
s_lshl_b32 s3, s46, 2
s_add_u32 s3, s3, 128
v_mov_b32 v194, 1
s_mov_b64 exec, 1
buffer_atomic_add v194, off, s[4:7], s3
s_mov_b64 exec, -1
L_sig1:
s_waitcnt lgkmcnt(3)
v_mfma_f32_16x16x32_bf16 v[104:107], a[228:231], v[168:171], v[104:107]
v_exp_f32 v129, v129
s_waitcnt lgkmcnt(0) vmcnt(12)
s_barrier
v_mfma_f32_16x16x32_bf16 v[108:111], a[228:231], v[172:175], v[108:111]
ds_read_b128 a[240:243], v231 offset:0
v_cvt_pk_bf16_f32 v160, v128, v129
v_mfma_f32_16x16x32_bf16 v[112:115], a[232:235], v[168:171], v[112:115]
buffer_load_dwordx4 v226, s[12:15], s76 offen offset:3072 lds
v_mfma_f32_16x16x32_bf16 v[116:119], a[232:235], v[172:175], v[116:119]
s_add_u32 m0, s48, 0
s_mov_b32 s76, 147456
ds_read_b128 a[244:247], v232 offset:0
v_mfma_f32_16x16x32_bf16 v[120:123], a[236:239], v[168:171], v[120:123]
ds_read_b128 a[248:251], v233 offset:0
v_mfma_f32_16x16x32_bf16 v[124:127], a[236:239], v[172:175], v[124:127]
v_exp_f32 v130, v130
v_mfma_f32_16x16x32_bf16 v[176:179], v[196:199], v[168:171], v[176:179]
v_exp_f32 v131, v131
v_mfma_f32_16x16x32_bf16 v[180:183], v[196:199], v[172:175], v[180:183]
ds_read_b128 a[252:255], v234 offset:0
v_cvt_pk_bf16_f32 v161, v130, v131
s_waitcnt lgkmcnt(3)
v_mfma_f32_16x16x32_bf16 v[128:131], a[240:243], a[112:115], v[184:187]
v_exp_f32 v132, v132
buffer_load_dwordx4 v227, s[16:19], s77 offen offset:0 lds
v_exp_f32 v133, v133
v_exp_f32 v134, v134
v_exp_f32 v135, v135
v_cvt_pk_bf16_f32 v164, v132, v133
v_cvt_pk_bf16_f32 v165, v134, v135
v_mfma_f32_16x16x32_bf16 v[132:135], a[240:243], a[116:119], v[188:191]
ds_read_b128 a[176:179], v231 offset:256
s_waitcnt lgkmcnt(2)
v_mfma_f32_16x16x32_bf16 v[128:131], a[244:247], a[120:123], v[128:131]
ds_read_b128 a[180:183], v232 offset:256
v_mfma_f32_16x16x32_bf16 v[132:135], a[244:247], a[124:127], v[132:135]
ds_read_b128 a[184:187], v233 offset:256
v_mfma_f32_16x16x32_bf16 v[128:131], a[248:251], a[128:131], v[128:131]
ds_read_b128 a[188:191], v234 offset:256
v_mfma_f32_16x16x32_bf16 v[132:135], a[248:251], a[132:135], v[132:135]
ds_read_b128 a[192:195], v231 offset:8192
s_waitcnt lgkmcnt(5)
v_mfma_f32_16x16x32_bf16 v[128:131], a[252:255], a[136:139], v[128:131]
buffer_load_dwordx4 v228, s[16:19], s77 offen offset:1024 lds
v_mfma_f32_16x16x32_bf16 v[132:135], a[252:255], a[140:143], v[132:135]
ds_read_b128 a[196:199], v232 offset:8192
s_waitcnt lgkmcnt(5)
v_mfma_f32_16x16x32_bf16 v[128:131], a[176:179], a[144:147], v[128:131]
ds_read_b128 a[200:203], v233 offset:8192
v_mfma_f32_16x16x32_bf16 v[132:135], a[176:179], a[148:151], v[132:135]
ds_read_b128 a[204:207], v234 offset:8192
s_waitcnt lgkmcnt(6)
v_mfma_f32_16x16x32_bf16 v[128:131], a[180:183], a[152:155], v[128:131]
v_exp_f32 v136, v136
v_mfma_f32_16x16x32_bf16 v[132:135], a[180:183], a[156:159], v[132:135]
ds_read_b128 a[208:211], v231 offset:8448
s_waitcnt lgkmcnt(5)
v_mfma_f32_16x16x32_bf16 v[128:131], a[184:187], a[160:163], v[128:131]
v_exp_f32 v137, v137
v_mfma_f32_16x16x32_bf16 v[132:135], a[184:187], a[164:167], v[132:135]
buffer_load_dwordx4 v229, s[16:19], s77 offen offset:2048 lds
v_mfma_f32_16x16x32_bf16 v[128:131], a[188:191], a[168:171], v[128:131]
v_exp_f32 v138, v138
v_mfma_f32_16x16x32_bf16 v[132:135], a[188:191], a[172:175], v[132:135]
v_exp_f32 v139, v139
v_cvt_pk_bf16_f32 v162, v136, v137
v_cvt_pk_bf16_f32 v163, v138, v139
s_waitcnt lgkmcnt(2)
v_mfma_f32_16x16x32_bf16 v[136:139], a[192:195], a[112:115], v[184:187]
v_exp_f32 v140, v140
v_max3_f32 v192, v192, v128, v129
v_max3_f32 v192, v192, v130, v131
v_max3_f32 v193, v193, v132, v133
v_max3_f32 v193, v193, v134, v135
v_exp_f32 v141, v141
v_exp_f32 v142, v142
v_exp_f32 v143, v143
buffer_load_dwordx4 v230, s[16:19], s77 offen offset:3072 lds
s_add_u32 m0, s49, 65536
s_mov_b32 s77, 114688
v_cvt_pk_bf16_f32 v166, v140, v141
v_cvt_pk_bf16_f32 v167, v142, v143
v_mfma_f32_16x16x32_bf16 v[140:143], a[192:195], a[116:119], v[188:191]
ds_read_b128 a[212:215], v232 offset:8448
v_mfma_f32_16x16x32_bf16 v[136:139], a[196:199], a[120:123], v[136:139]
ds_read_b128 a[216:219], v233 offset:8448
v_mfma_f32_16x16x32_bf16 v[140:143], a[196:199], a[124:127], v[140:143]
ds_read_b128 a[220:223], v234 offset:8448
v_mfma_f32_16x16x32_bf16 v[136:139], a[200:203], a[128:131], v[136:139]
ds_read_b64_tr_b16 a[224:225], v236 offset:32768
v_mfma_f32_16x16x32_bf16 v[140:143], a[200:203], a[132:135], v[140:143]
ds_read_b64_tr_b16 a[226:227], v236 offset:40960
s_waitcnt lgkmcnt(5)
v_mfma_f32_16x16x32_bf16 v[136:139], a[204:207], a[136:139], v[136:139]
buffer_load_dwordx4 v244, s[32:35], s70 offen offset:0 lds
v_mfma_f32_16x16x32_bf16 v[140:143], a[204:207], a[140:143], v[140:143]
ds_read_b64_tr_b16 a[228:229], v237 offset:32768
v_mfma_f32_16x16x32_bf16 v[136:139], a[208:211], a[144:147], v[136:139]
ds_read_b64_tr_b16 a[230:231], v237 offset:40960
v_mfma_f32_16x16x32_bf16 v[140:143], a[208:211], a[148:151], v[140:143]
ds_read_b64_tr_b16 a[232:233], v238 offset:32768
s_waitcnt lgkmcnt(6)
v_mfma_f32_16x16x32_bf16 v[136:139], a[212:215], a[152:155], v[136:139]
ds_read_b64_tr_b16 a[234:235], v238 offset:40960
v_mfma_f32_16x16x32_bf16 v[140:143], a[212:215], a[156:159], v[140:143]
ds_read_b64_tr_b16 a[236:237], v239 offset:32768
v_mfma_f32_16x16x32_bf16 v[136:139], a[216:219], a[160:163], v[136:139]
buffer_load_dwordx4 v245, s[32:35], s70 offen offset:1024 lds
v_mfma_f32_16x16x32_bf16 v[140:143], a[216:219], a[164:167], v[140:143]
ds_read_b64_tr_b16 a[238:239], v239 offset:40960
s_waitcnt lgkmcnt(6)
v_mfma_f32_16x16x32_bf16 v[136:139], a[220:223], a[168:171], v[136:139]
ds_read_b64_tr_b16 a[240:241], v240 offset:32768
v_mfma_f32_16x16x32_bf16 v[140:143], a[220:223], a[172:175], v[140:143]
ds_read_b64_tr_b16 a[242:243], v240 offset:40960
v_mfma_f32_16x16x32_bf16 v[0:3], a[224:227], v[160:163], v[0:3]
ds_read_b64_tr_b16 a[244:245], v241 offset:32768
v_mfma_f32_16x16x32_bf16 v[4:7], a[224:227], v[164:167], v[4:7]
ds_read_b64_tr_b16 a[246:247], v241 offset:40960
buffer_load_dwordx4 v246, s[32:35], s70 offen offset:2048 lds
s_waitcnt lgkmcnt(6)
v_mfma_f32_16x16x32_bf16 v[8:11], a[228:231], v[160:163], v[8:11]
v_max3_f32 v192, v192, v136, v137
v_max3_f32 v193, v193, v140, v141
v_mfma_f32_16x16x32_bf16 v[12:15], a[228:231], v[164:167], v[12:15]
v_max3_f32 v192, v192, v138, v139
v_mfma_f32_16x16x32_bf16 v[16:19], a[232:235], v[160:163], v[16:19]
v_max3_f32 v193, v193, v142, v143
ds_read_b64_tr_b16 a[248:249], v242 offset:32768
v_mfma_f32_16x16x32_bf16 v[20:23], a[232:235], v[164:167], v[20:23]
ds_read_b64_tr_b16 a[250:251], v242 offset:40960
s_waitcnt lgkmcnt(5)
v_mfma_f32_16x16x32_bf16 v[24:27], a[236:239], v[160:163], v[24:27]
ds_read_b64_tr_b16 a[252:253], v243 offset:32768
ds_read_b64_tr_b16 a[254:255], v243 offset:40960
buffer_load_dwordx4 v247, s[32:35], s70 offen offset:3072 lds
s_add_u32 m0, s49, 69632
v_mfma_f32_16x16x32_bf16 v[28:31], a[236:239], v[164:167], v[28:31]
s_add_u32 s70, s50, s53
s_waitcnt lgkmcnt(5)
v_mfma_f32_16x16x32_bf16 v[32:35], a[240:243], v[160:163], v[32:35]
ds_read_b64_tr_b16 a[176:177], v236 offset:33024
ds_read_b64_tr_b16 a[178:179], v236 offset:41216
v_mfma_f32_16x16x32_bf16 v[36:39], a[240:243], v[164:167], v[36:39]
ds_read_b64_tr_b16 a[180:181], v237 offset:33024
s_waitcnt lgkmcnt(7)
v_mfma_f32_16x16x32_bf16 v[40:43], a[244:247], v[160:163], v[40:43]
ds_read_b64_tr_b16 a[182:183], v237 offset:41216
v_mfma_f32_16x16x32_bf16 v[44:47], a[244:247], v[164:167], v[44:47]
ds_read_b64_tr_b16 a[184:185], v238 offset:33024
buffer_load_dwordx4 v244, s[32:35], s71 offen offset:0 lds
s_waitcnt lgkmcnt(7)
v_mfma_f32_16x16x32_bf16 v[48:51], a[248:251], v[160:163], v[48:51]
ds_read_b64_tr_b16 a[186:187], v238 offset:41216
v_mfma_f32_16x16x32_bf16 v[52:55], a[248:251], v[164:167], v[52:55]
ds_read_b64_tr_b16 a[188:189], v239 offset:33024
s_waitcnt lgkmcnt(7)
v_mfma_f32_16x16x32_bf16 v[56:59], a[252:255], v[160:163], v[56:59]
ds_read_b64_tr_b16 a[190:191], v239 offset:41216
v_mfma_f32_16x16x32_bf16 v[60:63], a[252:255], v[164:167], v[60:63]
ds_read_b64_tr_b16 a[192:193], v240 offset:33024
s_waitcnt lgkmcnt(7)
v_mfma_f32_16x16x32_bf16 v[64:67], a[176:179], v[160:163], v[64:67]
ds_read_b64_tr_b16 a[194:195], v240 offset:41216
buffer_load_dwordx4 v245, s[32:35], s71 offen offset:1024 lds
v_mfma_f32_16x16x32_bf16 v[68:71], a[176:179], v[164:167], v[68:71]
ds_read_b64_tr_b16 a[196:197], v241 offset:33024
s_waitcnt lgkmcnt(7)
v_mfma_f32_16x16x32_bf16 v[72:75], a[180:183], v[160:163], v[72:75]
ds_read_b64_tr_b16 a[198:199], v241 offset:41216
ds_read_b64_tr_b16 a[200:201], v242 offset:33024
v_mfma_f32_16x16x32_bf16 v[76:79], a[180:183], v[164:167], v[76:79]
ds_read_b64_tr_b16 a[202:203], v242 offset:41216
s_waitcnt lgkmcnt(8)
v_mfma_f32_16x16x32_bf16 v[80:83], a[184:187], v[160:163], v[80:83]
ds_read_b64_tr_b16 a[204:205], v243 offset:33024
ds_read_b64_tr_b16 a[206:207], v243 offset:41216
v_mfma_f32_16x16x32_bf16 v[84:87], a[184:187], v[164:167], v[84:87]
buffer_load_dwordx4 v246, s[32:35], s71 offen offset:2048 lds
s_waitcnt lgkmcnt(8)
v_mfma_f32_16x16x32_bf16 v[88:91], a[188:191], v[160:163], v[88:91]
s_add_u32 m0, s48, 147456
s_add_u32 s71, s70, 28672
v_mfma_f32_16x16x32_bf16 v[92:95], a[188:191], v[164:167], v[92:95]
s_waitcnt lgkmcnt(6)
v_mfma_f32_16x16x32_bf16 v[96:99], a[192:195], v[160:163], v[96:99]
v_exp_f32 v144, v144
v_mfma_f32_16x16x32_bf16 v[100:103], a[192:195], v[164:167], v[100:103]
s_cmp_eq_u32 s79, 2
s_cbranch_scc0 L_sig2
s_lshl_b32 s3, s46, 2
s_add_u32 s3, s3, 128
v_mov_b32 v194, 1
s_mov_b64 exec, 1
buffer_atomic_add v194, off, s[4:7], s3
s_mov_b64 exec, -1
L_sig2:
s_waitcnt lgkmcnt(3)
v_mfma_f32_16x16x32_bf16 v[104:107], a[196:199], v[160:163], v[104:107]
v_exp_f32 v145, v145
v_mfma_f32_16x16x32_bf16 v[108:111], a[196:199], v[164:167], v[108:111]
v_cvt_pk_bf16_f32 v168, v144, v145
s_waitcnt lgkmcnt(0)
v_mfma_f32_16x16x32_bf16 v[112:115], a[200:203], v[160:163], v[112:115]
buffer_load_dwordx4 v223, s[12:15], s72 offen offset:0 lds
v_mfma_f32_16x16x32_bf16 v[116:119], a[200:203], v[164:167], v[116:119]
v_exp_f32 v146, v146
v_mfma_f32_16x16x32_bf16 v[120:123], a[204:207], v[160:163], v[120:123]
v_exp_f32 v147, v147
v_mfma_f32_16x16x32_bf16 v[124:127], a[204:207], v[164:167], v[124:127]
v_cvt_pk_bf16_f32 v169, v146, v147
v_mfma_f32_16x16x32_bf16 v[176:179], v[196:199], v[160:163], v[176:179]
v_exp_f32 v148, v148
v_mfma_f32_16x16x32_bf16 v[180:183], v[196:199], v[164:167], v[180:183]
v_exp_f32 v149, v149
v_exp_f32 v150, v150
v_exp_f32 v151, v151
v_cvt_pk_bf16_f32 v172, v148, v149
buffer_load_dwordx4 v224, s[12:15], s72 offen offset:1024 lds
v_cvt_pk_bf16_f32 v173, v150, v151
v_exp_f32 v152, v152
v_exp_f32 v153, v153
v_exp_f32 v154, v154
v_exp_f32 v155, v155
v_cvt_pk_bf16_f32 v170, v152, v153
v_cvt_pk_bf16_f32 v171, v154, v155
v_exp_f32 v156, v156
v_exp_f32 v157, v157
v_exp_f32 v158, v158
v_exp_f32 v159, v159
v_cvt_pk_bf16_f32 v174, v156, v157
v_cvt_pk_bf16_f32 v175, v158, v159
v_exp_f32 v128, v128
v_exp_f32 v129, v129
v_exp_f32 v130, v130
buffer_load_dwordx4 v225, s[12:15], s72 offen offset:2048 lds
v_exp_f32 v131, v131
v_cvt_pk_bf16_f32 v160, v128, v129
v_cvt_pk_bf16_f32 v161, v130, v131
v_exp_f32 v132, v132
v_exp_f32 v133, v133
v_exp_f32 v134, v134
v_exp_f32 v135, v135
v_cvt_pk_bf16_f32 v164, v132, v133
v_cvt_pk_bf16_f32 v165, v134, v135
v_exp_f32 v136, v136
v_exp_f32 v137, v137
s_waitcnt vmcnt(3)
s_barrier
ds_read_b128 a[208:211], v231 offset:16384
ds_read_b128 a[212:215], v232 offset:16384
ds_read_b128 a[216:219], v233 offset:16384
ds_read_b128 a[220:223], v234 offset:16384
buffer_load_dwordx4 v226, s[12:15], s72 offen offset:3072 lds
s_add_u32 m0, s48, 16384
s_mov_b32 s72, 163840
ds_read_b128 a[224:227], v231 offset:16640
ds_read_b128 a[228:231], v232 offset:16640
ds_read_b128 a[232:235], v233 offset:16640
ds_read_b128 a[236:239], v234 offset:16640
ds_read_b128 a[240:243], v231 offset:24576
ds_read_b128 a[244:247], v232 offset:24576
ds_read_b128 a[248:251], v233 offset:24576
ds_read_b128 a[252:255], v234 offset:24576
ds_read_b128 a[176:179], v231 offset:24832
s_waitcnt lgkmcnt(12)
v_mfma_f32_16x16x32_bf16 v[144:147], a[208:211], a[112:115], v[184:187]
ds_read_b128 a[180:183], v232 offset:24832
v_cvt_pk_bf16_f32 v162, v136, v137
v_mfma_f32_16x16x32_bf16 v[148:151], a[208:211], a[116:119], v[188:191]
ds_read_b128 a[184:187], v233 offset:24832
s_waitcnt lgkmcnt(12)
v_mfma_f32_16x16x32_bf16 v[144:147], a[212:215], a[120:123], v[144:147]
buffer_load_dwordx4 v227, s[16:19], s73 offen offset:0 lds
v_mfma_f32_16x16x32_bf16 v[148:151], a[212:215], a[124:127], v[148:151]
ds_read_b128 a[188:191], v234 offset:24832
v_mfma_f32_16x16x32_bf16 v[144:147], a[216:219], a[128:131], v[144:147]
ds_read_b64_tr_b16 a[192:193], v236 offset:49152
v_mfma_f32_16x16x32_bf16 v[148:151], a[216:219], a[132:135], v[148:151]
ds_read_b64_tr_b16 a[194:195], v236 offset:57344
s_waitcnt lgkmcnt(7)
v_mfma_f32_16x16x32_bf16 v[144:147], a[220:223], a[136:139], v[144:147]
ds_read_b64_tr_b16 a[196:197], v237 offset:49152
v_mfma_f32_16x16x32_bf16 v[148:151], a[220:223], a[140:143], v[148:151]
ds_read_b64_tr_b16 a[198:199], v237 offset:57344
v_mfma_f32_16x16x32_bf16 v[144:147], a[224:227], a[144:147], v[144:147]
ds_read_b64_tr_b16 a[200:201], v238 offset:49152
v_mfma_f32_16x16x32_bf16 v[148:151], a[224:227], a[148:151], v[148:151]
buffer_load_dwordx4 v228, s[16:19], s73 offen offset:1024 lds
v_mfma_f32_16x16x32_bf16 v[144:147], a[228:231], a[152:155], v[144:147]
ds_read_b64_tr_b16 a[202:203], v238 offset:57344
v_mfma_f32_16x16x32_bf16 v[148:151], a[228:231], a[156:159], v[148:151]
ds_read_b64_tr_b16 a[204:205], v239 offset:49152
v_mfma_f32_16x16x32_bf16 v[144:147], a[232:235], a[160:163], v[144:147]
ds_read_b64_tr_b16 a[206:207], v239 offset:57344
v_mfma_f32_16x16x32_bf16 v[148:151], a[232:235], a[164:167], v[148:151]
ds_read_b64_tr_b16 a[208:209], v240 offset:49152
v_mfma_f32_16x16x32_bf16 v[144:147], a[236:239], a[168:171], v[144:147]
ds_read_b64_tr_b16 a[210:211], v240 offset:57344
v_mfma_f32_16x16x32_bf16 v[148:151], a[236:239], a[172:175], v[148:151]
ds_read_b64_tr_b16 a[212:213], v241 offset:49152
v_mfma_f32_16x16x32_bf16 v[152:155], a[240:243], a[112:115], v[184:187]
buffer_load_dwordx4 v229, s[16:19], s73 offen offset:2048 lds
v_mfma_f32_16x16x32_bf16 v[156:159], a[240:243], a[116:119], v[188:191]
ds_read_b64_tr_b16 a[214:215], v241 offset:57344
v_mfma_f32_16x16x32_bf16 v[152:155], a[244:247], a[120:123], v[152:155]
v_max3_f32 v192, v192, v144, v145
v_max3_f32 v192, v192, v146, v147
v_mfma_f32_16x16x32_bf16 v[156:159], a[244:247], a[124:127], v[156:159]
v_max3_f32 v193, v193, v148, v149
v_mfma_f32_16x16x32_bf16 v[152:155], a[248:251], a[128:131], v[152:155]
v_max3_f32 v193, v193, v150, v151
v_mfma_f32_16x16x32_bf16 v[156:159], a[248:251], a[132:135], v[156:159]
ds_read_b64_tr_b16 a[216:217], v242 offset:49152
s_waitcnt lgkmcnt(3)
v_mfma_f32_16x16x32_bf16 v[152:155], a[252:255], a[136:139], v[152:155]
ds_read_b64_tr_b16 a[218:219], v242 offset:57344
v_mfma_f32_16x16x32_bf16 v[156:159], a[252:255], a[140:143], v[156:159]
buffer_load_dwordx4 v230, s[16:19], s73 offen offset:3072 lds
v_mfma_f32_16x16x32_bf16 v[152:155], a[176:179], a[144:147], v[152:155]
s_add_u32 m0, s48, 98304
s_mov_b32 s73, 131072
v_mfma_f32_16x16x32_bf16 v[156:159], a[176:179], a[148:151], v[156:159]
ds_read_b64_tr_b16 a[220:221], v243 offset:49152
v_mfma_f32_16x16x32_bf16 v[152:155], a[180:183], a[152:155], v[152:155]
ds_read_b64_tr_b16 a[222:223], v243 offset:57344
v_mfma_f32_16x16x32_bf16 v[156:159], a[180:183], a[156:159], v[156:159]
ds_read_b64_tr_b16 a[224:225], v236 offset:49408
v_mfma_f32_16x16x32_bf16 v[152:155], a[184:187], a[160:163], v[152:155]
ds_read_b64_tr_b16 a[226:227], v236 offset:57600
v_mfma_f32_16x16x32_bf16 v[156:159], a[184:187], a[164:167], v[156:159]
ds_read_b64_tr_b16 a[228:229], v237 offset:49408
v_mfma_f32_16x16x32_bf16 v[152:155], a[188:191], a[168:171], v[152:155]
buffer_load_dwordx4 v223, s[12:15], s74 offen offset:0 lds
v_mfma_f32_16x16x32_bf16 v[156:159], a[188:191], a[172:175], v[156:159]
ds_read_b64_tr_b16 a[230:231], v237 offset:57600
v_mfma_f32_16x16x32_bf16 v[0:3], a[192:195], v[168:171], v[0:3]
ds_read_b64_tr_b16 a[232:233], v238 offset:49408
v_mfma_f32_16x16x32_bf16 v[4:7], a[192:195], v[172:175], v[4:7]
ds_read_b64_tr_b16 a[234:235], v238 offset:57600
v_mfma_f32_16x16x32_bf16 v[8:11], a[196:199], v[168:171], v[8:11]
v_max3_f32 v192, v192, v152, v153
v_max3_f32 v192, v192, v154, v155
v_mfma_f32_16x16x32_bf16 v[12:15], a[196:199], v[172:175], v[12:15]
v_max3_f32 v193, v193, v156, v157
v_mfma_f32_16x16x32_bf16 v[16:19], a[200:203], v[168:171], v[16:19]
v_max3_f32 v193, v193, v158, v159
v_mfma_f32_16x16x32_bf16 v[20:23], a[200:203], v[172:175], v[20:23]
buffer_load_dwordx4 v224, s[12:15], s74 offen offset:1024 lds
v_mfma_f32_16x16x32_bf16 v[24:27], a[204:207], v[168:171], v[24:27]
ds_read_b64_tr_b16 a[236:237], v239 offset:49408
v_mfma_f32_16x16x32_bf16 v[28:31], a[204:207], v[172:175], v[28:31]
ds_read_b64_tr_b16 a[238:239], v239 offset:57600
v_mfma_f32_16x16x32_bf16 v[32:35], a[208:211], v[168:171], v[32:35]
ds_read_b64_tr_b16 a[240:241], v240 offset:49408
v_mfma_f32_16x16x32_bf16 v[36:39], a[208:211], v[172:175], v[36:39]
ds_read_b64_tr_b16 a[242:243], v240 offset:57600
s_waitcnt lgkmcnt(4)
v_mfma_f32_16x16x32_bf16 v[40:43], a[212:215], v[168:171], v[40:43]
ds_read_b64_tr_b16 a[244:245], v241 offset:49408
v_mfma_f32_16x16x32_bf16 v[44:47], a[212:215], v[172:175], v[44:47]
ds_read_b64_tr_b16 a[246:247], v241 offset:57600
v_mfma_f32_16x16x32_bf16 v[48:51], a[216:219], v[168:171], v[48:51]
buffer_load_dwordx4 v225, s[12:15], s74 offen offset:2048 lds
v_mfma_f32_16x16x32_bf16 v[52:55], a[216:219], v[172:175], v[52:55]
ds_read_b64_tr_b16 a[248:249], v242 offset:49408
v_mfma_f32_16x16x32_bf16 v[56:59], a[220:223], v[168:171], v[56:59]
ds_read_b64_tr_b16 a[250:251], v242 offset:57600
v_mfma_f32_16x16x32_bf16 v[60:63], a[220:223], v[172:175], v[60:63]
ds_read_b64_tr_b16 a[252:253], v243 offset:49408
v_mfma_f32_16x16x32_bf16 v[64:67], a[224:227], v[168:171], v[64:67]
ds_read_b64_tr_b16 a[254:255], v243 offset:57600
v_mfma_f32_16x16x32_bf16 v[68:71], a[224:227], v[172:175], v[68:71]
ds_read_b64_tr_b16 a[176:177], v249 offset:0
v_mfma_f32_16x16x32_bf16 v[72:75], a[228:231], v[168:171], v[72:75]
ds_read_b64_tr_b16 a[178:179], v249 offset:2048
v_mfma_f32_16x16x32_bf16 v[76:79], a[228:231], v[172:175], v[76:79]
buffer_load_dwordx4 v226, s[12:15], s74 offen offset:3072 lds
v_mfma_f32_16x16x32_bf16 v[80:83], a[232:235], v[168:171], v[80:83]
s_add_u32 m0, s48, 32768
s_mov_b32 s74, 180224
v_mfma_f32_16x16x32_bf16 v[84:87], a[232:235], v[172:175], v[84:87]
ds_read_b64_tr_b16 a[180:181], v249 offset:4096
s_waitcnt lgkmcnt(5)
v_mfma_f32_16x16x32_bf16 v[88:91], a[236:239], v[168:171], v[88:91]
ds_read_b64_tr_b16 a[182:183], v249 offset:6144
v_mfma_f32_16x16x32_bf16 v[92:95], a[236:239], v[172:175], v[92:95]
ds_read_b64_tr_b16 a[184:185], v249 offset:8192
v_mfma_f32_16x16x32_bf16 v[96:99], a[240:243], v[168:171], v[96:99]
ds_read_b64_tr_b16 a[186:187], v249 offset:10240
v_mfma_f32_16x16x32_bf16 v[100:103], a[240:243], v[172:175], v[100:103]
ds_read_b64_tr_b16 a[188:189], v249 offset:12288
v_mfma_f32_16x16x32_bf16 v[104:107], a[244:247], v[168:171], v[104:107]
buffer_load_dwordx4 v227, s[16:19], s75 offen offset:0 lds
v_mfma_f32_16x16x32_bf16 v[108:111], a[244:247], v[172:175], v[108:111]
ds_read_b64_tr_b16 a[190:191], v249 offset:14336
v_mfma_f32_16x16x32_bf16 v[112:115], a[248:251], v[168:171], v[112:115]
ds_read_b64_tr_b16 a[192:193], v249 offset:16384
v_mfma_f32_16x16x32_bf16 v[116:119], a[248:251], v[172:175], v[116:119]
ds_read_b64_tr_b16 a[194:195], v249 offset:18432
s_waitcnt lgkmcnt(6)
v_mfma_f32_16x16x32_bf16 v[120:123], a[252:255], v[168:171], v[120:123]
ds_read_b64_tr_b16 a[196:197], v249 offset:20480
v_mfma_f32_16x16x32_bf16 v[124:127], a[252:255], v[172:175], v[124:127]
ds_read_b64_tr_b16 a[198:199], v249 offset:22528
v_mfma_f32_16x16x32_bf16 v[176:179], v[196:199], v[168:171], v[176:179]
ds_read_b64_tr_b16 a[200:201], v249 offset:24576
v_mfma_f32_16x16x32_bf16 v[180:183], v[196:199], v[172:175], v[180:183]
buffer_load_dwordx4 v228, s[16:19], s75 offen offset:1024 lds
v_mfma_f32_16x16x32_bf16 v[206:209], a[176:179], a[0:3], 0
ds_read_b64_tr_b16 a[202:203], v249 offset:26624
v_mfma_f32_16x16x32_bf16 v[210:213], a[176:179], a[4:7], 0
v_exp_f32 v138, v138
v_mfma_f32_16x16x32_bf16 v[214:217], a[176:179], a[8:11], 0
v_exp_f32 v139, v139
v_mfma_f32_16x16x32_bf16 v[218:221], a[176:179], a[12:15], 0
v_cvt_pk_bf16_f32 v163, v138, v139
v_mfma_f32_16x16x32_bf16 v[206:209], a[180:183], a[16:19], v[206:209]
v_exp_f32 v140, v140
v_mfma_f32_16x16x32_bf16 v[210:213], a[180:183], a[20:23], v[210:213]
v_exp_f32 v141, v141
v_mfma_f32_16x16x32_bf16 v[214:217], a[180:183], a[24:27], v[214:217]
buffer_load_dwordx4 v229, s[16:19], s75 offen offset:2048 lds
v_mfma_f32_16x16x32_bf16 v[218:221], a[180:183], a[28:31], v[218:221]
v_cvt_pk_bf16_f32 v166, v140, v141
s_waitcnt lgkmcnt(0)
v_mfma_f32_16x16x32_bf16 v[206:209], a[184:187], a[32:35], v[206:209]
v_exp_f32 v142, v142
v_mfma_f32_16x16x32_bf16 v[210:213], a[184:187], a[36:39], v[210:213]
v_exp_f32 v143, v143
v_mfma_f32_16x16x32_bf16 v[214:217], a[184:187], a[40:43], v[214:217]
v_cvt_pk_bf16_f32 v167, v142, v143
v_mfma_f32_16x16x32_bf16 v[218:221], a[184:187], a[44:47], v[218:221]
v_exp_f32 v144, v144
v_mfma_f32_16x16x32_bf16 v[206:209], a[188:191], a[48:51], v[206:209]
v_exp_f32 v145, v145
v_mfma_f32_16x16x32_bf16 v[210:213], a[188:191], a[52:55], v[210:213]
buffer_load_dwordx4 v230, s[16:19], s75 offen offset:3072 lds
v_mfma_f32_16x16x32_bf16 v[214:217], a[188:191], a[56:59], v[214:217]
s_add_u32 m0, s48, 114688
s_mov_b32 s75, 147456
v_mfma_f32_16x16x32_bf16 v[218:221], a[188:191], a[60:63], v[218:221]
v_exp_f32 v146, v146
v_mfma_f32_16x16x32_bf16 v[206:209], a[192:195], a[64:67], v[206:209]
v_exp_f32 v147, v147
v_mfma_f32_16x16x32_bf16 v[210:213], a[192:195], a[68:71], v[210:213]
v_cvt_pk_bf16_f32 v168, v144, v145
v_mfma_f32_16x16x32_bf16 v[214:217], a[192:195], a[72:75], v[214:217]
v_cvt_pk_bf16_f32 v169, v146, v147
v_mfma_f32_16x16x32_bf16 v[218:221], a[192:195], a[76:79], v[218:221]
v_exp_f32 v148, v148
v_mfma_f32_16x16x32_bf16 v[206:209], a[196:199], a[80:83], v[206:209]
v_exp_f32 v149, v149
s_cmp_eq_u32 s79, 3
s_cbranch_scc0 L_sig3
s_lshl_b32 s3, s46, 2
s_add_u32 s3, s3, 128
v_mov_b32 v194, 1
s_mov_b64 exec, 1
buffer_atomic_add v194, off, s[4:7], s3
s_mov_b64 exec, -1
L_sig3:
s_barrier
v_mfma_f32_16x16x32_bf16 v[210:213], a[196:199], a[84:87], v[210:213]
buffer_load_dwordx4 v223, s[12:15], s76 offen offset:0 lds
ds_read_b128 a[204:207], v231 offset:32768
v_mfma_f32_16x16x32_bf16 v[214:217], a[196:199], a[88:91], v[214:217]
ds_read_b128 a[208:211], v232 offset:32768
v_cvt_pk_bf16_f32 v172, v148, v149
v_mfma_f32_16x16x32_bf16 v[218:221], a[196:199], a[92:95], v[218:221]
ds_read_b128 a[212:215], v233 offset:32768
v_mfma_f32_16x16x32_bf16 v[206:209], a[200:203], a[96:99], v[206:209]
ds_read_b128 a[216:219], v234 offset:32768
v_mfma_f32_16x16x32_bf16 v[210:213], a[200:203], a[100:103], v[210:213]
ds_read_b128 a[220:223], v231 offset:33024
v_mfma_f32_16x16x32_bf16 v[214:217], a[200:203], a[104:107], v[214:217]
ds_read_b128 a[224:227], v232 offset:33024
v_mfma_f32_16x16x32_bf16 v[218:221], a[200:203], a[108:111], v[218:221]
ds_read_b128 a[228:231], v233 offset:33024
ds_read_b128 a[232:235], v234 offset:33024
buffer_load_dwordx4 v224, s[12:15], s76 offen offset:1024 lds
s_waitcnt lgkmcnt(7)
v_mfma_f32_16x16x32_bf16 v[128:131], a[204:207], a[112:115], v[184:187]
v_cvt_pk_bf16_f32 v206, v206, v207
v_cvt_pk_bf16_f32 v207, v208, v209
v_mfma_f32_16x16x32_bf16 v[132:135], a[204:207], a[116:119], v[188:191]
v_cvt_pk_bf16_f32 v208, v210, v211
s_waitcnt lgkmcnt(6)
v_mfma_f32_16x16x32_bf16 v[128:131], a[208:211], a[120:123], v[128:131]
v_cvt_pk_bf16_f32 v209, v212, v213
v_mfma_f32_16x16x32_bf16 v[132:135], a[208:211], a[124:127], v[132:135]
v_cvt_pk_bf16_f32 v210, v214, v215
s_waitcnt lgkmcnt(4)
v_mfma_f32_16x16x32_bf16 v[128:131], a[212:215], a[128:131], v[128:131]
v_cvt_pk_bf16_f32 v211, v216, v217
v_cvt_pk_bf16_f32 v212, v218, v219
v_mfma_f32_16x16x32_bf16 v[132:135], a[212:215], a[132:135], v[132:135]
v_cvt_pk_bf16_f32 v213, v220, v221
buffer_store_dwordx4 v[206:209], v253, s[36:39], s100 offen offset:0 sc1
v_mfma_f32_16x16x32_bf16 v[128:131], a[216:219], a[136:139], v[128:131]
ds_read_b128 a[236:239], v231 offset:40960
v_mfma_f32_16x16x32_bf16 v[132:135], a[216:219], a[140:143], v[132:135]
ds_read_b128 a[240:243], v232 offset:40960
buffer_store_dwordx4 v[210:213], v253, s[36:39], s100 offen offset:1024 sc1
s_waitcnt lgkmcnt(2)
v_mfma_f32_16x16x32_bf16 v[128:131], a[220:223], a[144:147], v[128:131]
ds_read_b128 a[244:247], v233 offset:40960
s_add_u32 s100, s60, 8192
v_mfma_f32_16x16x32_bf16 v[132:135], a[220:223], a[148:151], v[132:135]
ds_read_b128 a[248:251], v234 offset:40960
v_mfma_f32_16x16x32_bf16 v[128:131], a[224:227], a[152:155], v[128:131]
ds_read_b128 a[252:255], v231 offset:41216
v_mfma_f32_16x16x32_bf16 v[132:135], a[224:227], a[156:159], v[132:135]
ds_read_b128 a[176:179], v232 offset:41216
v_mfma_f32_16x16x32_bf16 v[128:131], a[228:231], a[160:163], v[128:131]
ds_read_b128 a[180:183], v233 offset:41216
v_mfma_f32_16x16x32_bf16 v[132:135], a[228:231], a[164:167], v[132:135]
ds_read_b128 a[184:187], v234 offset:41216
v_mfma_f32_16x16x32_bf16 v[128:131], a[232:235], a[168:171], v[128:131]
buffer_load_dwordx4 v225, s[12:15], s76 offen offset:2048 lds
v_mfma_f32_16x16x32_bf16 v[132:135], a[232:235], a[172:175], v[132:135]
ds_read_b64_tr_b16 a[188:189], v236 offset:0
s_waitcnt lgkmcnt(6)
v_mfma_f32_16x16x32_bf16 v[136:139], a[236:239], a[112:115], v[184:187]
ds_read_b64_tr_b16 a[190:191], v236 offset:8192
v_mfma_f32_16x16x32_bf16 v[140:143], a[236:239], a[116:119], v[188:191]
ds_read_b64_tr_b16 a[192:193], v237 offset:0
v_max3_f32 v192, v192, v128, v129
v_mfma_f32_16x16x32_bf16 v[136:139], a[240:243], a[120:123], v[136:139]
v_max3_f32 v193, v193, v132, v133
v_mfma_f32_16x16x32_bf16 v[140:143], a[240:243], a[124:127], v[140:143]
v_max3_f32 v192, v192, v130, v131
v_mfma_f32_16x16x32_bf16 v[136:139], a[244:247], a[128:131], v[136:139]
v_max3_f32 v193, v193, v134, v135
v_mfma_f32_16x16x32_bf16 v[140:143], a[244:247], a[132:135], v[140:143]
ds_read_b64_tr_b16 a[194:195], v237 offset:8192
s_waitcnt lgkmcnt(4)
v_mfma_f32_16x16x32_bf16 v[136:139], a[248:251], a[136:139], v[136:139]
buffer_load_dwordx4 v226, s[12:15], s76 offen offset:3072 lds
v_mfma_f32_16x16x32_bf16 v[140:143], a[248:251], a[140:143], v[140:143]
s_add_u32 m0, s48, 49152
s_mov_b32 s76, 196608
v_mfma_f32_16x16x32_bf16 v[136:139], a[252:255], a[144:147], v[136:139]
ds_read_b64_tr_b16 a[196:197], v238 offset:0
v_mfma_f32_16x16x32_bf16 v[140:143], a[252:255], a[148:151], v[140:143]
ds_read_b64_tr_b16 a[198:199], v238 offset:8192
v_mfma_f32_16x16x32_bf16 v[136:139], a[176:179], a[152:155], v[136:139]
ds_read_b64_tr_b16 a[200:201], v239 offset:0
v_mfma_f32_16x16x32_bf16 v[140:143], a[176:179], a[156:159], v[140:143]
ds_read_b64_tr_b16 a[202:203], v239 offset:8192
v_mfma_f32_16x16x32_bf16 v[136:139], a[180:183], a[160:163], v[136:139]
ds_read_b64_tr_b16 a[204:205], v240 offset:0
v_mfma_f32_16x16x32_bf16 v[140:143], a[180:183], a[164:167], v[140:143]
buffer_load_dwordx4 v227, s[16:19], s77 offen offset:0 lds
v_mfma_f32_16x16x32_bf16 v[136:139], a[184:187], a[168:171], v[136:139]
ds_read_b64_tr_b16 a[206:207], v240 offset:8192
v_mfma_f32_16x16x32_bf16 v[140:143], a[184:187], a[172:175], v[140:143]
ds_read_b64_tr_b16 a[208:209], v241 offset:0
s_waitcnt lgkmcnt(6)
v_mfma_f32_16x16x32_bf16 v[0:3], a[188:191], v[160:163], v[0:3]
ds_read_b64_tr_b16 a[210:211], v241 offset:8192
v_mfma_f32_16x16x32_bf16 v[4:7], a[188:191], v[164:167], v[4:7]
ds_read_b64_tr_b16 a[212:213], v242 offset:0
v_max3_f32 v192, v192, v136, v137
v_mfma_f32_16x16x32_bf16 v[8:11], a[192:195], v[160:163], v[8:11]
v_max3_f32 v193, v193, v140, v141
v_mfma_f32_16x16x32_bf16 v[12:15], a[192:195], v[164:167], v[12:15]
v_max3_f32 v192, v192, v138, v139
s_waitcnt lgkmcnt(4)
v_mfma_f32_16x16x32_bf16 v[16:19], a[196:199], v[160:163], v[16:19]
buffer_load_dwordx4 v228, s[16:19], s77 offen offset:1024 lds
v_mfma_f32_16x16x32_bf16 v[20:23], a[196:199], v[164:167], v[20:23]
v_max3_f32 v193, v193, v142, v143
ds_read_b64_tr_b16 a[214:215], v242 offset:8192
v_mfma_f32_16x16x32_bf16 v[24:27], a[200:203], v[160:163], v[24:27]
ds_read_b64_tr_b16 a[216:217], v243 offset:0
ds_read_b64_tr_b16 a[218:219], v243 offset:8192
v_mfma_f32_16x16x32_bf16 v[28:31], a[200:203], v[164:167], v[28:31]
ds_read_b64_tr_b16 a[220:221], v236 offset:256
s_waitcnt lgkmcnt(5)
v_mfma_f32_16x16x32_bf16 v[32:35], a[204:207], v[160:163], v[32:35]
ds_read_b64_tr_b16 a[222:223], v236 offset:8448
v_mfma_f32_16x16x32_bf16 v[36:39], a[204:207], v[164:167], v[36:39]
ds_read_b64_tr_b16 a[224:225], v237 offset:256
ds_read_b64_tr_b16 a[226:227], v237 offset:8448
v_mfma_f32_16x16x32_bf16 v[40:43], a[208:211], v[160:163], v[40:43]
ds_read_b64_tr_b16 a[228:229], v238 offset:256
v_mfma_f32_16x16x32_bf16 v[44:47], a[208:211], v[164:167], v[44:47]
ds_read_b64_tr_b16 a[230:231], v238 offset:8448
s_waitcnt lgkmcnt(8)
v_mfma_f32_16x16x32_bf16 v[48:51], a[212:215], v[160:163], v[48:51]
buffer_load_dwordx4 v229, s[16:19], s77 offen offset:2048 lds
v_mfma_f32_16x16x32_bf16 v[52:55], a[212:215], v[164:167], v[52:55]
ds_read_b64_tr_b16 a[232:233], v239 offset:256
s_waitcnt lgkmcnt(7)
v_mfma_f32_16x16x32_bf16 v[56:59], a[216:219], v[160:163], v[56:59]
ds_read_b64_tr_b16 a[234:235], v239 offset:8448
v_mfma_f32_16x16x32_bf16 v[60:63], a[216:219], v[164:167], v[60:63]
ds_read_b64_tr_b16 a[236:237], v240 offset:256
s_waitcnt lgkmcnt(7)
v_mfma_f32_16x16x32_bf16 v[64:67], a[220:223], v[160:163], v[64:67]
ds_read_b64_tr_b16 a[238:239], v240 offset:8448
v_mfma_f32_16x16x32_bf16 v[68:71], a[220:223], v[164:167], v[68:71]
ds_read_b64_tr_b16 a[240:241], v241 offset:256
s_waitcnt lgkmcnt(6)
v_mfma_f32_16x16x32_bf16 v[72:75], a[224:227], v[160:163], v[72:75]
ds_read_b64_tr_b16 a[242:243], v241 offset:8448
ds_read_b64_tr_b16 a[244:245], v242 offset:256
v_mfma_f32_16x16x32_bf16 v[76:79], a[224:227], v[164:167], v[76:79]
ds_read_b64_tr_b16 a[246:247], v242 offset:8448
s_waitcnt lgkmcnt(8)
v_mfma_f32_16x16x32_bf16 v[80:83], a[228:231], v[160:163], v[80:83]
buffer_load_dwordx4 v230, s[16:19], s77 offen offset:3072 lds
ds_read_b64_tr_b16 a[248:249], v243 offset:256
ds_read_b64_tr_b16 a[250:251], v243 offset:8448
v_mfma_f32_16x16x32_bf16 v[84:87], a[228:231], v[164:167], v[84:87]
s_add_u32 m0, s49, 65536
s_waitcnt lgkmcnt(7)
v_mfma_f32_16x16x32_bf16 v[88:91], a[232:235], v[160:163], v[88:91]
s_mov_b32 s77, 163840
v_exp_f32 v150, v150
v_mfma_f32_16x16x32_bf16 v[92:95], a[232:235], v[164:167], v[92:95]
s_waitcnt lgkmcnt(5)
v_mfma_f32_16x16x32_bf16 v[96:99], a[236:239], v[160:163], v[96:99]
v_exp_f32 v151, v151
v_mfma_f32_16x16x32_bf16 v[100:103], a[236:239], v[164:167], v[100:103]
v_cvt_pk_bf16_f32 v173, v150, v151
s_waitcnt lgkmcnt(2)
v_mfma_f32_16x16x32_bf16 v[104:107], a[240:243], v[160:163], v[104:107]
buffer_load_dwordx4 v244, s[32:35], s70 offen offset:0 lds
s_cmp_eq_u32 s79, 4
s_cbranch_scc0 L_sig4
s_lshl_b32 s3, s46, 2
s_add_u32 s3, s3, 128
v_mov_b32 v194, 1
s_mov_b64 exec, 1
buffer_atomic_add v194, off, s[4:7], s3
s_mov_b64 exec, -1
L_sig4:
s_waitcnt lgkmcnt(0) vmcnt(19)
s_barrier
v_mfma_f32_16x16x32_bf16 v[108:111], a[240:243], v[164:167], v[108:111]
ds_read_b128 a[252:255], v231 offset:49152
ds_read_b128 a[176:179], v232 offset:49152
v_mfma_f32_16x16x32_bf16 v[112:115], a[244:247], v[160:163], v[112:115]
ds_read_b128 a[180:183], v233 offset:49152
v_mfma_f32_16x16x32_bf16 v[116:119], a[244:247], v[164:167], v[116:119]
ds_read_b128 a[184:187], v234 offset:49152
v_mfma_f32_16x16x32_bf16 v[120:123], a[248:251], v[160:163], v[120:123]
buffer_load_dwordx4 v245, s[32:35], s70 offen offset:1024 lds
v_mfma_f32_16x16x32_bf16 v[124:127], a[248:251], v[164:167], v[124:127]
ds_read_b128 a[188:191], v231 offset:49408
v_mfma_f32_16x16x32_bf16 v[176:179], v[196:199], v[160:163], v[176:179]
ds_read_b128 a[192:195], v232 offset:49408
v_mfma_f32_16x16x32_bf16 v[180:183], v[196:199], v[164:167], v[180:183]
ds_read_b128 a[196:199], v233 offset:49408
s_waitcnt lgkmcnt(6)
v_mfma_f32_16x16x32_bf16 v[144:147], a[252:255], a[112:115], v[184:187]
ds_read_b128 a[200:203], v234 offset:49408
v_mfma_f32_16x16x32_bf16 v[148:151], a[252:255], a[116:119], v[188:191]
ds_read_b128 a[204:207], v231 offset:57344
s_waitcnt lgkmcnt(6)
v_mfma_f32_16x16x32_bf16 v[144:147], a[176:179], a[120:123], v[144:147]
buffer_load_dwordx4 v246, s[32:35], s70 offen offset:2048 lds
v_mfma_f32_16x16x32_bf16 v[148:151], a[176:179], a[124:127], v[148:151]
ds_read_b128 a[208:211], v232 offset:57344
v_mfma_f32_16x16x32_bf16 v[144:147], a[180:183], a[128:131], v[144:147]
ds_read_b128 a[212:215], v233 offset:57344
v_mfma_f32_16x16x32_bf16 v[148:151], a[180:183], a[132:135], v[148:151]
ds_read_b128 a[216:219], v234 offset:57344
s_waitcnt lgkmcnt(6)
v_mfma_f32_16x16x32_bf16 v[144:147], a[184:187], a[136:139], v[144:147]
v_exp_f32 v152, v152
v_mfma_f32_16x16x32_bf16 v[148:151], a[184:187], a[140:143], v[148:151]
v_exp_f32 v153, v153
v_mfma_f32_16x16x32_bf16 v[144:147], a[188:191], a[144:147], v[144:147]
buffer_load_dwordx4 v247, s[32:35], s70 offen offset:3072 lds
v_mfma_f32_16x16x32_bf16 v[148:151], a[188:191], a[148:151], v[148:151]
s_add_u32 m0, s49, 69632
s_add_u32 s70, s50, s54
v_mfma_f32_16x16x32_bf16 v[144:147], a[192:195], a[152:155], v[144:147]
v_exp_f32 v154, v154
v_mfma_f32_16x16x32_bf16 v[148:151], a[192:195], a[156:159], v[148:151]
v_cvt_pk_bf16_f32 v170, v152, v153
s_waitcnt lgkmcnt(1)
v_mfma_f32_16x16x32_bf16 v[144:147], a[196:199], a[160:163], v[144:147]
v_exp_f32 v155, v155
v_mfma_f32_16x16x32_bf16 v[148:151], a[196:199], a[164:167], v[148:151]
v_cvt_pk_bf16_f32 v171, v154, v155
v_mfma_f32_16x16x32_bf16 v[144:147], a[200:203], a[168:171], v[144:147]
buffer_load_dwordx4 v244, s[32:35], s71 offen offset:0 lds
v_mfma_f32_16x16x32_bf16 v[148:151], a[200:203], a[172:175], v[148:151]
v_exp_f32 v156, v156
v_mfma_f32_16x16x32_bf16 v[152:155], a[204:207], a[112:115], v[184:187]
v_exp_f32 v157, v157
v_exp_f32 v158, v158
v_exp_f32 v159, v159
v_cvt_pk_bf16_f32 v174, v156, v157
v_max3_f32 v192, v192, v144, v145
v_max3_f32 v192, v192, v146, v147
v_max3_f32 v193, v193, v148, v149
v_max3_f32 v193, v193, v150, v151
v_cvt_pk_bf16_f32 v175, v158, v159
v_mfma_f32_16x16x32_bf16 v[156:159], a[204:207], a[116:119], v[188:191]
buffer_load_dwordx4 v245, s[32:35], s71 offen offset:1024 lds
ds_read_b128 a[220:223], v231 offset:57600
v_mfma_f32_16x16x32_bf16 v[152:155], a[208:211], a[120:123], v[152:155]
ds_read_b128 a[224:227], v232 offset:57600
v_mfma_f32_16x16x32_bf16 v[156:159], a[208:211], a[124:127], v[156:159]
ds_read_b128 a[228:231], v233 offset:57600
v_mfma_f32_16x16x32_bf16 v[152:155], a[212:215], a[128:131], v[152:155]
ds_read_b128 a[232:235], v234 offset:57600
v_mfma_f32_16x16x32_bf16 v[156:159], a[212:215], a[132:135], v[156:159]
ds_read_b64_tr_b16 a[236:237], v236 offset:16384
s_waitcnt lgkmcnt(5)
v_mfma_f32_16x16x32_bf16 v[152:155], a[216:219], a[136:139], v[152:155]
buffer_load_dwordx4 v246, s[32:35], s71 offen offset:2048 lds
v_mfma_f32_16x16x32_bf16 v[156:159], a[216:219], a[140:143], v[156:159]
s_add_u32 m0, s48, 131072
s_add_u32 s71, s70, 28672
ds_read_b64_tr_b16 a[238:239], v236 offset:24576
s_waitcnt lgkmcnt(5)
v_mfma_f32_16x16x32_bf16 v[152:155], a[220:223], a[144:147], v[152:155]
ds_read_b64_tr_b16 a[240:241], v237 offset:16384
v_mfma_f32_16x16x32_bf16 v[156:159], a[220:223], a[148:151], v[156:159]
ds_read_b64_tr_b16 a[242:243], v237 offset:24576
s_waitcnt lgkmcnt(6)
v_mfma_f32_16x16x32_bf16 v[152:155], a[224:227], a[152:155], v[152:155]
ds_read_b64_tr_b16 a[244:245], v238 offset:16384
v_mfma_f32_16x16x32_bf16 v[156:159], a[224:227], a[156:159], v[156:159]
ds_read_b64_tr_b16 a[246:247], v238 offset:24576
s_waitcnt lgkmcnt(6)
v_mfma_f32_16x16x32_bf16 v[152:155], a[228:231], a[160:163], v[152:155]
ds_read_b64_tr_b16 a[248:249], v239 offset:16384
v_mfma_f32_16x16x32_bf16 v[156:159], a[228:231], a[164:167], v[156:159]
buffer_load_dwordx4 v223, s[12:15], s72 offen offset:0 lds
v_mfma_f32_16x16x32_bf16 v[152:155], a[232:235], a[168:171], v[152:155]
ds_read_b64_tr_b16 a[250:251], v239 offset:24576
v_mfma_f32_16x16x32_bf16 v[156:159], a[232:235], a[172:175], v[156:159]
ds_read_b64_tr_b16 a[252:253], v240 offset:16384
s_waitcnt lgkmcnt(6)
v_mfma_f32_16x16x32_bf16 v[0:3], a[236:239], v[168:171], v[0:3]
ds_read_b64_tr_b16 a[254:255], v240 offset:24576
v_mfma_f32_16x16x32_bf16 v[4:7], a[236:239], v[172:175], v[4:7]
ds_read_b64_tr_b16 a[176:177], v241 offset:16384
s_waitcnt lgkmcnt(6)
v_mfma_f32_16x16x32_bf16 v[8:11], a[240:243], v[168:171], v[8:11]
v_max3_f32 v192, v192, v152, v153
v_max3_f32 v193, v193, v156, v157
v_mfma_f32_16x16x32_bf16 v[12:15], a[240:243], v[172:175], v[12:15]
v_max3_f32 v192, v192, v154, v155
ds_read_b64_tr_b16 a[178:179], v241 offset:24576
s_waitcnt lgkmcnt(5)
v_mfma_f32_16x16x32_bf16 v[16:19], a[244:247], v[168:171], v[16:19]
buffer_load_dwordx4 v224, s[12:15], s72 offen offset:1024 lds
v_mfma_f32_16x16x32_bf16 v[20:23], a[244:247], v[172:175], v[20:23]
v_max3_f32 v193, v193, v158, v159
ds_read_b64_tr_b16 a[180:181], v242 offset:16384
ds_read_b64_tr_b16 a[182:183], v242 offset:24576
s_waitcnt lgkmcnt(5)
v_mfma_f32_16x16x32_bf16 v[24:27], a[248:251], v[168:171], v[24:27]
ds_read_b64_tr_b16 a[184:185], v243 offset:16384
ds_read_b64_tr_b16 a[186:187], v243 offset:24576
v_mfma_f32_16x16x32_bf16 v[28:31], a[248:251], v[172:175], v[28:31]
ds_read_b64_tr_b16 a[188:189], v236 offset:16640
s_waitcnt lgkmcnt(6)
v_mfma_f32_16x16x32_bf16 v[32:35], a[252:255], v[168:171], v[32:35]
ds_read_b64_tr_b16 a[190:191], v236 offset:24832
v_mfma_f32_16x16x32_bf16 v[36:39], a[252:255], v[172:175], v[36:39]
ds_read_b64_tr_b16 a[192:193], v237 offset:16640
s_waitcnt lgkmcnt(7)
v_mfma_f32_16x16x32_bf16 v[40:43], a[176:179], v[168:171], v[40:43]
buffer_load_dwordx4 v225, s[12:15], s72 offen offset:2048 lds
v_mfma_f32_16x16x32_bf16 v[44:47], a[176:179], v[172:175], v[44:47]
ds_read_b64_tr_b16 a[194:195], v237 offset:24832
s_waitcnt lgkmcnt(6)
v_mfma_f32_16x16x32_bf16 v[48:51], a[180:183], v[168:171], v[48:51]
ds_read_b64_tr_b16 a[196:197], v238 offset:16640
ds_read_b64_tr_b16 a[198:199], v238 offset:24832
v_mfma_f32_16x16x32_bf16 v[52:55], a[180:183], v[172:175], v[52:55]
ds_read_b64_tr_b16 a[200:201], v239 offset:16640
s_waitcnt lgkmcnt(7)
v_mfma_f32_16x16x32_bf16 v[56:59], a[184:187], v[168:171], v[56:59]
ds_read_b64_tr_b16 a[202:203], v239 offset:24832
v_mfma_f32_16x16x32_bf16 v[60:63], a[184:187], v[172:175], v[60:63]
ds_read_b64_tr_b16 a[204:205], v240 offset:16640
s_waitcnt lgkmcnt(7)
v_mfma_f32_16x16x32_bf16 v[64:67], a[188:191], v[168:171], v[64:67]
ds_read_b64_tr_b16 a[206:207], v240 offset:24832
v_mfma_f32_16x16x32_bf16 v[68:71], a[188:191], v[172:175], v[68:71]
ds_read_b64_tr_b16 a[208:209], v241 offset:16640
s_waitcnt lgkmcnt(7)
v_mfma_f32_16x16x32_bf16 v[72:75], a[192:195], v[168:171], v[72:75]
buffer_load_dwordx4 v226, s[12:15], s72 offen offset:3072 lds
v_mfma_f32_16x16x32_bf16 v[76:79], a[192:195], v[172:175], v[76:79]
s_add_u32 m0, s48, 0
ds_read_b64_tr_b16 a[210:211], v241 offset:24832
s_waitcnt lgkmcnt(6)
v_mfma_f32_16x16x32_bf16 v[80:83], a[196:199], v[168:171], v[80:83]
s_mov_b32 s72, 212992
ds_read_b64_tr_b16 a[212:213], v242 offset:16640
ds_read_b64_tr_b16 a[214:215], v242 offset:24832
ds_read_b64_tr_b16 a[216:217], v243 offset:16640
ds_read_b64_tr_b16 a[218:219], v243 offset:24832
v_mfma_f32_16x16x32_bf16 v[84:87], a[196:199], v[172:175], v[84:87]
s_waitcnt lgkmcnt(7)
v_mfma_f32_16x16x32_bf16 v[88:91], a[200:203], v[168:171], v[88:91]
v_exp_f32 v128, v128
v_mfma_f32_16x16x32_bf16 v[92:95], a[200:203], v[172:175], v[92:95]
s_waitcnt lgkmcnt(5)
v_mfma_f32_16x16x32_bf16 v[96:99], a[204:207], v[168:171], v[96:99]
buffer_load_dwordx4 v227, s[16:19], s73 offen offset:0 lds
v_mfma_f32_16x16x32_bf16 v[100:103], a[204:207], v[172:175], v[100:103]
s_cmp_eq_u32 s79, 5
s_cbranch_scc0 L_sig5
s_lshl_b32 s3, s46, 2
s_add_u32 s3, s3, 128
v_mov_b32 v194, 1
s_mov_b64 exec, 1
buffer_atomic_add v194, off, s[4:7], s3
s_mov_b64 exec, -1
L_sig5:
s_waitcnt lgkmcnt(4)
v_mfma_f32_16x16x32_bf16 v[104:107], a[208:211], v[168:171], v[104:107]
v_exp_f32 v129, v129
s_waitcnt lgkmcnt(0) vmcnt(5)
s_barrier
v_mfma_f32_16x16x32_bf16 v[108:111], a[208:211], v[172:175], v[108:111]
ds_read_b128 a[220:223], v231 offset:0
v_cvt_pk_bf16_f32 v160, v128, v129
v_mfma_f32_16x16x32_bf16 v[112:115], a[212:215], v[168:171], v[112:115]
ds_read_b128 a[224:227], v232 offset:0
v_mfma_f32_16x16x32_bf16 v[116:119], a[212:215], v[172:175], v[116:119]
ds_read_b128 a[228:231], v233 offset:0
v_mfma_f32_16x16x32_bf16 v[120:123], a[216:219], v[168:171], v[120:123]
buffer_load_dwordx4 v228, s[16:19], s73 offen offset:1024 lds
v_mfma_f32_16x16x32_bf16 v[124:127], a[216:219], v[172:175], v[124:127]
v_exp_f32 v130, v130
v_mfma_f32_16x16x32_bf16 v[176:179], v[196:199], v[168:171], v[176:179]
v_exp_f32 v131, v131
v_mfma_f32_16x16x32_bf16 v[180:183], v[196:199], v[172:175], v[180:183]
ds_read_b128 a[232:235], v234 offset:0
v_cvt_pk_bf16_f32 v161, v130, v131
s_waitcnt lgkmcnt(3)
v_mfma_f32_16x16x32_bf16 v[128:131], a[220:223], a[112:115], v[184:187]
v_exp_f32 v132, v132
v_exp_f32 v133, v133
v_exp_f32 v134, v134
v_exp_f32 v135, v135
v_cvt_pk_bf16_f32 v164, v132, v133
v_cvt_pk_bf16_f32 v165, v134, v135
v_mfma_f32_16x16x32_bf16 v[132:135], a[220:223], a[116:119], v[188:191]
ds_read_b128 a[236:239], v231 offset:256
s_waitcnt lgkmcnt(2)
v_mfma_f32_16x16x32_bf16 v[128:131], a[224:227], a[120:123], v[128:131]
buffer_load_dwordx4 v229, s[16:19], s73 offen offset:2048 lds
v_mfma_f32_16x16x32_bf16 v[132:135], a[224:227], a[124:127], v[132:135]
ds_read_b128 a[240:243], v232 offset:256
ds_read_b128 a[244:247], v233 offset:256
v_mfma_f32_16x16x32_bf16 v[128:131], a[228:231], a[128:131], v[128:131]
ds_read_b128 a[248:251], v234 offset:256
v_mfma_f32_16x16x32_bf16 v[132:135], a[228:231], a[132:135], v[132:135]
ds_read_b128 a[252:255], v231 offset:8192
s_waitcnt lgkmcnt(5)
v_mfma_f32_16x16x32_bf16 v[128:131], a[232:235], a[136:139], v[128:131]
ds_read_b128 a[176:179], v232 offset:8192
v_mfma_f32_16x16x32_bf16 v[132:135], a[232:235], a[140:143], v[132:135]
ds_read_b128 a[180:183], v233 offset:8192
s_waitcnt lgkmcnt(6)
v_mfma_f32_16x16x32_bf16 v[128:131], a[236:239], a[144:147], v[128:131]
v_exp_f32 v136, v136
v_mfma_f32_16x16x32_bf16 v[132:135], a[236:239], a[148:151], v[132:135]
ds_read_b128 a[184:187], v234 offset:8192
s_waitcnt lgkmcnt(6)
v_mfma_f32_16x16x32_bf16 v[128:131], a[240:243], a[152:155], v[128:131]
buffer_load_dwordx4 v230, s[16:19], s73 offen offset:3072 lds
v_mfma_f32_16x16x32_bf16 v[132:135], a[240:243], a[156:159], v[132:135]
s_add_u32 m0, s48, 147456
s_waitcnt lgkmcnt(4)
v_mfma_f32_16x16x32_bf16 v[128:131], a[244:247], a[160:163], v[128:131]
s_mov_b32 s73, 180224
buffer_load_dword v205, v201, s[24:27], 0 offen
v_mfma_f32_16x16x32_bf16 v[132:135], a[244:247], a[164:167], v[132:135]
v_exp_f32 v137, v137
v_mfma_f32_16x16x32_bf16 v[128:131], a[248:251], a[168:171], v[128:131]
v_exp_f32 v138, v138
v_mfma_f32_16x16x32_bf16 v[132:135], a[248:251], a[172:175], v[132:135]
v_exp_f32 v139, v139
v_cvt_pk_bf16_f32 v162, v136, v137
v_cvt_pk_bf16_f32 v163, v138, v139
s_waitcnt lgkmcnt(0)
v_mfma_f32_16x16x32_bf16 v[136:139], a[252:255], a[112:115], v[184:187]
v_exp_f32 v140, v140
v_max3_f32 v192, v192, v128, v129
v_max3_f32 v192, v192, v130, v131
v_max3_f32 v193, v193, v132, v133
v_max3_f32 v193, v193, v134, v135
v_exp_f32 v141, v141
v_exp_f32 v142, v142
buffer_load_dwordx4 v223, s[12:15], s74 offen offset:0 lds
v_exp_f32 v143, v143
v_cvt_pk_bf16_f32 v166, v140, v141
v_cvt_pk_bf16_f32 v167, v142, v143
v_mfma_f32_16x16x32_bf16 v[140:143], a[252:255], a[116:119], v[188:191]
ds_read_b128 a[188:191], v231 offset:8448
ds_read_b128 a[192:195], v232 offset:8448
v_mfma_f32_16x16x32_bf16 v[136:139], a[176:179], a[120:123], v[136:139]
ds_read_b128 a[196:199], v233 offset:8448
v_mfma_f32_16x16x32_bf16 v[140:143], a[176:179], a[124:127], v[140:143]
ds_read_b128 a[200:203], v234 offset:8448
v_mfma_f32_16x16x32_bf16 v[136:139], a[180:183], a[128:131], v[136:139]
ds_read_b64_tr_b16 a[204:205], v236 offset:32768
v_mfma_f32_16x16x32_bf16 v[140:143], a[180:183], a[132:135], v[140:143]
ds_read_b64_tr_b16 a[206:207], v236 offset:40960
v_mfma_f32_16x16x32_bf16 v[136:139], a[184:187], a[136:139], v[136:139]
buffer_load_dwordx4 v224, s[12:15], s74 offen offset:1024 lds
v_mfma_f32_16x16x32_bf16 v[140:143], a[184:187], a[140:143], v[140:143]
ds_read_b64_tr_b16 a[208:209], v237 offset:32768
s_waitcnt lgkmcnt(6)
v_mfma_f32_16x16x32_bf16 v[136:139], a[188:191], a[144:147], v[136:139]
ds_read_b64_tr_b16 a[210:211], v237 offset:40960
v_mfma_f32_16x16x32_bf16 v[140:143], a[188:191], a[148:151], v[140:143]
ds_read_b64_tr_b16 a[212:213], v238 offset:32768
s_waitcnt lgkmcnt(6)
v_mfma_f32_16x16x32_bf16 v[136:139], a[192:195], a[152:155], v[136:139]
ds_read_b64_tr_b16 a[214:215], v238 offset:40960
v_mfma_f32_16x16x32_bf16 v[140:143], a[192:195], a[156:159], v[140:143]
ds_read_b64_tr_b16 a[216:217], v239 offset:32768
v_mfma_f32_16x16x32_bf16 v[136:139], a[196:199], a[160:163], v[136:139]
ds_read_b64_tr_b16 a[218:219], v239 offset:40960
v_mfma_f32_16x16x32_bf16 v[140:143], a[196:199], a[164:167], v[140:143]
ds_read_b64_tr_b16 a[220:221], v240 offset:32768
s_waitcnt lgkmcnt(7)
v_mfma_f32_16x16x32_bf16 v[136:139], a[200:203], a[168:171], v[136:139]
buffer_load_dwordx4 v225, s[12:15], s74 offen offset:2048 lds
v_mfma_f32_16x16x32_bf16 v[140:143], a[200:203], a[172:175], v[140:143]
ds_read_b64_tr_b16 a[222:223], v240 offset:40960
v_mfma_f32_16x16x32_bf16 v[0:3], a[204:207], v[160:163], v[0:3]
ds_read_b64_tr_b16 a[224:225], v241 offset:32768
v_mfma_f32_16x16x32_bf16 v[4:7], a[204:207], v[164:167], v[4:7]
ds_read_b64_tr_b16 a[226:227], v241 offset:40960
s_waitcnt lgkmcnt(6)
v_mfma_f32_16x16x32_bf16 v[8:11], a[208:211], v[160:163], v[8:11]
v_max3_f32 v192, v192, v136, v137
v_max3_f32 v193, v193, v140, v141
v_mfma_f32_16x16x32_bf16 v[12:15], a[208:211], v[164:167], v[12:15]
v_max3_f32 v192, v192, v138, v139
v_mfma_f32_16x16x32_bf16 v[16:19], a[212:215], v[160:163], v[16:19]
v_max3_f32 v193, v193, v142, v143
ds_read_b64_tr_b16 a[228:229], v242 offset:32768
v_mfma_f32_16x16x32_bf16 v[20:23], a[212:215], v[164:167], v[20:23]
ds_read_b64_tr_b16 a[230:231], v242 offset:40960
s_waitcnt lgkmcnt(5)
v_mfma_f32_16x16x32_bf16 v[24:27], a[216:219], v[160:163], v[24:27]
buffer_load_dwordx4 v226, s[12:15], s74 offen offset:3072 lds
v_mfma_f32_16x16x32_bf16 v[28:31], a[216:219], v[164:167], v[28:31]
s_lshl_b32 s74, s46, 2
ds_read_b64_tr_b16 a[232:233], v243 offset:32768
ds_read_b64_tr_b16 a[234:235], v243 offset:40960
s_waitcnt lgkmcnt(5)
v_mfma_f32_16x16x32_bf16 v[32:35], a[220:223], v[160:163], v[32:35]
s_add_u32 s74, s74, 128
s_add_u32 m0, s48, 16384
v_mfma_f32_16x16x32_bf16 v[36:39], a[220:223], v[164:167], v[36:39]
ds_read_b64_tr_b16 a[236:237], v236 offset:33024
ds_read_b64_tr_b16 a[238:239], v236 offset:41216
s_waitcnt lgkmcnt(6)
v_mfma_f32_16x16x32_bf16 v[40:43], a[224:227], v[160:163], v[40:43]
ds_read_b64_tr_b16 a[240:241], v237 offset:33024
ds_read_b64_tr_b16 a[242:243], v237 offset:41216
v_mfma_f32_16x16x32_bf16 v[44:47], a[224:227], v[164:167], v[44:47]
ds_read_b64_tr_b16 a[244:245], v238 offset:33024
s_waitcnt lgkmcnt(7)
v_mfma_f32_16x16x32_bf16 v[48:51], a[228:231], v[160:163], v[48:51]
buffer_load_dwordx4 v227, s[16:19], s75 offen offset:0 lds
v_mfma_f32_16x16x32_bf16 v[52:55], a[228:231], v[164:167], v[52:55]
ds_read_b64_tr_b16 a[246:247], v238 offset:41216
s_waitcnt lgkmcnt(6)
v_mfma_f32_16x16x32_bf16 v[56:59], a[232:235], v[160:163], v[56:59]
ds_read_b64_tr_b16 a[248:249], v239 offset:33024
ds_read_b64_tr_b16 a[250:251], v239 offset:41216
v_mfma_f32_16x16x32_bf16 v[60:63], a[232:235], v[164:167], v[60:63]
ds_read_b64_tr_b16 a[252:253], v240 offset:33024
s_waitcnt lgkmcnt(7)
v_mfma_f32_16x16x32_bf16 v[64:67], a[236:239], v[160:163], v[64:67]
ds_read_b64_tr_b16 a[254:255], v240 offset:41216
v_mfma_f32_16x16x32_bf16 v[68:71], a[236:239], v[164:167], v[68:71]
ds_read_b64_tr_b16 a[176:177], v241 offset:33024
s_waitcnt lgkmcnt(7)
v_mfma_f32_16x16x32_bf16 v[72:75], a[240:243], v[160:163], v[72:75]
ds_read_b64_tr_b16 a[178:179], v241 offset:41216
v_mfma_f32_16x16x32_bf16 v[76:79], a[240:243], v[164:167], v[76:79]
ds_read_b64_tr_b16 a[180:181], v242 offset:33024
s_waitcnt lgkmcnt(7)
v_mfma_f32_16x16x32_bf16 v[80:83], a[244:247], v[160:163], v[80:83]
buffer_load_dwordx4 v228, s[16:19], s75 offen offset:1024 lds
v_mfma_f32_16x16x32_bf16 v[84:87], a[244:247], v[164:167], v[84:87]
ds_read_b64_tr_b16 a[182:183], v242 offset:41216
s_waitcnt lgkmcnt(6)
v_mfma_f32_16x16x32_bf16 v[88:91], a[248:251], v[160:163], v[88:91]
ds_read_b64_tr_b16 a[184:185], v243 offset:33024
ds_read_b64_tr_b16 a[186:187], v243 offset:41216
v_mfma_f32_16x16x32_bf16 v[92:95], a[248:251], v[164:167], v[92:95]
ds_read_b64_tr_b16 a[188:189], v249 offset:0
s_waitcnt lgkmcnt(7)
v_mfma_f32_16x16x32_bf16 v[96:99], a[252:255], v[160:163], v[96:99]
ds_read_b64_tr_b16 a[190:191], v249 offset:2048
v_mfma_f32_16x16x32_bf16 v[100:103], a[252:255], v[164:167], v[100:103]
ds_read_b64_tr_b16 a[192:193], v249 offset:4096
s_waitcnt lgkmcnt(7)
v_mfma_f32_16x16x32_bf16 v[104:107], a[176:179], v[160:163], v[104:107]
ds_read_b64_tr_b16 a[194:195], v249 offset:6144
v_mfma_f32_16x16x32_bf16 v[108:111], a[176:179], v[164:167], v[108:111]
ds_read_b64_tr_b16 a[196:197], v249 offset:8192
s_waitcnt lgkmcnt(7)
v_mfma_f32_16x16x32_bf16 v[112:115], a[180:183], v[160:163], v[112:115]
buffer_load_dwordx4 v229, s[16:19], s75 offen offset:2048 lds
v_mfma_f32_16x16x32_bf16 v[116:119], a[180:183], v[164:167], v[116:119]
ds_read_b64_tr_b16 a[198:199], v249 offset:10240
s_waitcnt lgkmcnt(6)
v_mfma_f32_16x16x32_bf16 v[120:123], a[184:187], v[160:163], v[120:123]
ds_read_b64_tr_b16 a[200:201], v249 offset:12288
v_mfma_f32_16x16x32_bf16 v[124:127], a[184:187], v[164:167], v[124:127]
ds_read_b64_tr_b16 a[202:203], v249 offset:14336
v_mfma_f32_16x16x32_bf16 v[176:179], v[196:199], v[160:163], v[176:179]
ds_read_b64_tr_b16 a[204:205], v249 offset:16384
v_mfma_f32_16x16x32_bf16 v[180:183], v[196:199], v[164:167], v[180:183]
ds_read_b64_tr_b16 a[206:207], v249 offset:18432
s_waitcnt lgkmcnt(6)
v_mfma_f32_16x16x32_bf16 v[206:209], a[188:191], a[0:3], 0
ds_read_b64_tr_b16 a[208:209], v249 offset:20480
v_mfma_f32_16x16x32_bf16 v[210:213], a[188:191], a[4:7], 0
buffer_load_dwordx4 v230, s[16:19], s75 offen offset:3072 lds
v_mfma_f32_16x16x32_bf16 v[214:217], a[188:191], a[8:11], 0
s_add_u32 m0, s48, 98304
s_mov_b32 s75, 229376
v_mfma_f32_16x16x32_bf16 v[218:221], a[188:191], a[12:15], 0
s_mov_b64 exec, 3
global_load_dword v205, v195, s[94:95]
s_mov_b64 exec, -1
v_mfma_f32_16x16x32_bf16 v[206:209], a[192:195], a[16:19], v[206:209]
v_mov_b32 v195, s98
v_mfma_f32_16x16x32_bf16 v[210:213], a[192:195], a[20:23], v[210:213]
ds_read_b64_tr_b16 a[210:211], v249 offset:22528
v_mfma_f32_16x16x32_bf16 v[214:217], a[192:195], a[24:27], v[214:217]
ds_read_b64_tr_b16 a[212:213], v249 offset:24576
v_mfma_f32_16x16x32_bf16 v[218:221], a[192:195], a[28:31], v[218:221]
ds_read_b64_tr_b16 a[214:215], v249 offset:26624
s_waitcnt lgkmcnt(3)
v_mfma_f32_16x16x32_bf16 v[206:209], a[196:199], a[32:35], v[206:209]
v_exp_f32 v144, v144
v_mfma_f32_16x16x32_bf16 v[210:213], a[196:199], a[36:39], v[210:213]
v_exp_f32 v145, v145
v_mfma_f32_16x16x32_bf16 v[214:217], a[196:199], a[40:43], v[214:217]
v_exp_f32 v146, v146
v_mfma_f32_16x16x32_bf16 v[218:221], a[196:199], a[44:47], v[218:221]
v_exp_f32 v147, v147
v_mfma_f32_16x16x32_bf16 v[206:209], a[200:203], a[48:51], v[206:209]
v_cvt_pk_bf16_f32 v168, v144, v145
v_mfma_f32_16x16x32_bf16 v[210:213], a[200:203], a[52:55], v[210:213]
v_cvt_pk_bf16_f32 v169, v146, v147
v_mfma_f32_16x16x32_bf16 v[214:217], a[200:203], a[56:59], v[214:217]
v_exp_f32 v148, v148
v_mfma_f32_16x16x32_bf16 v[218:221], a[200:203], a[60:63], v[218:221]
v_exp_f32 v149, v149
v_mfma_f32_16x16x32_bf16 v[206:209], a[204:207], a[64:67], v[206:209]
v_exp_f32 v150, v150
v_mfma_f32_16x16x32_bf16 v[210:213], a[204:207], a[68:71], v[210:213]
v_exp_f32 v151, v151
v_mfma_f32_16x16x32_bf16 v[214:217], a[204:207], a[72:75], v[214:217]
v_cvt_pk_bf16_f32 v172, v148, v149
v_mfma_f32_16x16x32_bf16 v[218:221], a[204:207], a[76:79], v[218:221]
v_cvt_pk_bf16_f32 v173, v150, v151
s_waitcnt lgkmcnt(0)
v_mfma_f32_16x16x32_bf16 v[206:209], a[208:211], a[80:83], v[206:209]
v_exp_f32 v152, v152
s_cmp_eq_u32 s79, 6
s_cbranch_scc0 L_sig6
s_lshl_b32 s3, s46, 2
s_add_u32 s3, s3, 128
v_mov_b32 v194, 1
s_mov_b64 exec, 1
buffer_atomic_add v194, off, s[4:7], s3
s_mov_b64 exec, -1
L_sig6:
s_barrier
v_mfma_f32_16x16x32_bf16 v[210:213], a[208:211], a[84:87], v[210:213]
buffer_load_dwordx4 v223, s[12:15], s76 offen offset:0 lds
ds_read_b128 a[216:219], v231 offset:16384
v_mfma_f32_16x16x32_bf16 v[214:217], a[208:211], a[88:91], v[214:217]
ds_read_b128 a[220:223], v232 offset:16384
v_mfma_f32_16x16x32_bf16 v[218:221], a[208:211], a[92:95], v[218:221]
ds_read_b128 a[224:227], v233 offset:16384
v_mfma_f32_16x16x32_bf16 v[206:209], a[212:215], a[96:99], v[206:209]
ds_read_b128 a[228:231], v234 offset:16384
v_mfma_f32_16x16x32_bf16 v[210:213], a[212:215], a[100:103], v[210:213]
ds_read_b128 a[232:235], v231 offset:16640
v_mfma_f32_16x16x32_bf16 v[214:217], a[212:215], a[104:107], v[214:217]
ds_read_b128 a[236:239], v232 offset:16640
v_mfma_f32_16x16x32_bf16 v[218:221], a[212:215], a[108:111], v[218:221]
ds_read_b128 a[240:243], v233 offset:16640
ds_read_b128 a[244:247], v234 offset:16640
buffer_load_dwordx4 v224, s[12:15], s76 offen offset:1024 lds
s_waitcnt lgkmcnt(7)
v_mfma_f32_16x16x32_bf16 v[144:147], a[216:219], a[112:115], v[184:187]
v_cvt_pk_bf16_f32 v206, v206, v207
v_cvt_pk_bf16_f32 v207, v208, v209
v_mfma_f32_16x16x32_bf16 v[148:151], a[216:219], a[116:119], v[188:191]
v_cvt_pk_bf16_f32 v208, v210, v211
s_waitcnt lgkmcnt(6)
v_mfma_f32_16x16x32_bf16 v[144:147], a[220:223], a[120:123], v[144:147]
v_cvt_pk_bf16_f32 v209, v212, v213
v_mfma_f32_16x16x32_bf16 v[148:151], a[220:223], a[124:127], v[148:151]
v_cvt_pk_bf16_f32 v210, v214, v215
s_waitcnt lgkmcnt(4)
v_mfma_f32_16x16x32_bf16 v[144:147], a[224:227], a[128:131], v[144:147]
v_cvt_pk_bf16_f32 v211, v216, v217
v_cvt_pk_bf16_f32 v212, v218, v219
v_mfma_f32_16x16x32_bf16 v[148:151], a[224:227], a[132:135], v[148:151]
v_cvt_pk_bf16_f32 v213, v220, v221
buffer_store_dwordx4 v[206:209], v253, s[36:39], s100 offen offset:0 sc1
v_mfma_f32_16x16x32_bf16 v[144:147], a[228:231], a[136:139], v[144:147]
ds_read_b128 a[248:251], v231 offset:24576
v_mfma_f32_16x16x32_bf16 v[148:151], a[228:231], a[140:143], v[148:151]
ds_read_b128 a[252:255], v232 offset:24576
buffer_store_dwordx4 v[210:213], v253, s[36:39], s100 offen offset:1024 sc1
s_waitcnt lgkmcnt(2)
v_mfma_f32_16x16x32_bf16 v[144:147], a[232:235], a[144:147], v[144:147]
ds_read_b128 a[176:179], v233 offset:24576
v_mfma_f32_16x16x32_bf16 v[148:151], a[232:235], a[148:151], v[148:151]
v_exp_f32 v153, v153
v_mfma_f32_16x16x32_bf16 v[144:147], a[236:239], a[152:155], v[144:147]
v_exp_f32 v154, v154
v_mfma_f32_16x16x32_bf16 v[148:151], a[236:239], a[156:159], v[148:151]
v_exp_f32 v155, v155
v_mfma_f32_16x16x32_bf16 v[144:147], a[240:243], a[160:163], v[144:147]
ds_read_b128 a[180:183], v234 offset:24576
v_cvt_pk_bf16_f32 v170, v152, v153
v_mfma_f32_16x16x32_bf16 v[148:151], a[240:243], a[164:167], v[148:151]
v_cvt_pk_bf16_f32 v171, v154, v155
v_mfma_f32_16x16x32_bf16 v[144:147], a[244:247], a[168:171], v[144:147]
buffer_load_dwordx4 v225, s[12:15], s76 offen offset:2048 lds
v_mfma_f32_16x16x32_bf16 v[148:151], a[244:247], a[172:175], v[148:151]
ds_read_b128 a[184:187], v231 offset:24832
s_waitcnt lgkmcnt(2)
v_mfma_f32_16x16x32_bf16 v[152:155], a[248:251], a[112:115], v[184:187]
v_exp_f32 v156, v156
v_exp_f32 v157, v157
v_exp_f32 v158, v158
v_max3_f32 v192, v192, v144, v145
v_max3_f32 v192, v192, v146, v147
v_max3_f32 v193, v193, v148, v149
v_max3_f32 v193, v193, v150, v151
v_exp_f32 v159, v159
v_cvt_pk_bf16_f32 v174, v156, v157
v_cvt_pk_bf16_f32 v175, v158, v159
v_mfma_f32_16x16x32_bf16 v[156:159], a[248:251], a[116:119], v[188:191]
ds_read_b128 a[188:191], v232 offset:24832
v_mfma_f32_16x16x32_bf16 v[152:155], a[252:255], a[120:123], v[152:155]
buffer_load_dwordx4 v226, s[12:15], s76 offen offset:3072 lds
v_mfma_f32_16x16x32_bf16 v[156:159], a[252:255], a[124:127], v[156:159]
s_add_u32 m0, s48, 32768
s_mov_b32 s76, 196608
v_mfma_f32_16x16x32_bf16 v[152:155], a[176:179], a[128:131], v[152:155]
ds_read_b128 a[192:195], v233 offset:24832
v_mfma_f32_16x16x32_bf16 v[156:159], a[176:179], a[132:135], v[156:159]
ds_read_b128 a[196:199], v234 offset:24832
s_waitcnt lgkmcnt(3)
v_mfma_f32_16x16x32_bf16 v[152:155], a[180:183], a[136:139], v[152:155]
ds_read_b64_tr_b16 a[200:201], v236 offset:49152
v_mfma_f32_16x16x32_bf16 v[156:159], a[180:183], a[140:143], v[156:159]
ds_read_b64_tr_b16 a[202:203], v236 offset:57344
v_mfma_f32_16x16x32_bf16 v[152:155], a[184:187], a[144:147], v[152:155]
ds_read_b64_tr_b16 a[204:205], v237 offset:49152
v_mfma_f32_16x16x32_bf16 v[156:159], a[184:187], a[148:151], v[156:159]
ds_read_b64_tr_b16 a[206:207], v237 offset:57344
s_waitcnt lgkmcnt(6)
v_mfma_f32_16x16x32_bf16 v[152:155], a[188:191], a[152:155], v[152:155]
buffer_load_dwordx4 v227, s[16:19], s77 offen offset:0 lds
v_mfma_f32_16x16x32_bf16 v[156:159], a[188:191], a[156:159], v[156:159]
ds_read_b64_tr_b16 a[208:209], v238 offset:49152
s_waitcnt lgkmcnt(6)
v_mfma_f32_16x16x32_bf16 v[152:155], a[192:195], a[160:163], v[152:155]
ds_read_b64_tr_b16 a[210:211], v238 offset:57344
v_mfma_f32_16x16x32_bf16 v[156:159], a[192:195], a[164:167], v[156:159]
ds_read_b64_tr_b16 a[212:213], v239 offset:49152
s_waitcnt lgkmcnt(6)
v_mfma_f32_16x16x32_bf16 v[152:155], a[196:199], a[168:171], v[152:155]
ds_read_b64_tr_b16 a[214:215], v239 offset:57344
v_mfma_f32_16x16x32_bf16 v[156:159], a[196:199], a[172:175], v[156:159]
ds_read_b64_tr_b16 a[216:217], v240 offset:49152
s_waitcnt lgkmcnt(6)
v_mfma_f32_16x16x32_bf16 v[0:3], a[200:203], v[168:171], v[0:3]
ds_read_b64_tr_b16 a[218:219], v240 offset:57344
s_add_u32 s100, s61, 8192
v_mfma_f32_16x16x32_bf16 v[4:7], a[200:203], v[172:175], v[4:7]
v_max3_f32 v192, v192, v152, v153
s_waitcnt lgkmcnt(6)
v_mfma_f32_16x16x32_bf16 v[8:11], a[204:207], v[168:171], v[8:11]
buffer_load_dwordx4 v228, s[16:19], s77 offen offset:1024 lds
v_mfma_f32_16x16x32_bf16 v[12:15], a[204:207], v[172:175], v[12:15]
v_max3_f32 v193, v193, v156, v157
ds_read_b64_tr_b16 a[220:221], v241 offset:49152
ds_read_b64_tr_b16 a[222:223], v241 offset:57344
s_waitcnt lgkmcnt(6)
v_mfma_f32_16x16x32_bf16 v[16:19], a[208:211], v[168:171], v[16:19]
v_max3_f32 v192, v192, v154, v155
v_mfma_f32_16x16x32_bf16 v[20:23], a[208:211], v[172:175], v[20:23]
v_max3_f32 v193, v193, v158, v159
ds_read_b64_tr_b16 a[224:225], v242 offset:49152
ds_read_b64_tr_b16 a[226:227], v242 offset:57344
s_waitcnt lgkmcnt(5)
v_mfma_f32_16x16x32_bf16 v[24:27], a[212:215], v[168:171], v[24:27]
ds_read_b64_tr_b16 a[228:229], v243 offset:49152
ds_read_b64_tr_b16 a[230:231], v243 offset:57344
v_mfma_f32_16x16x32_bf16 v[28:31], a[212:215], v[172:175], v[28:31]
ds_read_b64_tr_b16 a[232:233], v236 offset:49408
s_waitcnt lgkmcnt(7)
v_mfma_f32_16x16x32_bf16 v[32:35], a[216:219], v[168:171], v[32:35]
buffer_load_dwordx4 v229, s[16:19], s77 offen offset:2048 lds
v_mfma_f32_16x16x32_bf16 v[36:39], a[216:219], v[172:175], v[36:39]
ds_read_b64_tr_b16 a[234:235], v236 offset:57600
s_waitcnt lgkmcnt(6)
v_mfma_f32_16x16x32_bf16 v[40:43], a[220:223], v[168:171], v[40:43]
ds_read_b64_tr_b16 a[236:237], v237 offset:49408
ds_read_b64_tr_b16 a[238:239], v237 offset:57600
v_mfma_f32_16x16x32_bf16 v[44:47], a[220:223], v[172:175], v[44:47]
ds_read_b64_tr_b16 a[240:241], v238 offset:49408
s_waitcnt lgkmcnt(7)
v_mfma_f32_16x16x32_bf16 v[48:51], a[224:227], v[168:171], v[48:51]
ds_read_b64_tr_b16 a[242:243], v238 offset:57600
v_mfma_f32_16x16x32_bf16 v[52:55], a[224:227], v[172:175], v[52:55]
ds_read_b64_tr_b16 a[244:245], v239 offset:49408
s_waitcnt lgkmcnt(7)
v_mfma_f32_16x16x32_bf16 v[56:59], a[228:231], v[168:171], v[56:59]
ds_read_b64_tr_b16 a[246:247], v239 offset:57600
v_mfma_f32_16x16x32_bf16 v[60:63], a[228:231], v[172:175], v[60:63]
ds_read_b64_tr_b16 a[248:249], v240 offset:49408
s_waitcnt lgkmcnt(7)
v_mfma_f32_16x16x32_bf16 v[64:67], a[232:235], v[168:171], v[64:67]
buffer_load_dwordx4 v230, s[16:19], s77 offen offset:3072 lds
v_mfma_f32_16x16x32_bf16 v[68:71], a[232:235], v[172:175], v[68:71]
s_add_u32 m0, s49, 65536
ds_read_b64_tr_b16 a[250:251], v240 offset:57600
s_waitcnt lgkmcnt(6)
v_mfma_f32_16x16x32_bf16 v[72:75], a[236:239], v[168:171], v[72:75]
s_mov_b32 s77, 245760
ds_read_b64_tr_b16 a[252:253], v241 offset:49408
v_mfma_f32_16x16x32_bf16 v[76:79], a[236:239], v[172:175], v[76:79]
ds_read_b64_tr_b16 a[254:255], v241 offset:57600
s_waitcnt lgkmcnt(6)
v_mfma_f32_16x16x32_bf16 v[80:83], a[240:243], v[168:171], v[80:83]
ds_read_b64_tr_b16 a[176:177], v242 offset:49408
ds_read_b64_tr_b16 a[178:179], v242 offset:57600
ds_read_b64_tr_b16 a[180:181], v243 offset:49408
ds_read_b64_tr_b16 a[182:183], v243 offset:57600
v_mfma_f32_16x16x32_bf16 v[84:87], a[240:243], v[172:175], v[84:87]
s_waitcnt lgkmcnt(7)
v_mfma_f32_16x16x32_bf16 v[88:91], a[244:247], v[168:171], v[88:91]
buffer_load_dwordx4 v244, s[32:35], s70 offen offset:0 lds
v_mfma_f32_16x16x32_bf16 v[92:95], a[244:247], v[172:175], v[92:95]
s_waitcnt lgkmcnt(6)
v_mfma_f32_16x16x32_bf16 v[96:99], a[248:251], v[168:171], v[96:99]
v_exp_f32 v128, v128
v_mfma_f32_16x16x32_bf16 v[100:103], a[248:251], v[172:175], v[100:103]
s_cmp_eq_u32 s79, 7
s_cbranch_scc0 L_sig7
s_lshl_b32 s3, s46, 2
s_add_u32 s3, s3, 128
v_mov_b32 v194, 1
s_mov_b64 exec, 1
buffer_atomic_add v194, off, s[4:7], s3
s_mov_b64 exec, -1
L_sig7:
s_waitcnt lgkmcnt(4)
v_mfma_f32_16x16x32_bf16 v[104:107], a[252:255], v[168:171], v[104:107]
v_mov_b32 v194, 1
s_waitcnt lgkmcnt(0) vmcnt(21)
s_barrier
v_mfma_f32_16x16x32_bf16 v[108:111], a[252:255], v[172:175], v[108:111]
buffer_load_dwordx4 v245, s[32:35], s70 offen offset:1024 lds
ds_read_b128 a[184:187], v231 offset:32768
v_mfma_f32_16x16x32_bf16 v[112:115], a[176:179], v[168:171], v[112:115]
ds_read_b128 a[188:191], v232 offset:32768
v_mfma_f32_16x16x32_bf16 v[116:119], a[176:179], v[172:175], v[116:119]
ds_read_b128 a[192:195], v233 offset:32768
v_mfma_f32_16x16x32_bf16 v[120:123], a[180:183], v[168:171], v[120:123]
v_exp_f32 v129, v129
v_mfma_f32_16x16x32_bf16 v[124:127], a[180:183], v[172:175], v[124:127]
v_exp_f32 v130, v130
v_mfma_f32_16x16x32_bf16 v[176:179], v[196:199], v[168:171], v[176:179]
buffer_load_dwordx4 v246, s[32:35], s70 offen offset:2048 lds
v_mfma_f32_16x16x32_bf16 v[180:183], v[196:199], v[172:175], v[180:183]
v_exp_f32 v131, v131
ds_read_b128 a[196:199], v234 offset:32768
v_cvt_pk_bf16_f32 v160, v128, v129
v_cvt_pk_bf16_f32 v161, v130, v131
s_waitcnt lgkmcnt(3)
v_mfma_f32_16x16x32_bf16 v[128:131], a[184:187], a[112:115], v[184:187]
v_exp_f32 v132, v132
v_exp_f32 v133, v133
v_exp_f32 v134, v134
v_exp_f32 v135, v135
v_cvt_pk_bf16_f32 v164, v132, v133
buffer_load_dwordx4 v247, s[32:35], s70 offen offset:3072 lds
s_add_u32 m0, s49, 69632
s_mov_b32 s70, 212992
v_cvt_pk_bf16_f32 v165, v134, v135
v_mfma_f32_16x16x32_bf16 v[132:135], a[184:187], a[116:119], v[188:191]
ds_read_b128 a[200:203], v231 offset:33024
s_waitcnt lgkmcnt(2)
v_mfma_f32_16x16x32_bf16 v[128:131], a[188:191], a[120:123], v[128:131]
ds_read_b128 a[204:207], v232 offset:33024
v_mfma_f32_16x16x32_bf16 v[132:135], a[188:191], a[124:127], v[132:135]
ds_read_b128 a[208:211], v233 offset:33024
v_mfma_f32_16x16x32_bf16 v[128:131], a[192:195], a[128:131], v[128:131]
ds_read_b128 a[212:215], v234 offset:33024
v_mfma_f32_16x16x32_bf16 v[132:135], a[192:195], a[132:135], v[132:135]
ds_read_b128 a[216:219], v231 offset:40960
s_waitcnt lgkmcnt(5)
v_mfma_f32_16x16x32_bf16 v[128:131], a[196:199], a[136:139], v[128:131]
buffer_load_dwordx4 v244, s[32:35], s71 offen offset:0 lds
v_mfma_f32_16x16x32_bf16 v[132:135], a[196:199], a[140:143], v[132:135]
ds_read_b128 a[220:223], v232 offset:40960
s_waitcnt lgkmcnt(5)
v_mfma_f32_16x16x32_bf16 v[128:131], a[200:203], a[144:147], v[128:131]
ds_read_b128 a[224:227], v233 offset:40960
v_mfma_f32_16x16x32_bf16 v[132:135], a[200:203], a[148:151], v[132:135]
ds_read_b128 a[228:231], v234 offset:40960
s_waitcnt lgkmcnt(6)
v_mfma_f32_16x16x32_bf16 v[128:131], a[204:207], a[152:155], v[128:131]
v_exp_f32 v136, v136
v_mfma_f32_16x16x32_bf16 v[132:135], a[204:207], a[156:159], v[132:135]
ds_read_b128 a[232:235], v231 offset:41216
s_waitcnt lgkmcnt(5)
v_mfma_f32_16x16x32_bf16 v[128:131], a[208:211], a[160:163], v[128:131]
buffer_load_dwordx4 v245, s[32:35], s71 offen offset:1024 lds
v_mfma_f32_16x16x32_bf16 v[132:135], a[208:211], a[164:167], v[132:135]
v_exp_f32 v137, v137
v_mfma_f32_16x16x32_bf16 v[128:131], a[212:215], a[168:171], v[128:131]
v_exp_f32 v138, v138
v_mfma_f32_16x16x32_bf16 v[132:135], a[212:215], a[172:175], v[132:135]
v_exp_f32 v139, v139
v_cvt_pk_bf16_f32 v162, v136, v137
v_cvt_pk_bf16_f32 v163, v138, v139
s_waitcnt lgkmcnt(2)
v_mfma_f32_16x16x32_bf16 v[136:139], a[216:219], a[112:115], v[184:187]
v_exp_f32 v140, v140
buffer_load_dwordx4 v246, s[32:35], s71 offen offset:2048 lds
s_add_u32 m0, s48, 114688
s_add_u32 s71, s50, s55
v_max3_f32 v192, v192, v128, v129
v_max3_f32 v193, v193, v132, v133
v_max3_f32 v192, v192, v130, v131
v_max3_f32 v193, v193, v134, v135
v_exp_f32 v141, v141
v_exp_f32 v142, v142
v_exp_f32 v143, v143
v_cvt_pk_bf16_f32 v166, v140, v141
v_cvt_pk_bf16_f32 v167, v142, v143
v_mfma_f32_16x16x32_bf16 v[140:143], a[216:219], a[116:119], v[188:191]
ds_read_b128 a[236:239], v232 offset:41216
v_mfma_f32_16x16x32_bf16 v[136:139], a[220:223], a[120:123], v[136:139]
ds_read_b128 a[240:243], v233 offset:41216
v_mfma_f32_16x16x32_bf16 v[140:143], a[220:223], a[124:127], v[140:143]
ds_read_b128 a[244:247], v234 offset:41216
v_mfma_f32_16x16x32_bf16 v[136:139], a[224:227], a[128:131], v[136:139]
buffer_load_dwordx4 v223, s[12:15], s72 offen offset:0 lds
v_mfma_f32_16x16x32_bf16 v[140:143], a[224:227], a[132:135], v[140:143]
ds_read_b64_tr_b16 a[248:249], v236 offset:0
s_waitcnt lgkmcnt(4)
v_mfma_f32_16x16x32_bf16 v[136:139], a[228:231], a[136:139], v[136:139]
ds_read_b64_tr_b16 a[250:251], v236 offset:8192
v_mfma_f32_16x16x32_bf16 v[140:143], a[228:231], a[140:143], v[140:143]
ds_read_b64_tr_b16 a[252:253], v237 offset:0
v_mfma_f32_16x16x32_bf16 v[136:139], a[232:235], a[144:147], v[136:139]
ds_read_b64_tr_b16 a[254:255], v237 offset:8192
v_mfma_f32_16x16x32_bf16 v[140:143], a[232:235], a[148:151], v[140:143]
ds_read_b64_tr_b16 a[176:177], v238 offset:0
s_waitcnt lgkmcnt(6)
v_mfma_f32_16x16x32_bf16 v[136:139], a[236:239], a[152:155], v[136:139]
ds_read_b64_tr_b16 a[178:179], v238 offset:8192
v_mfma_f32_16x16x32_bf16 v[140:143], a[236:239], a[156:159], v[140:143]
buffer_load_dwordx4 v224, s[12:15], s72 offen offset:1024 lds
v_mfma_f32_16x16x32_bf16 v[136:139], a[240:243], a[160:163], v[136:139]
ds_read_b64_tr_b16 a[180:181], v239 offset:0
v_mfma_f32_16x16x32_bf16 v[140:143], a[240:243], a[164:167], v[140:143]
ds_read_b64_tr_b16 a[182:183], v239 offset:8192
s_waitcnt lgkmcnt(6)
v_mfma_f32_16x16x32_bf16 v[136:139], a[244:247], a[168:171], v[136:139]
ds_read_b64_tr_b16 a[184:185], v240 offset:0
v_mfma_f32_16x16x32_bf16 v[140:143], a[244:247], a[172:175], v[140:143]
ds_read_b64_tr_b16 a[186:187], v240 offset:8192
v_mfma_f32_16x16x32_bf16 v[0:3], a[248:251], v[160:163], v[0:3]
ds_read_b64_tr_b16 a[188:189], v241 offset:0
v_mfma_f32_16x16x32_bf16 v[4:7], a[248:251], v[164:167], v[4:7]
ds_read_b64_tr_b16 a[190:191], v241 offset:8192
s_waitcnt lgkmcnt(6)
v_mfma_f32_16x16x32_bf16 v[8:11], a[252:255], v[160:163], v[8:11]
buffer_load_dwordx4 v225, s[12:15], s72 offen offset:2048 lds
v_mfma_f32_16x16x32_bf16 v[12:15], a[252:255], v[164:167], v[12:15]
v_max3_f32 v192, v192, v136, v137
v_max3_f32 v193, v193, v140, v141
v_mfma_f32_16x16x32_bf16 v[16:19], a[176:179], v[160:163], v[16:19]
v_max3_f32 v192, v192, v138, v139
v_mfma_f32_16x16x32_bf16 v[20:23], a[176:179], v[164:167], v[20:23]
v_max3_f32 v193, v193, v142, v143
ds_read_b64_tr_b16 a[192:193], v242 offset:0
ds_read_b64_tr_b16 a[194:195], v242 offset:8192
s_waitcnt lgkmcnt(5)
v_mfma_f32_16x16x32_bf16 v[24:27], a[180:183], v[160:163], v[24:27]
ds_read_b64_tr_b16 a[196:197], v243 offset:0
ds_read_b64_tr_b16 a[198:199], v243 offset:8192
v_mfma_f32_16x16x32_bf16 v[28:31], a[180:183], v[164:167], v[28:31]
ds_read_b64_tr_b16 a[200:201], v236 offset:256
s_waitcnt lgkmcnt(5)
v_mfma_f32_16x16x32_bf16 v[32:35], a[184:187], v[160:163], v[32:35]
buffer_load_dwordx4 v226, s[12:15], s72 offen offset:3072 lds
v_mfma_f32_16x16x32_bf16 v[36:39], a[184:187], v[164:167], v[36:39]
s_add_u32 m0, s48, 49152
s_add_u32 s72, s71, 28672
ds_read_b64_tr_b16 a[202:203], v236 offset:8448
v_mfma_f32_16x16x32_bf16 v[40:43], a[188:191], v[160:163], v[40:43]
ds_read_b64_tr_b16 a[204:205], v237 offset:256
ds_read_b64_tr_b16 a[206:207], v237 offset:8448
v_mfma_f32_16x16x32_bf16 v[44:47], a[188:191], v[164:167], v[44:47]
ds_read_b64_tr_b16 a[208:209], v238 offset:256
s_waitcnt lgkmcnt(7)
v_mfma_f32_16x16x32_bf16 v[48:51], a[192:195], v[160:163], v[48:51]
ds_read_b64_tr_b16 a[210:211], v238 offset:8448
v_mfma_f32_16x16x32_bf16 v[52:55], a[192:195], v[164:167], v[52:55]
ds_read_b64_tr_b16 a[212:213], v239 offset:256
s_waitcnt lgkmcnt(7)
v_mfma_f32_16x16x32_bf16 v[56:59], a[196:199], v[160:163], v[56:59]
ds_read_b64_tr_b16 a[214:215], v239 offset:8448
v_mfma_f32_16x16x32_bf16 v[60:63], a[196:199], v[164:167], v[60:63]
buffer_load_dwordx4 v227, s[16:19], s73 offen offset:0 lds
ds_read_b64_tr_b16 a[216:217], v240 offset:256
ds_read_b64_tr_b16 a[218:219], v240 offset:8448
s_waitcnt lgkmcnt(8)
v_mfma_f32_16x16x32_bf16 v[64:67], a[200:203], v[160:163], v[64:67]
ds_read_b64_tr_b16 a[220:221], v241 offset:256
v_mfma_f32_16x16x32_bf16 v[68:71], a[200:203], v[164:167], v[68:71]
ds_read_b64_tr_b16 a[222:223], v241 offset:8448
s_waitcnt lgkmcnt(8)
v_mfma_f32_16x16x32_bf16 v[72:75], a[204:207], v[160:163], v[72:75]
ds_read_b64_tr_b16 a[224:225], v242 offset:256
ds_read_b64_tr_b16 a[226:227], v242 offset:8448
v_mfma_f32_16x16x32_bf16 v[76:79], a[204:207], v[164:167], v[76:79]
ds_read_b64_tr_b16 a[228:229], v243 offset:256
s_waitcnt lgkmcnt(9)
v_mfma_f32_16x16x32_bf16 v[80:83], a[208:211], v[160:163], v[80:83]
ds_read_b64_tr_b16 a[230:231], v243 offset:8448
v_mfma_f32_16x16x32_bf16 v[84:87], a[208:211], v[164:167], v[84:87]
s_waitcnt lgkmcnt(8)
v_mfma_f32_16x16x32_bf16 v[88:91], a[212:215], v[160:163], v[88:91]
buffer_load_dwordx4 v228, s[16:19], s73 offen offset:1024 lds
v_mfma_f32_16x16x32_bf16 v[92:95], a[212:215], v[164:167], v[92:95]
s_waitcnt lgkmcnt(5)
v_mfma_f32_16x16x32_bf16 v[96:99], a[216:219], v[160:163], v[96:99]
v_exp_f32 v144, v144
v_mfma_f32_16x16x32_bf16 v[100:103], a[216:219], v[164:167], v[100:103]
s_waitcnt lgkmcnt(3)
v_mfma_f32_16x16x32_bf16 v[104:107], a[220:223], v[160:163], v[104:107]
v_exp_f32 v145, v145
s_waitcnt lgkmcnt(0) vmcnt(6)
s_barrier
v_mfma_f32_16x16x32_bf16 v[108:111], a[220:223], v[164:167], v[108:111]
ds_read_b128 a[232:235], v231 offset:49152
v_cvt_pk_bf16_f32 v168, v144, v145
v_mfma_f32_16x16x32_bf16 v[112:115], a[224:227], v[160:163], v[112:115]
buffer_load_dwordx4 v229, s[16:19], s73 offen offset:2048 lds
v_mfma_f32_16x16x32_bf16 v[116:119], a[224:227], v[164:167], v[116:119]
ds_read_b128 a[236:239], v232 offset:49152
ds_read_b128 a[240:243], v233 offset:49152
v_mfma_f32_16x16x32_bf16 v[120:123], a[228:231], v[160:163], v[120:123]
v_exp_f32 v146, v146
v_mfma_f32_16x16x32_bf16 v[124:127], a[228:231], v[164:167], v[124:127]
v_exp_f32 v147, v147
v_mfma_f32_16x16x32_bf16 v[176:179], v[196:199], v[160:163], v[176:179]
ds_read_b128 a[244:247], v234 offset:49152
v_cvt_pk_bf16_f32 v169, v146, v147
v_mfma_f32_16x16x32_bf16 v[180:183], v[196:199], v[164:167], v[180:183]
ds_read_b128 a[248:251], v231 offset:49408
s_waitcnt lgkmcnt(4)
v_mfma_f32_16x16x32_bf16 v[144:147], a[232:235], a[112:115], v[184:187]
v_exp_f32 v148, v148
buffer_load_dwordx4 v230, s[16:19], s73 offen offset:3072 lds
s_add_u32 m0, s48, 131072
s_mov_b32 s73, 229376
v_exp_f32 v149, v149
v_exp_f32 v150, v150
v_exp_f32 v151, v151
v_cvt_pk_bf16_f32 v172, v148, v149
v_cvt_pk_bf16_f32 v173, v150, v151
v_mfma_f32_16x16x32_bf16 v[148:151], a[232:235], a[116:119], v[188:191]
ds_read_b128 a[252:255], v232 offset:49408
s_waitcnt lgkmcnt(3)
v_mfma_f32_16x16x32_bf16 v[144:147], a[236:239], a[120:123], v[144:147]
buffer_load_dword v203, off, s[4:7], s74 sc1
v_mfma_f32_16x16x32_bf16 v[148:151], a[236:239], a[124:127], v[148:151]
s_mov_b32 s74, 245760
ds_read_b128 a[176:179], v233 offset:49408
v_mfma_f32_16x16x32_bf16 v[144:147], a[240:243], a[128:131], v[144:147]
ds_read_b128 a[180:183], v234 offset:49408
v_mfma_f32_16x16x32_bf16 v[148:151], a[240:243], a[132:135], v[148:151]
ds_read_b128 a[184:187], v231 offset:57344
s_waitcnt lgkmcnt(4)
v_mfma_f32_16x16x32_bf16 v[144:147], a[244:247], a[136:139], v[144:147]
ds_read_b128 a[188:191], v232 offset:57344
v_mfma_f32_16x16x32_bf16 v[148:151], a[244:247], a[140:143], v[148:151]
ds_read_b128 a[192:195], v233 offset:57344
v_mfma_f32_16x16x32_bf16 v[144:147], a[248:251], a[144:147], v[144:147]
v_exp_f32 v152, v152
v_mfma_f32_16x16x32_bf16 v[148:151], a[248:251], a[148:151], v[148:151]
ds_read_b128 a[196:199], v234 offset:57344
s_waitcnt lgkmcnt(6)
v_mfma_f32_16x16x32_bf16 v[144:147], a[252:255], a[152:155], v[144:147]
buffer_load_dwordx4 v223, s[12:15], s75 offen offset:0 lds
v_mfma_f32_16x16x32_bf16 v[148:151], a[252:255], a[156:159], v[148:151]
ds_read_b128 a[200:203], v231 offset:57600
s_waitcnt lgkmcnt(5)
v_mfma_f32_16x16x32_bf16 v[144:147], a[176:179], a[160:163], v[144:147]
v_exp_f32 v153, v153
v_mfma_f32_16x16x32_bf16 v[148:151], a[176:179], a[164:167], v[148:151]
v_exp_f32 v154, v154
v_mfma_f32_16x16x32_bf16 v[144:147], a[180:183], a[168:171], v[144:147]
v_exp_f32 v155, v155
v_mfma_f32_16x16x32_bf16 v[148:151], a[180:183], a[172:175], v[148:151]
v_cvt_pk_bf16_f32 v170, v152, v153
v_cvt_pk_bf16_f32 v171, v154, v155
s_waitcnt lgkmcnt(2)
v_mfma_f32_16x16x32_bf16 v[152:155], a[184:187], a[112:115], v[184:187]
v_exp_f32 v156, v156
buffer_load_dwordx4 v224, s[12:15], s75 offen offset:1024 lds
v_max3_f32 v192, v192, v144, v145
v_max3_f32 v192, v192, v146, v147
v_max3_f32 v193, v193, v148, v149
v_max3_f32 v193, v193, v150, v151
v_exp_f32 v157, v157
v_exp_f32 v158, v158
v_exp_f32 v159, v159
v_cvt_pk_bf16_f32 v174, v156, v157
v_cvt_pk_bf16_f32 v175, v158, v159
v_mfma_f32_16x16x32_bf16 v[156:159], a[184:187], a[116:119], v[188:191]
ds_read_b128 a[204:207], v232 offset:57600
v_mfma_f32_16x16x32_bf16 v[152:155], a[188:191], a[120:123], v[152:155]
ds_read_b128 a[208:211], v233 offset:57600
v_mfma_f32_16x16x32_bf16 v[156:159], a[188:191], a[124:127], v[156:159]
ds_read_b128 a[212:215], v234 offset:57600
v_mfma_f32_16x16x32_bf16 v[152:155], a[192:195], a[128:131], v[152:155]
ds_read_b64_tr_b16 a[216:217], v236 offset:16384
v_mfma_f32_16x16x32_bf16 v[156:159], a[192:195], a[132:135], v[156:159]
ds_read_b64_tr_b16 a[218:219], v236 offset:24576
s_waitcnt lgkmcnt(5)
v_mfma_f32_16x16x32_bf16 v[152:155], a[196:199], a[136:139], v[152:155]
buffer_load_dwordx4 v225, s[12:15], s75 offen offset:2048 lds
v_mfma_f32_16x16x32_bf16 v[156:159], a[196:199], a[140:143], v[156:159]
ds_read_b64_tr_b16 a[220:221], v237 offset:16384
v_mfma_f32_16x16x32_bf16 v[152:155], a[200:203], a[144:147], v[152:155]
ds_read_b64_tr_b16 a[222:223], v237 offset:24576
v_mfma_f32_16x16x32_bf16 v[156:159], a[200:203], a[148:151], v[156:159]
ds_read_b64_tr_b16 a[224:225], v238 offset:16384
s_waitcnt lgkmcnt(6)
v_mfma_f32_16x16x32_bf16 v[152:155], a[204:207], a[152:155], v[152:155]
ds_read_b64_tr_b16 a[226:227], v238 offset:24576
v_mfma_f32_16x16x32_bf16 v[156:159], a[204:207], a[156:159], v[156:159]
ds_read_b64_tr_b16 a[228:229], v239 offset:16384
v_mfma_f32_16x16x32_bf16 v[152:155], a[208:211], a[160:163], v[152:155]
ds_read_b64_tr_b16 a[230:231], v239 offset:24576
v_mfma_f32_16x16x32_bf16 v[156:159], a[208:211], a[164:167], v[156:159]
ds_read_b64_tr_b16 a[232:233], v240 offset:16384
s_waitcnt lgkmcnt(7)
v_mfma_f32_16x16x32_bf16 v[152:155], a[212:215], a[168:171], v[152:155]
buffer_load_dwordx4 v226, s[12:15], s75 offen offset:3072 lds
v_mfma_f32_16x16x32_bf16 v[156:159], a[212:215], a[172:175], v[156:159]
s_add_u32 m0, s48, 0
s_add_u32 s75, s50, s57
v_mfma_f32_16x16x32_bf16 v[0:3], a[216:219], v[168:171], v[0:3]
ds_read_b64_tr_b16 a[234:235], v240 offset:24576
v_mfma_f32_16x16x32_bf16 v[4:7], a[216:219], v[172:175], v[4:7]
ds_read_b64_tr_b16 a[236:237], v241 offset:16384
s_waitcnt lgkmcnt(5)
v_mfma_f32_16x16x32_bf16 v[8:11], a[220:223], v[168:171], v[8:11]
v_max3_f32 v192, v192, v152, v153
v_max3_f32 v193, v193, v156, v157
v_mfma_f32_16x16x32_bf16 v[12:15], a[220:223], v[172:175], v[12:15]
v_max3_f32 v192, v192, v154, v155
ds_read_b64_tr_b16 a[238:239], v241 offset:24576
v_mfma_f32_16x16x32_bf16 v[16:19], a[224:227], v[168:171], v[16:19]
v_max3_f32 v193, v193, v158, v159
ds_read_b64_tr_b16 a[240:241], v242 offset:16384
ds_read_b64_tr_b16 a[242:243], v242 offset:24576
ds_read_b64_tr_b16 a[244:245], v243 offset:16384
ds_read_b64_tr_b16 a[246:247], v243 offset:24576
ds_read_b64_tr_b16 a[248:249], v236 offset:16640
ds_read_b64_tr_b16 a[250:251], v236 offset:24832
ds_read_b64_tr_b16 a[252:253], v237 offset:16640
ds_read_b64_tr_b16 a[254:255], v237 offset:24832
ds_read_b64_tr_b16 a[176:177], v238 offset:16640
ds_read_b64_tr_b16 a[178:179], v238 offset:24832
ds_read_b64_tr_b16 a[180:181], v239 offset:16640
ds_read_b64_tr_b16 a[182:183], v239 offset:24832
ds_read_b64_tr_b16 a[184:185], v240 offset:16640
ds_read_b64_tr_b16 a[186:187], v240 offset:24832
ds_read_b64_tr_b16 a[188:189], v241 offset:16640
ds_read_b64_tr_b16 a[190:191], v241 offset:24832
ds_read_b64_tr_b16 a[192:193], v242 offset:16640
ds_read_b64_tr_b16 a[194:195], v242 offset:24832
ds_read_b64_tr_b16 a[196:197], v243 offset:16640
ds_read_b64_tr_b16 a[198:199], v243 offset:24832
ds_read_b64_tr_b16 a[200:201], v249 offset:0
ds_read_b64_tr_b16 a[202:203], v249 offset:2048
ds_read_b64_tr_b16 a[204:205], v249 offset:4096
ds_read_b64_tr_b16 a[206:207], v249 offset:6144
ds_read_b64_tr_b16 a[208:209], v249 offset:8192
ds_read_b64_tr_b16 a[210:211], v249 offset:10240
ds_read_b64_tr_b16 a[212:213], v249 offset:12288
ds_read_b64_tr_b16 a[214:215], v249 offset:14336
ds_read_b64_tr_b16 a[216:217], v249 offset:16384
ds_read_b64_tr_b16 a[218:219], v249 offset:18432
ds_read_b64_tr_b16 a[220:221], v249 offset:20480
ds_read_b64_tr_b16 a[222:223], v249 offset:22528
v_mfma_f32_16x16x32_bf16 v[20:23], a[224:227], v[172:175], v[20:23]
ds_read_b64_tr_b16 a[224:225], v249 offset:24576
ds_read_b64_tr_b16 a[226:227], v249 offset:26624
s_waitcnt lgkmcnt(14)
v_mfma_f32_16x16x32_bf16 v[24:27], a[228:231], v[168:171], v[24:27]
buffer_load_dwordx4 v227, s[16:19], s76 offen offset:0 lds
v_mfma_f32_16x16x32_bf16 v[28:31], a[228:231], v[172:175], v[28:31]
v_exp_f32 v128, v128
v_mfma_f32_16x16x32_bf16 v[32:35], a[232:235], v[168:171], v[32:35]
v_exp_f32 v129, v129
v_mfma_f32_16x16x32_bf16 v[36:39], a[232:235], v[172:175], v[36:39]
v_exp_f32 v130, v130
v_mfma_f32_16x16x32_bf16 v[40:43], a[236:239], v[168:171], v[40:43]
v_exp_f32 v131, v131
v_mfma_f32_16x16x32_bf16 v[44:47], a[236:239], v[172:175], v[44:47]
v_cvt_pk_bf16_f32 v160, v128, v129
s_waitcnt lgkmcnt(0)
s_barrier
ds_read_b128 a[228:231], v231 offset:0
ds_read_b128 a[232:235], v232 offset:0
buffer_load_dwordx4 v228, s[16:19], s76 offen offset:1024 lds
ds_read_b128 a[236:239], v233 offset:0
v_mfma_f32_16x16x32_bf16 v[48:51], a[240:243], v[168:171], v[48:51]
v_cvt_pk_bf16_f32 v161, v130, v131
v_mfma_f32_16x16x32_bf16 v[52:55], a[240:243], v[172:175], v[52:55]
ds_read_b128 a[240:243], v234 offset:0
v_mfma_f32_16x16x32_bf16 v[56:59], a[244:247], v[168:171], v[56:59]
v_exp_f32 v132, v132
v_mfma_f32_16x16x32_bf16 v[60:63], a[244:247], v[172:175], v[60:63]
ds_read_b128 a[244:247], v231 offset:256
v_mfma_f32_16x16x32_bf16 v[64:67], a[248:251], v[168:171], v[64:67]
v_exp_f32 v133, v133
v_mfma_f32_16x16x32_bf16 v[68:71], a[248:251], v[172:175], v[68:71]
ds_read_b128 a[248:251], v232 offset:256
v_cvt_pk_bf16_f32 v164, v132, v133
v_mfma_f32_16x16x32_bf16 v[72:75], a[252:255], v[168:171], v[72:75]
buffer_load_dwordx4 v229, s[16:19], s76 offen offset:2048 lds
v_mfma_f32_16x16x32_bf16 v[76:79], a[252:255], v[172:175], v[76:79]
ds_read_b128 a[252:255], v233 offset:256
v_mfma_f32_16x16x32_bf16 v[80:83], a[176:179], v[168:171], v[80:83]
v_exp_f32 v134, v134
v_mfma_f32_16x16x32_bf16 v[84:87], a[176:179], v[172:175], v[84:87]
ds_read_b128 a[176:179], v234 offset:256
v_mfma_f32_16x16x32_bf16 v[88:91], a[180:183], v[168:171], v[88:91]
v_exp_f32 v135, v135
v_mfma_f32_16x16x32_bf16 v[92:95], a[180:183], v[172:175], v[92:95]
ds_read_b128 a[180:183], v231 offset:8192
v_cvt_pk_bf16_f32 v165, v134, v135
v_mfma_f32_16x16x32_bf16 v[96:99], a[184:187], v[168:171], v[96:99]
v_exp_f32 v136, v136
v_mfma_f32_16x16x32_bf16 v[100:103], a[184:187], v[172:175], v[100:103]
buffer_load_dwordx4 v230, s[16:19], s76 offen offset:3072 lds
s_add_u32 m0, s48, 147456
ds_read_b128 a[184:187], v232 offset:8192
v_mfma_f32_16x16x32_bf16 v[104:107], a[188:191], v[168:171], v[104:107]
s_add_u32 s76, s75, 28672
v_exp_f32 v137, v137
v_mfma_f32_16x16x32_bf16 v[108:111], a[188:191], v[172:175], v[108:111]
ds_read_b128 a[188:191], v233 offset:8192
v_cvt_pk_bf16_f32 v162, v136, v137
v_mfma_f32_16x16x32_bf16 v[112:115], a[192:195], v[168:171], v[112:115]
v_exp_f32 v138, v138
v_mfma_f32_16x16x32_bf16 v[116:119], a[192:195], v[172:175], v[116:119]
ds_read_b128 a[192:195], v234 offset:8192
v_mfma_f32_16x16x32_bf16 v[120:123], a[196:199], v[168:171], v[120:123]
v_exp_f32 v139, v139
v_mfma_f32_16x16x32_bf16 v[124:127], a[196:199], v[172:175], v[124:127]
buffer_load_dwordx4 v223, s[12:15], s77 offen offset:0 lds
ds_read_b128 a[196:199], v231 offset:8448
v_mfma_f32_16x16x32_bf16 v[176:179], v[196:199], v[168:171], v[176:179]
v_exp_f32 v140, v140
v_mfma_f32_16x16x32_bf16 v[180:183], v[196:199], v[172:175], v[180:183]
v_exp_f32 v141, v141
v_mfma_f32_16x16x32_bf16 v[206:209], a[200:203], a[0:3], 0
v_exp_f32 v142, v142
v_mfma_f32_16x16x32_bf16 v[210:213], a[200:203], a[4:7], 0
v_exp_f32 v143, v143
v_mfma_f32_16x16x32_bf16 v[214:217], a[200:203], a[8:11], 0
v_exp_f32 v144, v144
v_mfma_f32_16x16x32_bf16 v[218:221], a[200:203], a[12:15], 0
ds_read_b128 a[200:203], v232 offset:8448
v_cvt_pk_bf16_f32 v163, v138, v139
buffer_load_dwordx4 v224, s[12:15], s77 offen offset:1024 lds
v_mfma_f32_16x16x32_bf16 v[206:209], a[204:207], a[16:19], v[206:209]
v_exp_f32 v145, v145
v_mfma_f32_16x16x32_bf16 v[210:213], a[204:207], a[20:23], v[210:213]
v_exp_f32 v146, v146
v_mfma_f32_16x16x32_bf16 v[214:217], a[204:207], a[24:27], v[214:217]
v_exp_f32 v147, v147
v_mfma_f32_16x16x32_bf16 v[218:221], a[204:207], a[28:31], v[218:221]
ds_read_b128 a[204:207], v233 offset:8448
v_cvt_pk_bf16_f32 v166, v140, v141
v_mfma_f32_16x16x32_bf16 v[206:209], a[208:211], a[32:35], v[206:209]
v_exp_f32 v152, v152
v_mfma_f32_16x16x32_bf16 v[210:213], a[208:211], a[36:39], v[210:213]
v_exp_f32 v153, v153
v_mfma_f32_16x16x32_bf16 v[214:217], a[208:211], a[40:43], v[214:217]
v_exp_f32 v154, v154
buffer_load_dwordx4 v225, s[12:15], s77 offen offset:2048 lds
v_mfma_f32_16x16x32_bf16 v[218:221], a[208:211], a[44:47], v[218:221]
ds_read_b128 a[208:211], v234 offset:8448
v_cvt_pk_bf16_f32 v167, v142, v143
v_mfma_f32_16x16x32_bf16 v[206:209], a[212:215], a[48:51], v[206:209]
v_exp_f32 v155, v155
v_mfma_f32_16x16x32_bf16 v[210:213], a[212:215], a[52:55], v[210:213]
v_exp_f32 v148, v148
v_mfma_f32_16x16x32_bf16 v[214:217], a[212:215], a[56:59], v[214:217]
v_exp_f32 v149, v149
v_mfma_f32_16x16x32_bf16 v[218:221], a[212:215], a[60:63], v[218:221]
ds_read_b64_tr_b16 a[212:213], v236 offset:32768
v_cvt_pk_bf16_f32 v168, v144, v145
ds_read_b64_tr_b16 a[214:215], v236 offset:40960
v_mfma_f32_16x16x32_bf16 v[206:209], a[216:219], a[64:67], v[206:209]
v_exp_f32 v150, v150
v_mfma_f32_16x16x32_bf16 v[210:213], a[216:219], a[68:71], v[210:213]
buffer_load_dwordx4 v226, s[12:15], s77 offen offset:3072 lds
s_add_u32 m0, s48, 16384
v_mfma_f32_16x16x32_bf16 v[214:217], a[216:219], a[72:75], v[214:217]
s_add_u32 s77, s50, s56
v_exp_f32 v151, v151
v_mfma_f32_16x16x32_bf16 v[218:221], a[216:219], a[76:79], v[218:221]
ds_read_b64_tr_b16 a[216:217], v237 offset:32768
v_cvt_pk_bf16_f32 v169, v146, v147
ds_read_b64_tr_b16 a[218:219], v237 offset:40960
v_mfma_f32_16x16x32_bf16 v[206:209], a[220:223], a[80:83], v[206:209]
v_exp_f32 v156, v156
v_mfma_f32_16x16x32_bf16 v[210:213], a[220:223], a[84:87], v[210:213]
v_exp_f32 v157, v157
v_mfma_f32_16x16x32_bf16 v[214:217], a[220:223], a[88:91], v[214:217]
v_exp_f32 v158, v158
v_mfma_f32_16x16x32_bf16 v[218:221], a[220:223], a[92:95], v[218:221]
buffer_load_dwordx4 v227, s[16:19], s70 offen offset:0 lds
ds_read_b64_tr_b16 a[220:221], v238 offset:32768
ds_read_b64_tr_b16 a[222:223], v238 offset:40960
v_mfma_f32_16x16x32_bf16 v[206:209], a[224:227], a[96:99], v[206:209]
v_exp_f32 v159, v159
v_mfma_f32_16x16x32_bf16 v[210:213], a[224:227], a[100:103], v[210:213]
v_cvt_pk_bf16_f32 v170, v152, v153
v_mfma_f32_16x16x32_bf16 v[214:217], a[224:227], a[104:107], v[214:217]
v_cvt_pk_bf16_f32 v171, v154, v155
v_mfma_f32_16x16x32_bf16 v[218:221], a[224:227], a[108:111], v[218:221]
ds_read_b64_tr_b16 a[224:225], v239 offset:32768
ds_read_b64_tr_b16 a[226:227], v239 offset:40960
v_cvt_pk_bf16_f32 v206, v206, v207
v_cvt_pk_bf16_f32 v207, v208, v209
v_cvt_pk_bf16_f32 v208, v210, v211
v_cvt_pk_bf16_f32 v209, v212, v213
v_cvt_pk_bf16_f32 v210, v214, v215
buffer_load_dwordx4 v228, s[16:19], s70 offen offset:1024 lds
v_cvt_pk_bf16_f32 v211, v216, v217
v_cvt_pk_bf16_f32 v212, v218, v219
v_cvt_pk_bf16_f32 v213, v220, v221
s_waitcnt lgkmcnt(4)
v_mfma_f32_16x16x32_bf16 v[128:131], a[228:231], a[112:115], v[184:187]
buffer_store_dwordx4 v[206:209], v253, s[36:39], s100 offen offset:0 sc1
v_mfma_f32_16x16x32_bf16 v[132:135], a[228:231], a[116:119], v[188:191]
ds_read_b64_tr_b16 a[228:229], v240 offset:32768
v_cvt_pk_bf16_f32 v172, v148, v149
buffer_store_dwordx4 v[210:213], v253, s[36:39], s100 offen offset:1024 sc1
ds_read_b64_tr_b16 a[230:231], v240 offset:40960
v_mfma_f32_16x16x32_bf16 v[128:131], a[232:235], a[120:123], v[128:131]
v_cvt_pk_bf16_f32 v173, v150, v151
s_waitcnt vmcnt(16)
v_readfirstlane_b32 s3, v203
s_nop 3
s_cmp_ge_u32 s3, 8
s_cbranch_scc1 L_rdy_ok
s_lshl_b32 s69, s46, 2
s_add_u32 s69, s69, 128
s_mov_b32 s100, 0x5000
L_rdy_spin:
s_sleep 8
buffer_load_dword v203, off, s[4:7], s69 sc1
s_waitcnt vmcnt(0)
v_readfirstlane_b32 s3, v203
s_sub_u32 s100, s100, 1
s_cmp_eq_u32 s100, 0
s_cbranch_scc1 L_rdy_ok
s_cmp_lt_u32 s3, 8
s_cbranch_scc1 L_rdy_spin
L_rdy_ok:
s_add_u32 s100, s62, 8192
s_lshl_b32 s3, s52, 1
s_add_u32 s3, s3, s66
s_mov_b64 exec, 1
buffer_store_dword v194, off, s[36:39], s3 offset:128 sc1
s_mov_b64 exec, -1
s_lshl_b32 s3, s53, 1
s_add_u32 s3, s3, s66
s_mov_b64 exec, 1
buffer_store_dword v194, off, s[36:39], s3 offset:128 sc1
s_mov_b64 exec, -1
v_mfma_f32_16x16x32_bf16 v[132:135], a[232:235], a[124:127], v[132:135]
ds_read_b64_tr_b16 a[232:233], v241 offset:32768
v_cvt_pk_bf16_f32 v174, v156, v157
ds_read_b64_tr_b16 a[234:235], v241 offset:40960
v_mfma_f32_16x16x32_bf16 v[128:131], a[236:239], a[128:131], v[128:131]
v_cvt_pk_bf16_f32 v175, v158, v159
v_mfma_f32_16x16x32_bf16 v[132:135], a[236:239], a[132:135], v[132:135]
ds_read_b64_tr_b16 a[236:237], v242 offset:32768
ds_read_b64_tr_b16 a[238:239], v242 offset:40960
v_mfma_f32_16x16x32_bf16 v[128:131], a[240:243], a[136:139], v[128:131]
v_mfma_f32_16x16x32_bf16 v[132:135], a[240:243], a[140:143], v[132:135]
ds_read_b64_tr_b16 a[240:241], v243 offset:32768
ds_read_b64_tr_b16 a[242:243], v243 offset:40960
buffer_load_dwordx4 v229, s[16:19], s70 offen offset:2048 lds
v_mfma_f32_16x16x32_bf16 v[128:131], a[244:247], a[144:147], v[128:131]
v_mfma_f32_16x16x32_bf16 v[132:135], a[244:247], a[148:151], v[132:135]
ds_read_b64_tr_b16 a[244:245], v236 offset:33024
ds_read_b64_tr_b16 a[246:247], v236 offset:41216
v_mfma_f32_16x16x32_bf16 v[128:131], a[248:251], a[152:155], v[128:131]
v_mfma_f32_16x16x32_bf16 v[132:135], a[248:251], a[156:159], v[132:135]
ds_read_b64_tr_b16 a[248:249], v237 offset:33024
ds_read_b64_tr_b16 a[250:251], v237 offset:41216
v_mfma_f32_16x16x32_bf16 v[128:131], a[252:255], a[160:163], v[128:131]
v_mfma_f32_16x16x32_bf16 v[132:135], a[252:255], a[164:167], v[132:135]
ds_read_b64_tr_b16 a[252:253], v238 offset:33024
ds_read_b64_tr_b16 a[254:255], v238 offset:41216
buffer_load_dwordx4 v230, s[16:19], s70 offen offset:3072 lds
s_add_u32 m0, s49, 65536
s_add_u32 s70, s77, 28672
v_mfma_f32_16x16x32_bf16 v[128:131], a[176:179], a[168:171], v[128:131]
v_mfma_f32_16x16x32_bf16 v[132:135], a[176:179], a[172:175], v[132:135]
ds_read_b64_tr_b16 a[176:177], v239 offset:33024
ds_read_b64_tr_b16 a[178:179], v239 offset:41216
v_mfma_f32_16x16x32_bf16 v[136:139], a[180:183], a[112:115], v[184:187]
v_mfma_f32_16x16x32_bf16 v[140:143], a[180:183], a[116:119], v[188:191]
ds_read_b64_tr_b16 a[180:181], v240 offset:33024
ds_read_b64_tr_b16 a[182:183], v240 offset:41216
v_mfma_f32_16x16x32_bf16 v[136:139], a[184:187], a[120:123], v[136:139]
buffer_load_dwordx4 v244, s[32:35], s71 offen offset:0 lds
v_max3_f32 v192, v192, v128, v129
v_max3_f32 v193, v193, v132, v133
v_max3_f32 v192, v192, v130, v131
v_max3_f32 v193, v193, v134, v135
v_exp_f32 v128, v128
v_exp_f32 v129, v129
v_exp_f32 v130, v130
v_exp_f32 v131, v131
v_exp_f32 v132, v132
v_exp_f32 v133, v133
v_exp_f32 v134, v134
v_exp_f32 v135, v135
buffer_load_dwordx4 v245, s[32:35], s71 offen offset:1024 lds
v_mfma_f32_16x16x32_bf16 v[140:143], a[184:187], a[124:127], v[140:143]
ds_read_b64_tr_b16 a[184:185], v241 offset:33024
ds_read_b64_tr_b16 a[186:187], v241 offset:41216
v_mfma_f32_16x16x32_bf16 v[136:139], a[188:191], a[128:131], v[136:139]
v_mfma_f32_16x16x32_bf16 v[140:143], a[188:191], a[132:135], v[140:143]
ds_read_b64_tr_b16 a[188:189], v242 offset:33024
ds_read_b64_tr_b16 a[190:191], v242 offset:41216
v_mfma_f32_16x16x32_bf16 v[136:139], a[192:195], a[136:139], v[136:139]
v_mfma_f32_16x16x32_bf16 v[140:143], a[192:195], a[140:143], v[140:143]
ds_read_b64_tr_b16 a[192:193], v243 offset:33024
buffer_load_dwordx4 v246, s[32:35], s71 offen offset:2048 lds
ds_read_b64_tr_b16 a[194:195], v243 offset:41216
v_mfma_f32_16x16x32_bf16 v[136:139], a[196:199], a[144:147], v[136:139]
v_mfma_f32_16x16x32_bf16 v[140:143], a[196:199], a[148:151], v[140:143]
v_mfma_f32_16x16x32_bf16 v[136:139], a[200:203], a[152:155], v[136:139]
v_mfma_f32_16x16x32_bf16 v[140:143], a[200:203], a[156:159], v[140:143]
v_mfma_f32_16x16x32_bf16 v[136:139], a[204:207], a[160:163], v[136:139]
buffer_load_dwordx4 v247, s[32:35], s71 offen offset:3072 lds
s_add_u32 m0, s49, 69632
s_add_u32 s71, s50, s58
v_mfma_f32_16x16x32_bf16 v[140:143], a[204:207], a[164:167], v[140:143]
s_waitcnt lgkmcnt(0)
s_barrier
ds_read_b128 a[196:199], v231 offset:16384
ds_read_b128 a[200:203], v232 offset:16384
ds_read_b128 a[204:207], v233 offset:16384
v_mfma_f32_16x16x32_bf16 v[136:139], a[208:211], a[168:171], v[136:139]
v_mfma_f32_16x16x32_bf16 v[140:143], a[208:211], a[172:175], v[140:143]
ds_read_b128 a[208:211], v234 offset:16384
buffer_load_dwordx4 v244, s[32:35], s72 offen offset:0 lds
v_mfma_f32_16x16x32_bf16 v[0:3], a[212:215], v[160:163], v[0:3]
v_mfma_f32_16x16x32_bf16 v[4:7], a[212:215], v[164:167], v[4:7]
ds_read_b128 a[212:215], v231 offset:16640
v_mfma_f32_16x16x32_bf16 v[8:11], a[216:219], v[160:163], v[8:11]
v_mfma_f32_16x16x32_bf16 v[12:15], a[216:219], v[164:167], v[12:15]
v_max3_f32 v192, v192, v136, v137
v_max3_f32 v193, v193, v140, v141
v_max3_f32 v192, v192, v138, v139
v_max3_f32 v193, v193, v142, v143
ds_read_b128 a[216:219], v232 offset:16640
v_exp_f32 v136, v136
buffer_load_dwordx4 v245, s[32:35], s72 offen offset:1024 lds
v_exp_f32 v137, v137
v_exp_f32 v138, v138
v_exp_f32 v139, v139
v_exp_f32 v140, v140
v_exp_f32 v141, v141
v_exp_f32 v142, v142
v_exp_f32 v143, v143
v_mfma_f32_16x16x32_bf16 v[16:19], a[220:223], v[160:163], v[16:19]
v_mfma_f32_16x16x32_bf16 v[20:23], a[220:223], v[164:167], v[20:23]
ds_read_b128 a[220:223], v233 offset:16640
buffer_load_dwordx4 v246, s[32:35], s72 offen offset:2048 lds
s_add_u32 m0, s48, 32768
s_add_u32 s72, s71, 28672
v_mfma_f32_16x16x32_bf16 v[24:27], a[224:227], v[160:163], v[24:27]
v_mfma_f32_16x16x32_bf16 v[28:31], a[224:227], v[164:167], v[28:31]
ds_read_b128 a[224:227], v234 offset:16640
v_mfma_f32_16x16x32_bf16 v[32:35], a[228:231], v[160:163], v[32:35]
v_mfma_f32_16x16x32_bf16 v[36:39], a[228:231], v[164:167], v[36:39]
ds_read_b128 a[228:231], v231 offset:24576
v_mfma_f32_16x16x32_bf16 v[40:43], a[232:235], v[160:163], v[40:43]
v_mfma_f32_16x16x32_bf16 v[44:47], a[232:235], v[164:167], v[44:47]
ds_read_b128 a[232:235], v232 offset:24576
v_mfma_f32_16x16x32_bf16 v[48:51], a[236:239], v[160:163], v[48:51]
buffer_load_dwordx4 v227, s[16:19], s73 offen offset:0 lds
v_mfma_f32_16x16x32_bf16 v[52:55], a[236:239], v[164:167], v[52:55]
ds_read_b128 a[236:239], v233 offset:24576
v_mfma_f32_16x16x32_bf16 v[56:59], a[240:243], v[160:163], v[56:59]
v_mfma_f32_16x16x32_bf16 v[60:63], a[240:243], v[164:167], v[60:63]
ds_read_b128 a[240:243], v234 offset:24576
v_mfma_f32_16x16x32_bf16 v[64:67], a[244:247], v[160:163], v[64:67]
v_mfma_f32_16x16x32_bf16 v[68:71], a[244:247], v[164:167], v[68:71]
ds_read_b128 a[244:247], v231 offset:24832
v_mfma_f32_16x16x32_bf16 v[72:75], a[248:251], v[160:163], v[72:75]
v_mfma_f32_16x16x32_bf16 v[76:79], a[248:251], v[164:167], v[76:79]
buffer_load_dwordx4 v228, s[16:19], s73 offen offset:1024 lds
ds_read_b128 a[248:251], v232 offset:24832
v_mfma_f32_16x16x32_bf16 v[80:83], a[252:255], v[160:163], v[80:83]
v_mfma_f32_16x16x32_bf16 v[84:87], a[252:255], v[164:167], v[84:87]
ds_read_b128 a[252:255], v233 offset:24832
v_mfma_f32_16x16x32_bf16 v[88:91], a[176:179], v[160:163], v[88:91]
v_mfma_f32_16x16x32_bf16 v[92:95], a[176:179], v[164:167], v[92:95]
ds_read_b128 a[176:179], v234 offset:24832
v_mfma_f32_16x16x32_bf16 v[96:99], a[180:183], v[160:163], v[96:99]
v_mfma_f32_16x16x32_bf16 v[100:103], a[180:183], v[164:167], v[100:103]
ds_read_b64_tr_b16 a[180:181], v236 offset:49152
ds_read_b64_tr_b16 a[182:183], v236 offset:57344
buffer_load_dwordx4 v229, s[16:19], s73 offen offset:2048 lds
v_mfma_f32_16x16x32_bf16 v[104:107], a[184:187], v[160:163], v[104:107]
v_mfma_f32_16x16x32_bf16 v[108:111], a[184:187], v[164:167], v[108:111]
ds_read_b64_tr_b16 a[184:185], v237 offset:49152
ds_read_b64_tr_b16 a[186:187], v237 offset:57344
v_mfma_f32_16x16x32_bf16 v[112:115], a[188:191], v[160:163], v[112:115]
v_mfma_f32_16x16x32_bf16 v[116:119], a[188:191], v[164:167], v[116:119]
ds_read_b64_tr_b16 a[188:189], v238 offset:49152
ds_read_b64_tr_b16 a[190:191], v238 offset:57344
v_mfma_f32_16x16x32_bf16 v[120:123], a[192:195], v[160:163], v[120:123]
v_mfma_f32_16x16x32_bf16 v[124:127], a[192:195], v[164:167], v[124:127]
ds_read_b64_tr_b16 a[192:193], v239 offset:49152
ds_read_b64_tr_b16 a[194:195], v239 offset:57344
buffer_load_dwordx4 v230, s[16:19], s73 offen offset:3072 lds
s_add_u32 m0, s48, 49152
v_mfma_f32_16x16x32_bf16 v[176:179], v[196:199], v[160:163], v[176:179]
s_add_u32 s73, s51, s52
v_cvt_pk_bf16_f32 v160, v128, v129
v_cvt_pk_bf16_f32 v161, v130, v131
v_cvt_pk_bf16_f32 v162, v136, v137
v_cvt_pk_bf16_f32 v163, v138, v139
v_mfma_f32_16x16x32_bf16 v[180:183], v[196:199], v[164:167], v[180:183]
v_cvt_pk_bf16_f32 v164, v132, v133
v_cvt_pk_bf16_f32 v165, v134, v135
v_cvt_pk_bf16_f32 v166, v140, v141
v_cvt_pk_bf16_f32 v167, v142, v143
s_waitcnt lgkmcnt(4)
v_mfma_f32_16x16x32_bf16 v[144:147], a[196:199], a[112:115], v[184:187]
v_mfma_f32_16x16x32_bf16 v[148:151], a[196:199], a[116:119], v[188:191]
ds_read_b64_tr_b16 a[196:197], v240 offset:49152
ds_read_b64_tr_b16 a[198:199], v240 offset:57344
v_mfma_f32_16x16x32_bf16 v[144:147], a[200:203], a[120:123], v[144:147]
v_mfma_f32_16x16x32_bf16 v[148:151], a[200:203], a[124:127], v[148:151]
ds_read_b64_tr_b16 a[200:201], v241 offset:49152
ds_read_b64_tr_b16 a[202:203], v241 offset:57344
v_mfma_f32_16x16x32_bf16 v[144:147], a[204:207], a[128:131], v[144:147]
v_mfma_f32_16x16x32_bf16 v[148:151], a[204:207], a[132:135], v[148:151]
ds_read_b64_tr_b16 a[204:205], v242 offset:49152
ds_read_b64_tr_b16 a[206:207], v242 offset:57344
v_mfma_f32_16x16x32_bf16 v[144:147], a[208:211], a[136:139], v[144:147]
v_mfma_f32_16x16x32_bf16 v[148:151], a[208:211], a[140:143], v[148:151]
ds_read_b64_tr_b16 a[208:209], v243 offset:49152
ds_read_b64_tr_b16 a[210:211], v243 offset:57344
v_mfma_f32_16x16x32_bf16 v[144:147], a[212:215], a[144:147], v[144:147]
v_mfma_f32_16x16x32_bf16 v[148:151], a[212:215], a[148:151], v[148:151]
ds_read_b64_tr_b16 a[212:213], v236 offset:49408
ds_read_b64_tr_b16 a[214:215], v236 offset:57600
v_mfma_f32_16x16x32_bf16 v[144:147], a[216:219], a[152:155], v[144:147]
v_mfma_f32_16x16x32_bf16 v[148:151], a[216:219], a[156:159], v[148:151]
ds_read_b64_tr_b16 a[216:217], v237 offset:49408
ds_read_b64_tr_b16 a[218:219], v237 offset:57600
v_mfma_f32_16x16x32_bf16 v[144:147], a[220:223], a[160:163], v[144:147]
v_mfma_f32_16x16x32_bf16 v[148:151], a[220:223], a[164:167], v[148:151]
ds_read_b64_tr_b16 a[220:221], v238 offset:49408
ds_read_b64_tr_b16 a[222:223], v238 offset:57600
v_mfma_f32_16x16x32_bf16 v[144:147], a[224:227], a[168:171], v[144:147]
v_mfma_f32_16x16x32_bf16 v[148:151], a[224:227], a[172:175], v[148:151]
ds_read_b64_tr_b16 a[224:225], v239 offset:49408
ds_read_b64_tr_b16 a[226:227], v239 offset:57600
v_mfma_f32_16x16x32_bf16 v[152:155], a[228:231], a[112:115], v[184:187]
v_mfma_f32_16x16x32_bf16 v[156:159], a[228:231], a[116:119], v[188:191]
ds_read_b64_tr_b16 a[228:229], v240 offset:49408
ds_read_b64_tr_b16 a[230:231], v240 offset:57600
v_mfma_f32_16x16x32_bf16 v[152:155], a[232:235], a[120:123], v[152:155]
v_max3_f32 v192, v192, v144, v145
v_max3_f32 v193, v193, v148, v149
v_max3_f32 v192, v192, v146, v147
v_max3_f32 v193, v193, v150, v151
v_exp_f32 v144, v144
v_exp_f32 v145, v145
v_exp_f32 v146, v146
v_exp_f32 v147, v147
v_exp_f32 v148, v148
v_exp_f32 v149, v149
v_exp_f32 v150, v150
v_exp_f32 v151, v151
v_mfma_f32_16x16x32_bf16 v[156:159], a[232:235], a[124:127], v[156:159]
ds_read_b64_tr_b16 a[232:233], v241 offset:49408
ds_read_b64_tr_b16 a[234:235], v241 offset:57600
v_mfma_f32_16x16x32_bf16 v[152:155], a[236:239], a[128:131], v[152:155]
v_mfma_f32_16x16x32_bf16 v[156:159], a[236:239], a[132:135], v[156:159]
ds_read_b64_tr_b16 a[236:237], v242 offset:49408
ds_read_b64_tr_b16 a[238:239], v242 offset:57600
s_waitcnt vmcnt(15)
s_lshl_b32 s3, s54, 1
s_add_u32 s3, s3, s66
s_mov_b64 exec, 1
buffer_store_dword v194, off, s[36:39], s3 offset:128 sc1
s_mov_b64 exec, -1
v_mfma_f32_16x16x32_bf16 v[152:155], a[240:243], a[136:139], v[152:155]
v_mfma_f32_16x16x32_bf16 v[156:159], a[240:243], a[140:143], v[156:159]
ds_read_b64_tr_b16 a[240:241], v243 offset:49408
ds_read_b64_tr_b16 a[242:243], v243 offset:57600
v_mfma_f32_16x16x32_bf16 v[152:155], a[244:247], a[144:147], v[152:155]
v_mfma_f32_16x16x32_bf16 v[156:159], a[244:247], a[148:151], v[156:159]
v_mfma_f32_16x16x32_bf16 v[152:155], a[248:251], a[152:155], v[152:155]
v_mfma_f32_16x16x32_bf16 v[156:159], a[248:251], a[156:159], v[156:159]
v_mfma_f32_16x16x32_bf16 v[152:155], a[252:255], a[160:163], v[152:155]
v_mfma_f32_16x16x32_bf16 v[156:159], a[252:255], a[164:167], v[156:159]
v_mfma_f32_16x16x32_bf16 v[152:155], a[176:179], a[168:171], v[152:155]
s_waitcnt lgkmcnt(0) vmcnt(5)
s_barrier
buffer_load_dwordx4 v227, s[16:19], s74 offen offset:0 lds
ds_read_b128 a[244:247], v231 offset:32768
ds_read_b128 a[248:251], v232 offset:32768
ds_read_b128 a[252:255], v233 offset:32768
v_mfma_f32_16x16x32_bf16 v[156:159], a[176:179], a[172:175], v[156:159]
ds_read_b128 a[176:179], v234 offset:32768
v_max3_f32 v192, v192, v152, v153
v_max3_f32 v192, v192, v154, v155
v_exp_f32 v152, v152
v_exp_f32 v153, v153
v_exp_f32 v154, v154
v_exp_f32 v155, v155
v_mfma_f32_16x16x32_bf16 v[0:3], a[180:183], v[168:171], v[0:3]
v_max3_f32 v193, v193, v156, v157
v_max3_f32 v193, v193, v158, v159
v_exp_f32 v156, v156
v_exp_f32 v157, v157
v_exp_f32 v158, v158
buffer_load_dwordx4 v228, s[16:19], s74 offen offset:1024 lds
v_exp_f32 v159, v159
v_mfma_f32_16x16x32_bf16 v[4:7], a[180:183], v[172:175], v[4:7]
ds_read_b128 a[180:183], v231 offset:33024
v_mfma_f32_16x16x32_bf16 v[8:11], a[184:187], v[168:171], v[8:11]
v_mfma_f32_16x16x32_bf16 v[12:15], a[184:187], v[172:175], v[12:15]
ds_read_b128 a[184:187], v232 offset:33024
v_mfma_f32_16x16x32_bf16 v[16:19], a[188:191], v[168:171], v[16:19]
v_mfma_f32_16x16x32_bf16 v[20:23], a[188:191], v[172:175], v[20:23]
ds_read_b128 a[188:191], v233 offset:33024
v_mfma_f32_16x16x32_bf16 v[24:27], a[192:195], v[168:171], v[24:27]
v_mfma_f32_16x16x32_bf16 v[28:31], a[192:195], v[172:175], v[28:31]
buffer_load_dwordx4 v229, s[16:19], s74 offen offset:2048 lds
ds_read_b128 a[192:195], v234 offset:33024
v_mfma_f32_16x16x32_bf16 v[32:35], a[196:199], v[168:171], v[32:35]
v_mfma_f32_16x16x32_bf16 v[36:39], a[196:199], v[172:175], v[36:39]
ds_read_b128 a[196:199], v231 offset:40960
v_mfma_f32_16x16x32_bf16 v[40:43], a[200:203], v[168:171], v[40:43]
v_mfma_f32_16x16x32_bf16 v[44:47], a[200:203], v[172:175], v[44:47]
ds_read_b128 a[200:203], v232 offset:40960
v_mfma_f32_16x16x32_bf16 v[48:51], a[204:207], v[168:171], v[48:51]
v_mfma_f32_16x16x32_bf16 v[52:55], a[204:207], v[172:175], v[52:55]
ds_read_b128 a[204:207], v233 offset:40960
buffer_load_dwordx4 v230, s[16:19], s74 offen offset:3072 lds
s_add_u32 m0, s49, 94208
v_mfma_f32_16x16x32_bf16 v[56:59], a[208:211], v[168:171], v[56:59]
s_add_u32 s74, s51, s52
v_mfma_f32_16x16x32_bf16 v[60:63], a[208:211], v[172:175], v[60:63]
s_add_u32 s74, s74, 114688
ds_read_b128 a[208:211], v234 offset:40960
v_mfma_f32_16x16x32_bf16 v[64:67], a[212:215], v[168:171], v[64:67]
v_mfma_f32_16x16x32_bf16 v[68:71], a[212:215], v[172:175], v[68:71]
ds_read_b128 a[212:215], v231 offset:41216
v_mfma_f32_16x16x32_bf16 v[72:75], a[216:219], v[168:171], v[72:75]
buffer_load_dwordx4 v244, s[32:35], s75 offen offset:0 lds
v_mfma_f32_16x16x32_bf16 v[76:79], a[216:219], v[172:175], v[76:79]
ds_read_b128 a[216:219], v232 offset:41216
v_mfma_f32_16x16x32_bf16 v[80:83], a[220:223], v[168:171], v[80:83]
v_mfma_f32_16x16x32_bf16 v[84:87], a[220:223], v[172:175], v[84:87]
ds_read_b128 a[220:223], v233 offset:41216
v_mfma_f32_16x16x32_bf16 v[88:91], a[224:227], v[168:171], v[88:91]
v_mfma_f32_16x16x32_bf16 v[92:95], a[224:227], v[172:175], v[92:95]
ds_read_b128 a[224:227], v234 offset:41216
v_mfma_f32_16x16x32_bf16 v[96:99], a[228:231], v[168:171], v[96:99]
buffer_load_dwordx4 v245, s[32:35], s75 offen offset:1024 lds
v_mfma_f32_16x16x32_bf16 v[100:103], a[228:231], v[172:175], v[100:103]
ds_read_b64_tr_b16 a[228:229], v236 offset:0
ds_read_b64_tr_b16 a[230:231], v236 offset:8192
v_mfma_f32_16x16x32_bf16 v[104:107], a[232:235], v[168:171], v[104:107]
v_mfma_f32_16x16x32_bf16 v[108:111], a[232:235], v[172:175], v[108:111]
ds_read_b64_tr_b16 a[232:233], v237 offset:0
ds_read_b64_tr_b16 a[234:235], v237 offset:8192
v_mfma_f32_16x16x32_bf16 v[112:115], a[236:239], v[168:171], v[112:115]
v_mfma_f32_16x16x32_bf16 v[116:119], a[236:239], v[172:175], v[116:119]
buffer_load_dwordx4 v246, s[32:35], s75 offen offset:2048 lds
ds_read_b64_tr_b16 a[236:237], v238 offset:0
ds_read_b64_tr_b16 a[238:239], v238 offset:8192
v_mfma_f32_16x16x32_bf16 v[120:123], a[240:243], v[168:171], v[120:123]
v_mfma_f32_16x16x32_bf16 v[124:127], a[240:243], v[172:175], v[124:127]
ds_read_b64_tr_b16 a[240:241], v239 offset:0
ds_read_b64_tr_b16 a[242:243], v239 offset:8192
v_mfma_f32_16x16x32_bf16 v[176:179], v[196:199], v[168:171], v[176:179]
v_cvt_pk_bf16_f32 v168, v144, v145
v_cvt_pk_bf16_f32 v169, v146, v147
v_cvt_pk_bf16_f32 v170, v152, v153
v_cvt_pk_bf16_f32 v171, v154, v155
v_mfma_f32_16x16x32_bf16 v[180:183], v[196:199], v[172:175], v[180:183]
v_cvt_pk_bf16_f32 v172, v148, v149
buffer_load_dwordx4 v247, s[32:35], s75 offen offset:3072 lds
s_add_u32 m0, s49, 98304
v_cvt_pk_bf16_f32 v173, v150, v151
v_cvt_pk_bf16_f32 v174, v156, v157
v_cvt_pk_bf16_f32 v175, v158, v159
s_waitcnt lgkmcnt(4)
v_mfma_f32_16x16x32_bf16 v[128:131], a[244:247], a[112:115], v[184:187]
s_add_u32 s75, s51, s52
v_mfma_f32_16x16x32_bf16 v[132:135], a[244:247], a[116:119], v[188:191]
s_add_u32 s75, s75, 229376
ds_read_b64_tr_b16 a[244:245], v240 offset:0
ds_read_b64_tr_b16 a[246:247], v240 offset:8192
v_mfma_f32_16x16x32_bf16 v[128:131], a[248:251], a[120:123], v[128:131]
v_mfma_f32_16x16x32_bf16 v[132:135], a[248:251], a[124:127], v[132:135]
buffer_load_dwordx4 v244, s[32:35], s76 offen offset:0 lds
ds_read_b64_tr_b16 a[248:249], v241 offset:0
ds_read_b64_tr_b16 a[250:251], v241 offset:8192
v_mfma_f32_16x16x32_bf16 v[128:131], a[252:255], a[128:131], v[128:131]
v_mfma_f32_16x16x32_bf16 v[132:135], a[252:255], a[132:135], v[132:135]
ds_read_b64_tr_b16 a[252:253], v242 offset:0
ds_read_b64_tr_b16 a[254:255], v242 offset:8192
v_mfma_f32_16x16x32_bf16 v[128:131], a[176:179], a[136:139], v[128:131]
v_mfma_f32_16x16x32_bf16 v[132:135], a[176:179], a[140:143], v[132:135]
ds_read_b64_tr_b16 a[176:177], v243 offset:0
buffer_load_dwordx4 v245, s[32:35], s76 offen offset:1024 lds
ds_read_b64_tr_b16 a[178:179], v243 offset:8192
v_mfma_f32_16x16x32_bf16 v[128:131], a[180:183], a[144:147], v[128:131]
v_mfma_f32_16x16x32_bf16 v[132:135], a[180:183], a[148:151], v[132:135]
ds_read_b64_tr_b16 a[180:181], v236 offset:256
ds_read_b64_tr_b16 a[182:183], v236 offset:8448
v_mfma_f32_16x16x32_bf16 v[128:131], a[184:187], a[152:155], v[128:131]
v_mfma_f32_16x16x32_bf16 v[132:135], a[184:187], a[156:159], v[132:135]
ds_read_b64_tr_b16 a[184:185], v237 offset:256
ds_read_b64_tr_b16 a[186:187], v237 offset:8448
v_mfma_f32_16x16x32_bf16 v[128:131], a[188:191], a[160:163], v[128:131]
buffer_load_dwordx4 v246, s[32:35], s76 offen offset:2048 lds
s_add_u32 m0, s49, 65536
v_mfma_f32_16x16x32_bf16 v[132:135], a[188:191], a[164:167], v[132:135]
s_add_u32 s76, s51, s52
ds_read_b64_tr_b16 a[188:189], v238 offset:256
ds_read_b64_tr_b16 a[190:191], v238 offset:8448
v_mfma_f32_16x16x32_bf16 v[128:131], a[192:195], a[168:171], v[128:131]
s_add_u32 s76, s76, 344064
v_mfma_f32_16x16x32_bf16 v[132:135], a[192:195], a[172:175], v[132:135]
ds_read_b64_tr_b16 a[192:193], v239 offset:256
ds_read_b64_tr_b16 a[194:195], v239 offset:8448
v_mfma_f32_16x16x32_bf16 v[136:139], a[196:199], a[112:115], v[184:187]
v_mfma_f32_16x16x32_bf16 v[140:143], a[196:199], a[116:119], v[188:191]
ds_read_b64_tr_b16 a[196:197], v240 offset:256
ds_read_b64_tr_b16 a[198:199], v240 offset:8448
v_max3_f32 v192, v192, v128, v129
v_max3_f32 v192, v192, v130, v131
v_max3_f32 v193, v193, v132, v133
v_max3_f32 v193, v193, v134, v135
v_exp_f32 v128, v128
v_exp_f32 v129, v129
v_exp_f32 v130, v130
v_exp_f32 v131, v131
v_exp_f32 v132, v132
v_exp_f32 v133, v133
v_exp_f32 v134, v134
v_exp_f32 v135, v135
v_mfma_f32_16x16x32_bf16 v[136:139], a[200:203], a[120:123], v[136:139]
v_mfma_f32_16x16x32_bf16 v[140:143], a[200:203], a[124:127], v[140:143]
ds_read_b64_tr_b16 a[200:201], v241 offset:256
ds_read_b64_tr_b16 a[202:203], v241 offset:8448
v_mfma_f32_16x16x32_bf16 v[136:139], a[204:207], a[128:131], v[136:139]
v_mfma_f32_16x16x32_bf16 v[140:143], a[204:207], a[132:135], v[140:143]
ds_read_b64_tr_b16 a[204:205], v242 offset:256
ds_read_b64_tr_b16 a[206:207], v242 offset:8448
v_mfma_f32_16x16x32_bf16 v[136:139], a[208:211], a[136:139], v[136:139]
v_mfma_f32_16x16x32_bf16 v[140:143], a[208:211], a[140:143], v[140:143]
ds_read_b64_tr_b16 a[208:209], v243 offset:256
ds_read_b64_tr_b16 a[210:211], v243 offset:8448
v_mfma_f32_16x16x32_bf16 v[136:139], a[212:215], a[144:147], v[136:139]
v_mfma_f32_16x16x32_bf16 v[140:143], a[212:215], a[148:151], v[140:143]
ds_read_b64_tr_b16 a[212:213], v249 offset:0
ds_read_b64_tr_b16 a[214:215], v249 offset:2048
v_mfma_f32_16x16x32_bf16 v[136:139], a[216:219], a[152:155], v[136:139]
v_mfma_f32_16x16x32_bf16 v[140:143], a[216:219], a[156:159], v[140:143]
ds_read_b64_tr_b16 a[216:217], v249 offset:4096
ds_read_b64_tr_b16 a[218:219], v249 offset:6144
v_mfma_f32_16x16x32_bf16 v[136:139], a[220:223], a[160:163], v[136:139]
v_mfma_f32_16x16x32_bf16 v[140:143], a[220:223], a[164:167], v[140:143]
ds_read_b64_tr_b16 a[220:221], v249 offset:8192
ds_read_b64_tr_b16 a[222:223], v249 offset:10240
v_mfma_f32_16x16x32_bf16 v[136:139], a[224:227], a[168:171], v[136:139]
v_mfma_f32_16x16x32_bf16 v[140:143], a[224:227], a[172:175], v[140:143]
ds_read_b64_tr_b16 a[224:225], v249 offset:12288
ds_read_b64_tr_b16 a[226:227], v249 offset:14336
v_mfma_f32_16x16x32_bf16 v[0:3], a[228:231], v[160:163], v[0:3]
v_mfma_f32_16x16x32_bf16 v[4:7], a[228:231], v[164:167], v[4:7]
ds_read_b64_tr_b16 a[228:229], v249 offset:16384
ds_read_b64_tr_b16 a[230:231], v249 offset:18432
v_mfma_f32_16x16x32_bf16 v[8:11], a[232:235], v[160:163], v[8:11]
v_max3_f32 v192, v192, v136, v137
v_max3_f32 v193, v193, v140, v141
v_max3_f32 v192, v192, v138, v139
v_max3_f32 v193, v193, v142, v143
v_exp_f32 v136, v136
v_exp_f32 v137, v137
v_exp_f32 v138, v138
v_exp_f32 v139, v139
v_exp_f32 v140, v140
v_exp_f32 v141, v141
v_exp_f32 v142, v142
v_exp_f32 v143, v143
v_mfma_f32_16x16x32_bf16 v[12:15], a[232:235], v[164:167], v[12:15]
ds_read_b64_tr_b16 a[232:233], v249 offset:20480
ds_read_b64_tr_b16 a[234:235], v249 offset:22528
s_waitcnt lgkmcnt(3)
v_mfma_f32_16x16x32_bf16 v[16:19], a[236:239], v[160:163], v[16:19]
v_mfma_f32_16x16x32_bf16 v[20:23], a[236:239], v[164:167], v[20:23]
ds_read_b64_tr_b16 a[236:237], v249 offset:24576
ds_read_b64_tr_b16 a[238:239], v249 offset:26624
v_mfma_f32_16x16x32_bf16 v[24:27], a[240:243], v[160:163], v[24:27]
v_mfma_f32_16x16x32_bf16 v[28:31], a[240:243], v[164:167], v[28:31]
v_mfma_f32_16x16x32_bf16 v[32:35], a[244:247], v[160:163], v[32:35]
v_mfma_f32_16x16x32_bf16 v[36:39], a[244:247], v[164:167], v[36:39]
v_mfma_f32_16x16x32_bf16 v[40:43], a[248:251], v[160:163], v[40:43]
v_mfma_f32_16x16x32_bf16 v[44:47], a[248:251], v[164:167], v[44:47]
v_mfma_f32_16x16x32_bf16 v[48:51], a[252:255], v[160:163], v[48:51]
s_waitcnt lgkmcnt(0)
s_barrier
buffer_load_dwordx4 v244, s[32:35], s77 offen offset:0 lds
ds_read_b128 a[240:243], v231 offset:49152
ds_read_b128 a[244:247], v232 offset:49152
ds_read_b128 a[248:251], v233 offset:49152
v_mfma_f32_16x16x32_bf16 v[52:55], a[252:255], v[164:167], v[52:55]
ds_read_b128 a[252:255], v234 offset:49152
v_mfma_f32_16x16x32_bf16 v[56:59], a[176:179], v[160:163], v[56:59]
v_mfma_f32_16x16x32_bf16 v[60:63], a[176:179], v[164:167], v[60:63]
ds_read_b128 a[176:179], v231 offset:49408
v_mfma_f32_16x16x32_bf16 v[64:67], a[180:183], v[160:163], v[64:67]
buffer_load_dwordx4 v245, s[32:35], s77 offen offset:1024 lds
v_mfma_f32_16x16x32_bf16 v[68:71], a[180:183], v[164:167], v[68:71]
ds_read_b128 a[180:183], v232 offset:49408
v_mfma_f32_16x16x32_bf16 v[72:75], a[184:187], v[160:163], v[72:75]
v_mfma_f32_16x16x32_bf16 v[76:79], a[184:187], v[164:167], v[76:79]
ds_read_b128 a[184:187], v233 offset:49408
v_mfma_f32_16x16x32_bf16 v[80:83], a[188:191], v[160:163], v[80:83]
v_mfma_f32_16x16x32_bf16 v[84:87], a[188:191], v[164:167], v[84:87]
ds_read_b128 a[188:191], v234 offset:49408
v_mfma_f32_16x16x32_bf16 v[88:91], a[192:195], v[160:163], v[88:91]
buffer_load_dwordx4 v246, s[32:35], s77 offen offset:2048 lds
v_mfma_f32_16x16x32_bf16 v[92:95], a[192:195], v[164:167], v[92:95]
ds_read_b128 a[192:195], v231 offset:57344
v_mfma_f32_16x16x32_bf16 v[96:99], a[196:199], v[160:163], v[96:99]
v_mfma_f32_16x16x32_bf16 v[100:103], a[196:199], v[164:167], v[100:103]
ds_read_b128 a[196:199], v232 offset:57344
v_mfma_f32_16x16x32_bf16 v[104:107], a[200:203], v[160:163], v[104:107]
v_mfma_f32_16x16x32_bf16 v[108:111], a[200:203], v[164:167], v[108:111]
ds_read_b128 a[200:203], v233 offset:57344
buffer_load_dwordx4 v247, s[32:35], s77 offen offset:3072 lds
s_add_u32 m0, s49, 69632
v_mfma_f32_16x16x32_bf16 v[112:115], a[204:207], v[160:163], v[112:115]
s_add_u32 s77, s51, s53
v_mfma_f32_16x16x32_bf16 v[116:119], a[204:207], v[164:167], v[116:119]
ds_read_b128 a[204:207], v234 offset:57344
v_mfma_f32_16x16x32_bf16 v[120:123], a[208:211], v[160:163], v[120:123]
v_mfma_f32_16x16x32_bf16 v[124:127], a[208:211], v[164:167], v[124:127]
ds_read_b128 a[208:211], v231 offset:57600
v_mfma_f32_16x16x32_bf16 v[176:179], v[196:199], v[160:163], v[176:179]
v_cvt_pk_bf16_f32 v160, v128, v129
v_cvt_pk_bf16_f32 v161, v130, v131
buffer_load_dwordx4 v244, s[32:35], s70 offen offset:0 lds
v_cvt_pk_bf16_f32 v162, v136, v137
v_cvt_pk_bf16_f32 v163, v138, v139
v_mfma_f32_16x16x32_bf16 v[180:183], v[196:199], v[164:167], v[180:183]
v_cvt_pk_bf16_f32 v164, v132, v133
v_cvt_pk_bf16_f32 v165, v134, v135
v_cvt_pk_bf16_f32 v166, v140, v141
v_cvt_pk_bf16_f32 v167, v142, v143
v_mfma_f32_16x16x32_bf16 v[206:209], a[212:215], a[0:3], 0
v_mfma_f32_16x16x32_bf16 v[210:213], a[212:215], a[4:7], 0
v_mfma_f32_16x16x32_bf16 v[214:217], a[212:215], a[8:11], 0
v_mfma_f32_16x16x32_bf16 v[218:221], a[212:215], a[12:15], 0
buffer_load_dwordx4 v245, s[32:35], s70 offen offset:1024 lds
ds_read_b128 a[212:215], v232 offset:57600
v_mfma_f32_16x16x32_bf16 v[206:209], a[216:219], a[16:19], v[206:209]
v_mfma_f32_16x16x32_bf16 v[210:213], a[216:219], a[20:23], v[210:213]
v_mfma_f32_16x16x32_bf16 v[214:217], a[216:219], a[24:27], v[214:217]
v_mfma_f32_16x16x32_bf16 v[218:221], a[216:219], a[28:31], v[218:221]
ds_read_b128 a[216:219], v233 offset:57600
v_mfma_f32_16x16x32_bf16 v[206:209], a[220:223], a[32:35], v[206:209]
buffer_load_dwordx4 v246, s[32:35], s70 offen offset:2048 lds
s_add_u32 m0, s49, 135168
v_mfma_f32_16x16x32_bf16 v[210:213], a[220:223], a[36:39], v[210:213]
s_add_u32 s70, s51, s53
v_mfma_f32_16x16x32_bf16 v[214:217], a[220:223], a[40:43], v[214:217]
s_add_u32 s70, s70, 114688
v_mfma_f32_16x16x32_bf16 v[218:221], a[220:223], a[44:47], v[218:221]
ds_read_b128 a[220:223], v234 offset:57600
v_mfma_f32_16x16x32_bf16 v[206:209], a[224:227], a[48:51], v[206:209]
v_mfma_f32_16x16x32_bf16 v[210:213], a[224:227], a[52:55], v[210:213]
v_mfma_f32_16x16x32_bf16 v[214:217], a[224:227], a[56:59], v[214:217]
v_mfma_f32_16x16x32_bf16 v[218:221], a[224:227], a[60:63], v[218:221]
ds_read_b64_tr_b16 a[224:225], v236 offset:16384
ds_read_b64_tr_b16 a[226:227], v236 offset:24576
v_mfma_f32_16x16x32_bf16 v[206:209], a[228:231], a[64:67], v[206:209]
v_mfma_f32_16x16x32_bf16 v[210:213], a[228:231], a[68:71], v[210:213]
v_mfma_f32_16x16x32_bf16 v[214:217], a[228:231], a[72:75], v[214:217]
v_mfma_f32_16x16x32_bf16 v[218:221], a[228:231], a[76:79], v[218:221]
ds_read_b64_tr_b16 a[228:229], v237 offset:16384
ds_read_b64_tr_b16 a[230:231], v237 offset:24576
v_mfma_f32_16x16x32_bf16 v[206:209], a[232:235], a[80:83], v[206:209]
v_mfma_f32_16x16x32_bf16 v[210:213], a[232:235], a[84:87], v[210:213]
v_mfma_f32_16x16x32_bf16 v[214:217], a[232:235], a[88:91], v[214:217]
v_mfma_f32_16x16x32_bf16 v[218:221], a[232:235], a[92:95], v[218:221]
ds_read_b64_tr_b16 a[232:233], v238 offset:16384
ds_read_b64_tr_b16 a[234:235], v238 offset:24576
v_mfma_f32_16x16x32_bf16 v[206:209], a[236:239], a[96:99], v[206:209]
v_mfma_f32_16x16x32_bf16 v[210:213], a[236:239], a[100:103], v[210:213]
v_mfma_f32_16x16x32_bf16 v[214:217], a[236:239], a[104:107], v[214:217]
v_mfma_f32_16x16x32_bf16 v[218:221], a[236:239], a[108:111], v[218:221]
ds_read_b64_tr_b16 a[236:237], v239 offset:16384
ds_read_b64_tr_b16 a[238:239], v239 offset:24576
s_waitcnt lgkmcnt(4)
v_mfma_f32_16x16x32_bf16 v[144:147], a[240:243], a[112:115], v[184:187]
v_mfma_f32_16x16x32_bf16 v[148:151], a[240:243], a[116:119], v[188:191]
v_cvt_pk_bf16_f32 v206, v206, v207
v_cvt_pk_bf16_f32 v207, v208, v209
v_cvt_pk_bf16_f32 v208, v210, v211
v_cvt_pk_bf16_f32 v209, v212, v213
v_cvt_pk_bf16_f32 v210, v214, v215
v_cvt_pk_bf16_f32 v211, v216, v217
v_cvt_pk_bf16_f32 v212, v218, v219
v_cvt_pk_bf16_f32 v213, v220, v221
buffer_store_dwordx4 v[206:209], v253, s[36:39], s100 offen offset:0 sc1
ds_read_b64_tr_b16 a[240:241], v240 offset:16384
ds_read_b64_tr_b16 a[242:243], v240 offset:24576
v_mfma_f32_16x16x32_bf16 v[144:147], a[244:247], a[120:123], v[144:147]
buffer_store_dwordx4 v[210:213], v253, s[36:39], s100 offen offset:1024 sc1
v_mfma_f32_16x16x32_bf16 v[148:151], a[244:247], a[124:127], v[148:151]
ds_read_b64_tr_b16 a[244:245], v241 offset:16384
ds_read_b64_tr_b16 a[246:247], v241 offset:24576
v_mfma_f32_16x16x32_bf16 v[144:147], a[248:251], a[128:131], v[144:147]
v_mfma_f32_16x16x32_bf16 v[148:151], a[248:251], a[132:135], v[148:151]
ds_read_b64_tr_b16 a[248:249], v242 offset:16384
ds_read_b64_tr_b16 a[250:251], v242 offset:24576
v_mfma_f32_16x16x32_bf16 v[144:147], a[252:255], a[136:139], v[144:147]
v_mfma_f32_16x16x32_bf16 v[148:151], a[252:255], a[140:143], v[148:151]
ds_read_b64_tr_b16 a[252:253], v243 offset:16384
ds_read_b64_tr_b16 a[254:255], v243 offset:24576
v_mfma_f32_16x16x32_bf16 v[144:147], a[176:179], a[144:147], v[144:147]
v_mfma_f32_16x16x32_bf16 v[148:151], a[176:179], a[148:151], v[148:151]
ds_read_b64_tr_b16 a[176:177], v236 offset:16640
ds_read_b64_tr_b16 a[178:179], v236 offset:24832
v_mfma_f32_16x16x32_bf16 v[144:147], a[180:183], a[152:155], v[144:147]
v_mfma_f32_16x16x32_bf16 v[148:151], a[180:183], a[156:159], v[148:151]
ds_read_b64_tr_b16 a[180:181], v237 offset:16640
ds_read_b64_tr_b16 a[182:183], v237 offset:24832
v_mfma_f32_16x16x32_bf16 v[144:147], a[184:187], a[160:163], v[144:147]
v_mfma_f32_16x16x32_bf16 v[148:151], a[184:187], a[164:167], v[148:151]
ds_read_b64_tr_b16 a[184:185], v238 offset:16640
ds_read_b64_tr_b16 a[186:187], v238 offset:24832
v_mfma_f32_16x16x32_bf16 v[144:147], a[188:191], a[168:171], v[144:147]
v_mfma_f32_16x16x32_bf16 v[148:151], a[188:191], a[172:175], v[148:151]
ds_read_b64_tr_b16 a[188:189], v239 offset:16640
ds_read_b64_tr_b16 a[190:191], v239 offset:24832
v_mfma_f32_16x16x32_bf16 v[152:155], a[192:195], a[112:115], v[184:187]
v_mfma_f32_16x16x32_bf16 v[156:159], a[192:195], a[116:119], v[188:191]
ds_read_b64_tr_b16 a[192:193], v240 offset:16640
ds_read_b64_tr_b16 a[194:195], v240 offset:24832
v_mfma_f32_16x16x32_bf16 v[152:155], a[196:199], a[120:123], v[152:155]
v_max3_f32 v192, v192, v144, v145
v_max3_f32 v193, v193, v148, v149
v_max3_f32 v192, v192, v146, v147
v_max3_f32 v193, v193, v150, v151
v_exp_f32 v144, v144
v_exp_f32 v145, v145
v_exp_f32 v146, v146
v_exp_f32 v147, v147
v_exp_f32 v148, v148
v_exp_f32 v149, v149
v_exp_f32 v150, v150
v_exp_f32 v151, v151
v_mfma_f32_16x16x32_bf16 v[156:159], a[196:199], a[124:127], v[156:159]
ds_read_b64_tr_b16 a[196:197], v241 offset:16640
ds_read_b64_tr_b16 a[198:199], v241 offset:24832
v_mfma_f32_16x16x32_bf16 v[152:155], a[200:203], a[128:131], v[152:155]
v_mfma_f32_16x16x32_bf16 v[156:159], a[200:203], a[132:135], v[156:159]
ds_read_b64_tr_b16 a[200:201], v242 offset:16640
ds_read_b64_tr_b16 a[202:203], v242 offset:24832
v_mfma_f32_16x16x32_bf16 v[152:155], a[204:207], a[136:139], v[152:155]
v_mfma_f32_16x16x32_bf16 v[156:159], a[204:207], a[140:143], v[156:159]
ds_read_b64_tr_b16 a[204:205], v243 offset:16640
ds_read_b64_tr_b16 a[206:207], v243 offset:24832
v_mfma_f32_16x16x32_bf16 v[152:155], a[208:211], a[144:147], v[152:155]
v_mfma_f32_16x16x32_bf16 v[156:159], a[208:211], a[148:151], v[156:159]
v_mfma_f32_16x16x32_bf16 v[152:155], a[212:215], a[152:155], v[152:155]
v_mfma_f32_16x16x32_bf16 v[156:159], a[212:215], a[156:159], v[156:159]
v_mfma_f32_16x16x32_bf16 v[152:155], a[216:219], a[160:163], v[152:155]
v_mfma_f32_16x16x32_bf16 v[156:159], a[216:219], a[164:167], v[156:159]
v_mfma_f32_16x16x32_bf16 v[152:155], a[220:223], a[168:171], v[152:155]
v_mfma_f32_16x16x32_bf16 v[156:159], a[220:223], a[172:175], v[156:159]
v_mfma_f32_16x16x32_bf16 v[0:3], a[224:227], v[168:171], v[0:3]
v_mfma_f32_16x16x32_bf16 v[4:7], a[224:227], v[172:175], v[4:7]
v_mfma_f32_16x16x32_bf16 v[8:11], a[228:231], v[168:171], v[8:11]
v_mfma_f32_16x16x32_bf16 v[12:15], a[228:231], v[172:175], v[12:15]
s_waitcnt lgkmcnt(0)
v_mfma_f32_16x16x32_bf16 v[16:19], a[232:235], v[168:171], v[16:19]
v_mfma_f32_16x16x32_bf16 v[20:23], a[232:235], v[172:175], v[20:23]
v_max3_f32 v192, v192, v152, v153
v_max3_f32 v193, v193, v156, v157
v_max3_f32 v192, v192, v154, v155
v_max3_f32 v193, v193, v158, v159
v_max_f32 v202, v192, v193
v_cmp_nle_f32 vcc, v202, v222
s_nop 4
s_cmp_lg_u64 vcc, 0
s_cselect_b32 s3, 1, 0
v_mov_b32 v202, s3
ds_write_b32 v195, v202
v_exp_f32 v152, v152
v_mov_b32 v195, 126976
v_exp_f32 v153, v153
v_exp_f32 v154, v154
v_exp_f32 v155, v155
v_exp_f32 v156, v156
v_exp_f32 v157, v157
s_waitcnt lgkmcnt(0) vmcnt(21)
s_barrier
buffer_load_dwordx4 v244, s[32:35], s71 offen offset:0 lds
ds_read_b128 v[200:203], v195
ds_read_b64_tr_b16 a[208:209], v236 offset:32768
ds_read_b64_tr_b16 a[210:211], v236 offset:40960
ds_read_b64_tr_b16 a[212:213], v237 offset:32768
ds_read_b64_tr_b16 a[214:215], v237 offset:40960
ds_read_b64_tr_b16 a[216:217], v238 offset:32768
ds_read_b64_tr_b16 a[218:219], v238 offset:40960
ds_read_b64_tr_b16 a[220:221], v239 offset:32768
ds_read_b64_tr_b16 a[222:223], v239 offset:40960
ds_read_b64_tr_b16 a[224:225], v240 offset:32768
ds_read_b64_tr_b16 a[226:227], v240 offset:40960
buffer_load_dwordx4 v245, s[32:35], s71 offen offset:1024 lds
ds_read_b64_tr_b16 a[228:229], v241 offset:32768
ds_read_b64_tr_b16 a[230:231], v241 offset:40960
ds_read_b64_tr_b16 a[232:233], v242 offset:32768
ds_read_b64_tr_b16 a[234:235], v242 offset:40960
v_exp_f32 v158, v158
v_exp_f32 v159, v159
s_waitcnt lgkmcnt(13)
v_or_b32 v200, v200, v201
v_or_b32 v202, v202, v203
v_or_b32 v200, v200, v202
s_nop 0
v_readfirstlane_b32 s91, v200
v_mfma_f32_16x16x32_bf16 v[24:27], a[236:239], v[168:171], v[24:27]
v_mov_b32 v200, 1
v_mfma_f32_16x16x32_bf16 v[28:31], a[236:239], v[172:175], v[28:31]
buffer_load_dwordx4 v246, s[32:35], s71 offen offset:2048 lds
ds_read_b64_tr_b16 a[236:237], v243 offset:32768
ds_read_b64_tr_b16 a[238:239], v243 offset:40960
v_mfma_f32_16x16x32_bf16 v[32:35], a[240:243], v[168:171], v[32:35]
v_mfma_f32_16x16x32_bf16 v[36:39], a[240:243], v[172:175], v[36:39]
ds_read_b64_tr_b16 a[240:241], v236 offset:33024
ds_read_b64_tr_b16 a[242:243], v236 offset:41216
v_mfma_f32_16x16x32_bf16 v[40:43], a[244:247], v[168:171], v[40:43]
v_mfma_f32_16x16x32_bf16 v[44:47], a[244:247], v[172:175], v[44:47]
ds_read_b64_tr_b16 a[244:245], v237 offset:33024
buffer_load_dwordx4 v247, s[32:35], s71 offen offset:3072 lds
s_add_u32 m0, s49, 139264
ds_read_b64_tr_b16 a[246:247], v237 offset:41216
v_mfma_f32_16x16x32_bf16 v[48:51], a[248:251], v[168:171], v[48:51]
s_add_u32 s71, s51, s53
v_mfma_f32_16x16x32_bf16 v[52:55], a[248:251], v[172:175], v[52:55]
s_add_u32 s71, s71, 229376
ds_read_b64_tr_b16 a[248:249], v238 offset:33024
ds_read_b64_tr_b16 a[250:251], v238 offset:41216
v_mfma_f32_16x16x32_bf16 v[56:59], a[252:255], v[168:171], v[56:59]
v_mfma_f32_16x16x32_bf16 v[60:63], a[252:255], v[172:175], v[60:63]
ds_read_b64_tr_b16 a[252:253], v239 offset:33024
ds_read_b64_tr_b16 a[254:255], v239 offset:41216
buffer_load_dwordx4 v244, s[32:35], s72 offen offset:0 lds
v_mfma_f32_16x16x32_bf16 v[64:67], a[176:179], v[168:171], v[64:67]
v_mfma_f32_16x16x32_bf16 v[68:71], a[176:179], v[172:175], v[68:71]
ds_read_b64_tr_b16 a[176:177], v240 offset:33024
ds_read_b64_tr_b16 a[178:179], v240 offset:41216
v_mfma_f32_16x16x32_bf16 v[72:75], a[180:183], v[168:171], v[72:75]
v_mfma_f32_16x16x32_bf16 v[76:79], a[180:183], v[172:175], v[76:79]
ds_read_b64_tr_b16 a[180:181], v241 offset:33024
ds_read_b64_tr_b16 a[182:183], v241 offset:41216
v_mfma_f32_16x16x32_bf16 v[80:83], a[184:187], v[168:171], v[80:83]
buffer_load_dwordx4 v245, s[32:35], s72 offen offset:1024 lds
v_mfma_f32_16x16x32_bf16 v[84:87], a[184:187], v[172:175], v[84:87]
ds_read_b64_tr_b16 a[184:185], v242 offset:33024
ds_read_b64_tr_b16 a[186:187], v242 offset:41216
v_mfma_f32_16x16x32_bf16 v[88:91], a[188:191], v[168:171], v[88:91]
v_mfma_f32_16x16x32_bf16 v[92:95], a[188:191], v[172:175], v[92:95]
ds_read_b64_tr_b16 a[188:189], v243 offset:33024
ds_read_b64_tr_b16 a[190:191], v243 offset:41216
v_mfma_f32_16x16x32_bf16 v[96:99], a[192:195], v[168:171], v[96:99]
v_mfma_f32_16x16x32_bf16 v[100:103], a[192:195], v[172:175], v[100:103]
buffer_load_dwordx4 v246, s[32:35], s72 offen offset:2048 lds
v_mfma_f32_16x16x32_bf16 v[104:107], a[196:199], v[168:171], v[104:107]
s_add_u32 s72, s51, s53
v_mfma_f32_16x16x32_bf16 v[108:111], a[196:199], v[172:175], v[108:111]
s_add_u32 s72, s72, 344064
v_mfma_f32_16x16x32_bf16 v[112:115], a[200:203], v[168:171], v[112:115]
v_mfma_f32_16x16x32_bf16 v[116:119], a[200:203], v[172:175], v[116:119]
v_mfma_f32_16x16x32_bf16 v[120:123], a[204:207], v[168:171], v[120:123]
s_waitcnt lgkmcnt(0) vmcnt(23)
s_barrier
v_mfma_f32_16x16x32_bf16 v[124:127], a[204:207], v[172:175], v[124:127]
ds_read_b64_tr_b16 a[192:193], v236 offset:49152
v_mfma_f32_16x16x32_bf16 v[176:179], v[196:199], v[168:171], v[176:179]
v_cvt_pk_bf16_f32 v168, v144, v145
v_cvt_pk_bf16_f32 v169, v146, v147
v_cvt_pk_bf16_f32 v170, v152, v153
v_cvt_pk_bf16_f32 v171, v154, v155
v_mfma_f32_16x16x32_bf16 v[180:183], v[196:199], v[172:175], v[180:183]
v_cvt_pk_bf16_f32 v172, v148, v149
v_cvt_pk_bf16_f32 v173, v150, v151
v_cvt_pk_bf16_f32 v174, v156, v157
v_cvt_pk_bf16_f32 v175, v158, v159
v_mfma_f32_16x16x32_bf16 v[0:3], a[208:211], v[160:163], v[0:3]
ds_read_b64_tr_b16 a[194:195], v236 offset:57344
v_mfma_f32_16x16x32_bf16 v[4:7], a[208:211], v[164:167], v[4:7]
ds_read_b64_tr_b16 a[196:197], v237 offset:49152
v_mfma_f32_16x16x32_bf16 v[8:11], a[212:215], v[160:163], v[8:11]
ds_read_b64_tr_b16 a[198:199], v237 offset:57344
v_mfma_f32_16x16x32_bf16 v[12:15], a[212:215], v[164:167], v[12:15]
ds_read_b64_tr_b16 a[200:201], v238 offset:49152
v_mfma_f32_16x16x32_bf16 v[16:19], a[216:219], v[160:163], v[16:19]
ds_read_b64_tr_b16 a[202:203], v238 offset:57344
v_mfma_f32_16x16x32_bf16 v[20:23], a[216:219], v[164:167], v[20:23]
ds_read_b64_tr_b16 a[204:205], v239 offset:49152
v_mfma_f32_16x16x32_bf16 v[24:27], a[220:223], v[160:163], v[24:27]
ds_read_b64_tr_b16 a[206:207], v239 offset:57344
v_mfma_f32_16x16x32_bf16 v[28:31], a[220:223], v[164:167], v[28:31]
ds_read_b64_tr_b16 a[208:209], v240 offset:49152
v_mfma_f32_16x16x32_bf16 v[32:35], a[224:227], v[160:163], v[32:35]
ds_read_b64_tr_b16 a[210:211], v240 offset:57344
v_mfma_f32_16x16x32_bf16 v[36:39], a[224:227], v[164:167], v[36:39]
ds_read_b64_tr_b16 a[212:213], v241 offset:49152
v_mfma_f32_16x16x32_bf16 v[40:43], a[228:231], v[160:163], v[40:43]
ds_read_b64_tr_b16 a[214:215], v241 offset:57344
v_mfma_f32_16x16x32_bf16 v[44:47], a[228:231], v[164:167], v[44:47]
ds_read_b64_tr_b16 a[216:217], v242 offset:49152
v_mfma_f32_16x16x32_bf16 v[48:51], a[232:235], v[160:163], v[48:51]
ds_read_b64_tr_b16 a[218:219], v242 offset:57344
v_mfma_f32_16x16x32_bf16 v[52:55], a[232:235], v[164:167], v[52:55]
ds_read_b64_tr_b16 a[220:221], v243 offset:49152
v_mfma_f32_16x16x32_bf16 v[56:59], a[236:239], v[160:163], v[56:59]
ds_read_b64_tr_b16 a[222:223], v243 offset:57344
v_mfma_f32_16x16x32_bf16 v[60:63], a[236:239], v[164:167], v[60:63]
ds_read_b64_tr_b16 a[224:225], v236 offset:49408
v_mfma_f32_16x16x32_bf16 v[64:67], a[240:243], v[160:163], v[64:67]
ds_read_b64_tr_b16 a[226:227], v236 offset:57600
v_mfma_f32_16x16x32_bf16 v[68:71], a[240:243], v[164:167], v[68:71]
ds_read_b64_tr_b16 a[228:229], v237 offset:49408
v_mfma_f32_16x16x32_bf16 v[72:75], a[244:247], v[160:163], v[72:75]
ds_read_b64_tr_b16 a[230:231], v237 offset:57600
v_mfma_f32_16x16x32_bf16 v[76:79], a[244:247], v[164:167], v[76:79]
ds_read_b64_tr_b16 a[232:233], v238 offset:49408
v_mfma_f32_16x16x32_bf16 v[80:83], a[248:251], v[160:163], v[80:83]
ds_read_b64_tr_b16 a[234:235], v238 offset:57600
v_mfma_f32_16x16x32_bf16 v[84:87], a[248:251], v[164:167], v[84:87]
ds_read_b64_tr_b16 a[236:237], v239 offset:49408
v_mfma_f32_16x16x32_bf16 v[88:91], a[252:255], v[160:163], v[88:91]
ds_read_b64_tr_b16 a[238:239], v239 offset:57600
v_mfma_f32_16x16x32_bf16 v[92:95], a[252:255], v[164:167], v[92:95]
ds_read_b64_tr_b16 a[240:241], v240 offset:49408
v_mfma_f32_16x16x32_bf16 v[96:99], a[176:179], v[160:163], v[96:99]
ds_read_b64_tr_b16 a[242:243], v240 offset:57600
v_mfma_f32_16x16x32_bf16 v[100:103], a[176:179], v[164:167], v[100:103]
ds_read_b64_tr_b16 a[244:245], v241 offset:49408
s_waitcnt vmcnt(7)
s_lshl_b32 s3, s55, 1
s_add_u32 s3, s3, s66
s_mov_b64 exec, 1
buffer_store_dword v194, off, s[36:39], s3 offset:128 sc1
s_mov_b64 exec, -1
v_mfma_f32_16x16x32_bf16 v[104:107], a[180:183], v[160:163], v[104:107]
ds_read_b64_tr_b16 a[246:247], v241 offset:57600
ds_read_b64_tr_b16 a[248:249], v242 offset:49408
ds_read_b64_tr_b16 a[250:251], v242 offset:57600
ds_read_b64_tr_b16 a[252:253], v243 offset:49408
ds_read_b64_tr_b16 a[254:255], v243 offset:57600
v_mfma_f32_16x16x32_bf16 v[108:111], a[180:183], v[164:167], v[108:111]
v_mfma_f32_16x16x32_bf16 v[112:115], a[184:187], v[160:163], v[112:115]
v_mfma_f32_16x16x32_bf16 v[116:119], a[184:187], v[164:167], v[116:119]
v_mfma_f32_16x16x32_bf16 v[120:123], a[188:191], v[160:163], v[120:123]
v_mfma_f32_16x16x32_bf16 v[124:127], a[188:191], v[164:167], v[124:127]
v_mfma_f32_16x16x32_bf16 v[176:179], v[196:199], v[160:163], v[176:179]
v_mfma_f32_16x16x32_bf16 v[180:183], v[196:199], v[164:167], v[180:183]
s_waitcnt lgkmcnt(0)
s_barrier
ds_read_b64_tr_b16 v[204:205], v249 offset:0
ds_read_b64_tr_b16 v[206:207], v249 offset:2048
ds_read_b64_tr_b16 v[208:209], v249 offset:4096
ds_read_b64_tr_b16 v[210:211], v249 offset:6144
ds_read_b64_tr_b16 v[212:213], v249 offset:8192
ds_read_b64_tr_b16 v[214:215], v249 offset:10240
s_cmp_lg_u32 s91, 0
s_cbranch_scc1 L_fallback
L_fb_ret:
v_mfma_f32_16x16x32_bf16 v[176:179], v[196:199], v[168:171], v[176:179]
s_add_u32 m0, s48, 65536
ds_read_b64_tr_b16 v[216:217], v249 offset:12288
v_mfma_f32_16x16x32_bf16 v[180:183], v[196:199], v[172:175], v[180:183]
ds_read_b64_tr_b16 v[218:219], v249 offset:14336
s_sub_u32 s98, s45, 1
v_mfma_f32_16x16x32_bf16 v[0:3], a[192:195], v[168:171], v[0:3]
ds_read_b64_tr_b16 v[220:221], v249 offset:16384
v_sub_u32 v201, s98, v255
v_rcp_f32 v176, v176
v_mfma_f32_16x16x32_bf16 v[4:7], a[192:195], v[172:175], v[4:7]
ds_read_b64_tr_b16 v[222:223], v249 offset:18432
v_add_u32 v202, 7, v201
v_rcp_f32 v180, v180
v_mfma_f32_16x16x32_bf16 v[8:11], a[196:199], v[168:171], v[8:11]
ds_read_b64_tr_b16 v[224:225], v249 offset:20480
v_cmp_gt_i32 vcc, 0, v201
v_mfma_f32_16x16x32_bf16 v[12:15], a[196:199], v[172:175], v[12:15]
ds_read_b64_tr_b16 v[226:227], v249 offset:22528
v_cndmask_b32 v201, v201, v202, vcc
v_mfma_f32_16x16x32_bf16 v[16:19], a[200:203], v[168:171], v[16:19]
v_mov_b32 v202, 7
v_mfma_f32_16x16x32_bf16 v[20:23], a[200:203], v[172:175], v[20:23]
v_cmp_eq_u32 vcc, 6, v255
v_mfma_f32_16x16x32_bf16 v[24:27], a[204:207], v[168:171], v[24:27]
v_mul_f32 v0, v176, v0
v_mfma_f32_16x16x32_bf16 v[28:31], a[204:207], v[172:175], v[28:31]
v_cndmask_b32 v201, v201, v202, vcc
v_mfma_f32_16x16x32_bf16 v[32:35], a[208:211], v[168:171], v[32:35]
v_and_b32 v202, 15, v255
v_mfma_f32_16x16x32_bf16 v[36:39], a[208:211], v[172:175], v[36:39]
v_mul_u32_u24 v202, 896, v202
v_mfma_f32_16x16x32_bf16 v[40:43], a[212:215], v[168:171], v[40:43]
v_lshlrev_b32 v201, 2, v201
v_mfma_f32_16x16x32_bf16 v[44:47], a[212:215], v[172:175], v[44:47]
v_mul_f32 v1, v176, v1
v_mfma_f32_16x16x32_bf16 v[48:51], a[216:219], v[168:171], v[48:51]
v_mul_f32 v4, v180, v4
v_mfma_f32_16x16x32_bf16 v[52:55], a[216:219], v[172:175], v[52:55]
v_mul_f32 v5, v180, v5
v_mfma_f32_16x16x32_bf16 v[56:59], a[220:223], v[168:171], v[56:59]
v_mul_f32 v16, v176, v16
v_mfma_f32_16x16x32_bf16 v[60:63], a[220:223], v[172:175], v[60:63]
v_mul_f32 v17, v176, v17
v_mfma_f32_16x16x32_bf16 v[64:67], a[224:227], v[168:171], v[64:67]
v_mul_f32 v20, v180, v20
v_mfma_f32_16x16x32_bf16 v[68:71], a[224:227], v[172:175], v[68:71]
v_mul_f32 v21, v180, v21
v_mfma_f32_16x16x32_bf16 v[72:75], a[228:231], v[168:171], v[72:75]
v_mul_f32 v32, v176, v32
v_mfma_f32_16x16x32_bf16 v[76:79], a[228:231], v[172:175], v[76:79]
v_mul_f32 v33, v176, v33
v_mfma_f32_16x16x32_bf16 v[80:83], a[232:235], v[168:171], v[80:83]
v_mul_f32 v36, v180, v36
v_mfma_f32_16x16x32_bf16 v[84:87], a[232:235], v[172:175], v[84:87]
v_mul_f32 v37, v180, v37
v_mfma_f32_16x16x32_bf16 v[88:91], a[236:239], v[168:171], v[88:91]
v_mul_f32 v48, v176, v48
v_mfma_f32_16x16x32_bf16 v[92:95], a[236:239], v[172:175], v[92:95]
v_mul_f32 v49, v176, v49
v_mfma_f32_16x16x32_bf16 v[96:99], a[240:243], v[168:171], v[96:99]
v_mul_f32 v52, v180, v52
v_mfma_f32_16x16x32_bf16 v[100:103], a[240:243], v[172:175], v[100:103]
v_mul_f32 v53, v180, v53
v_mfma_f32_16x16x32_bf16 v[104:107], a[244:247], v[168:171], v[104:107]
v_mul_f32 v64, v176, v64
v_mfma_f32_16x16x32_bf16 v[108:111], a[244:247], v[172:175], v[108:111]
v_mul_f32 v65, v176, v65
v_mfma_f32_16x16x32_bf16 v[112:115], a[248:251], v[168:171], v[112:115]
v_mul_f32 v68, v180, v68
v_mfma_f32_16x16x32_bf16 v[116:119], a[248:251], v[172:175], v[116:119]
v_mul_f32 v69, v180, v69
v_mfma_f32_16x16x32_bf16 v[120:123], a[252:255], v[168:171], v[120:123]
v_mul_f32 v80, v176, v80
v_mfma_f32_16x16x32_bf16 v[124:127], a[252:255], v[172:175], v[124:127]
v_mul_f32 v81, v176, v81
s_waitcnt lgkmcnt(0)
L_final:
v_mfma_f32_16x16x32_bf16 v[128:131], v[204:207], a[0:3], 0
v_mul_f32 v112, v176, v112
v_mul_f32 v113, v176, v113
v_mul_f32 v116, v180, v116
v_mul_f32 v117, v180, v117
v_mul_f32 v114, v176, v114
v_mul_f32 v115, v176, v115
v_cvt_pk_bf16_f32 v112, v112, v113
v_mul_f32 v118, v180, v118
v_mul_f32 v119, v180, v119
v_cvt_pk_bf16_f32 v116, v116, v117
v_mul_f32 v120, v176, v120
v_mul_f32 v121, v176, v121
v_mul_f32 v122, v176, v122
v_mul_f32 v123, v176, v123
v_cvt_pk_bf16_f32 v113, v114, v115
v_mul_f32 v124, v180, v124
v_mul_f32 v125, v180, v125
v_mul_f32 v126, v180, v126
v_mul_f32 v127, v180, v127
v_cvt_pk_bf16_f32 v117, v118, v119
v_cvt_pk_bf16_f32 v114, v120, v121
v_cvt_pk_bf16_f32 v115, v122, v123
v_cvt_pk_bf16_f32 v118, v124, v125
v_cvt_pk_bf16_f32 v119, v126, v127
ds_write_b128 v254, v[112:115] offset:28672
ds_write_b128 v254, v[116:119] offset:29696
v_mfma_f32_16x16x32_bf16 v[132:135], v[204:207], a[4:7], 0
v_mul_f32 v84, v180, v84
v_mfma_f32_16x16x32_bf16 v[136:139], v[204:207], a[8:11], 0
v_mul_f32 v85, v180, v85
v_mfma_f32_16x16x32_bf16 v[140:143], v[204:207], a[12:15], 0
ds_read_b64_tr_b16 v[204:205], v249 offset:24576
v_mul_f32 v96, v176, v96
v_mfma_f32_16x16x32_bf16 v[128:131], v[208:211], a[16:19], v[128:131]
ds_read_b64_tr_b16 v[206:207], v249 offset:26624
v_mul_f32 v97, v176, v97
v_mfma_f32_16x16x32_bf16 v[132:135], v[208:211], a[20:23], v[132:135]
v_mul_f32 v100, v180, v100
v_mfma_f32_16x16x32_bf16 v[136:139], v[208:211], a[24:27], v[136:139]
v_mul_f32 v101, v180, v101
v_mfma_f32_16x16x32_bf16 v[140:143], v[208:211], a[28:31], v[140:143]
ds_read_b64_tr_b16 v[208:209], v249 offset:28672
v_mul_f32 v2, v176, v2
v_mfma_f32_16x16x32_bf16 v[128:131], v[212:215], a[32:35], v[128:131]
ds_read_b64_tr_b16 v[210:211], v249 offset:30720
v_mul_f32 v3, v176, v3
v_mfma_f32_16x16x32_bf16 v[132:135], v[212:215], a[36:39], v[132:135]
v_cvt_pk_bf16_f32 v0, v0, v1
v_mfma_f32_16x16x32_bf16 v[136:139], v[212:215], a[40:43], v[136:139]
v_mul_f32 v6, v180, v6
v_mfma_f32_16x16x32_bf16 v[140:143], v[212:215], a[44:47], v[140:143]
ds_read_b64_tr_b16 v[212:213], v249 offset:32768
v_mul_f32 v7, v180, v7
v_mfma_f32_16x16x32_bf16 v[128:131], v[216:219], a[48:51], v[128:131]
ds_read_b64_tr_b16 v[214:215], v249 offset:34816
v_cvt_pk_bf16_f32 v4, v4, v5
v_mfma_f32_16x16x32_bf16 v[132:135], v[216:219], a[52:55], v[132:135]
v_mul_f32 v18, v176, v18
v_mfma_f32_16x16x32_bf16 v[136:139], v[216:219], a[56:59], v[136:139]
v_mul_f32 v19, v176, v19
v_mfma_f32_16x16x32_bf16 v[140:143], v[216:219], a[60:63], v[140:143]
ds_read_b64_tr_b16 v[216:217], v249 offset:36864
v_cvt_pk_bf16_f32 v16, v16, v17
v_mfma_f32_16x16x32_bf16 v[128:131], v[220:223], a[64:67], v[128:131]
ds_read_b64_tr_b16 v[218:219], v249 offset:38912
v_mul_f32 v22, v180, v22
v_mfma_f32_16x16x32_bf16 v[132:135], v[220:223], a[68:71], v[132:135]
v_mul_f32 v23, v180, v23
v_mfma_f32_16x16x32_bf16 v[136:139], v[220:223], a[72:75], v[136:139]
v_cvt_pk_bf16_f32 v20, v20, v21
v_mfma_f32_16x16x32_bf16 v[140:143], v[220:223], a[76:79], v[140:143]
ds_read_b64_tr_b16 v[220:221], v249 offset:40960
v_mul_f32 v34, v176, v34
v_mfma_f32_16x16x32_bf16 v[128:131], v[224:227], a[80:83], v[128:131]
ds_read_b64_tr_b16 v[222:223], v249 offset:43008
v_mul_f32 v35, v176, v35
v_mfma_f32_16x16x32_bf16 v[132:135], v[224:227], a[84:87], v[132:135]
v_cvt_pk_bf16_f32 v32, v32, v33
v_mfma_f32_16x16x32_bf16 v[136:139], v[224:227], a[88:91], v[136:139]
v_mul_f32 v38, v180, v38
v_mfma_f32_16x16x32_bf16 v[140:143], v[224:227], a[92:95], v[140:143]
ds_read_b64_tr_b16 v[224:225], v249 offset:45056
s_waitcnt lgkmcnt(4)
v_mfma_f32_16x16x32_bf16 v[128:131], v[204:207], a[96:99], v[128:131]
ds_read_b64_tr_b16 v[226:227], v249 offset:47104
v_mul_f32 v39, v180, v39
v_mfma_f32_16x16x32_bf16 v[132:135], v[204:207], a[100:103], v[132:135]
v_cvt_pk_bf16_f32 v36, v36, v37
v_mfma_f32_16x16x32_bf16 v[136:139], v[204:207], a[104:107], v[136:139]
v_mul_f32 v50, v176, v50
v_mfma_f32_16x16x32_bf16 v[140:143], v[204:207], a[108:111], v[140:143]
ds_read_b64_tr_b16 v[204:205], v249 offset:49152
v_cvt_pk_bf16_f32 v228, v128, v129
v_mfma_f32_16x16x32_bf16 v[144:147], v[208:211], a[0:3], 0
v_cvt_pk_bf16_f32 v229, v130, v131
v_mfma_f32_16x16x32_bf16 v[148:151], v[208:211], a[4:7], 0
v_cvt_pk_bf16_f32 v230, v132, v133
v_mfma_f32_16x16x32_bf16 v[152:155], v[208:211], a[8:11], 0
v_cvt_pk_bf16_f32 v231, v134, v135
v_mfma_f32_16x16x32_bf16 v[156:159], v[208:211], a[12:15], 0
v_cvt_pk_bf16_f32 v232, v136, v137
v_mfma_f32_16x16x32_bf16 v[144:147], v[212:215], a[16:19], v[144:147]
v_cvt_pk_bf16_f32 v233, v138, v139
v_mfma_f32_16x16x32_bf16 v[148:151], v[212:215], a[20:23], v[148:151]
v_cvt_pk_bf16_f32 v234, v140, v141
v_mfma_f32_16x16x32_bf16 v[152:155], v[212:215], a[24:27], v[152:155]
v_cvt_pk_bf16_f32 v235, v142, v143
v_mfma_f32_16x16x32_bf16 v[156:159], v[212:215], a[28:31], v[156:159]
ds_read_b64_tr_b16 v[206:207], v249 offset:51200
s_waitcnt lgkmcnt(1)
v_mfma_f32_16x16x32_bf16 v[144:147], v[216:219], a[32:35], v[144:147]
ds_read_b64_tr_b16 v[208:209], v249 offset:53248
v_mul_f32 v51, v176, v51
v_mfma_f32_16x16x32_bf16 v[148:151], v[216:219], a[36:39], v[148:151]
ds_read_b64_tr_b16 v[210:211], v249 offset:55296
v_cvt_pk_bf16_f32 v48, v48, v49
v_mfma_f32_16x16x32_bf16 v[152:155], v[216:219], a[40:43], v[152:155]
v_mul_f32 v54, v180, v54
v_mfma_f32_16x16x32_bf16 v[156:159], v[216:219], a[44:47], v[156:159]
v_mul_f32 v55, v180, v55
v_mfma_f32_16x16x32_bf16 v[144:147], v[220:223], a[48:51], v[144:147]
v_cvt_pk_bf16_f32 v52, v52, v53
v_mfma_f32_16x16x32_bf16 v[148:151], v[220:223], a[52:55], v[148:151]
v_mul_f32 v66, v176, v66
v_mfma_f32_16x16x32_bf16 v[152:155], v[220:223], a[56:59], v[152:155]
v_mul_f32 v67, v176, v67
v_mfma_f32_16x16x32_bf16 v[156:159], v[220:223], a[60:63], v[156:159]
v_cvt_pk_bf16_f32 v64, v64, v65
v_mfma_f32_16x16x32_bf16 v[144:147], v[224:227], a[64:67], v[144:147]
v_mul_f32 v70, v180, v70
v_mul_f32 v71, v180, v71
v_mfma_f32_16x16x32_bf16 v[148:151], v[224:227], a[68:71], v[148:151]
v_cvt_pk_bf16_f32 v68, v68, v69
v_mul_f32 v82, v176, v82
v_mul_f32 v83, v176, v83
v_cvt_pk_bf16_f32 v80, v80, v81
v_mul_f32 v86, v180, v86
v_mul_f32 v87, v180, v87
v_cvt_pk_bf16_f32 v84, v84, v85
v_mul_f32 v98, v176, v98
v_mul_f32 v99, v176, v99
v_cvt_pk_bf16_f32 v96, v96, v97
v_mul_f32 v102, v180, v102
v_mul_f32 v103, v180, v103
v_cvt_pk_bf16_f32 v100, v100, v101
v_mfma_f32_16x16x32_bf16 v[152:155], v[224:227], a[72:75], v[152:155]
v_mul_f32 v8, v176, v8
v_mul_f32 v9, v176, v9
v_mul_f32 v10, v176, v10
v_mul_f32 v11, v176, v11
v_cvt_pk_bf16_f32 v1, v2, v3
v_mul_f32 v12, v180, v12
v_mul_f32 v13, v180, v13
v_mul_f32 v14, v180, v14
v_mul_f32 v15, v180, v15
v_cvt_pk_bf16_f32 v5, v6, v7
v_mul_f32 v24, v176, v24
v_mul_f32 v25, v176, v25
v_mul_f32 v26, v176, v26
v_mul_f32 v27, v176, v27
v_cvt_pk_bf16_f32 v17, v18, v19
v_mul_f32 v28, v180, v28
v_mul_f32 v29, v180, v29
v_mul_f32 v30, v180, v30
v_mul_f32 v31, v180, v31
v_cvt_pk_bf16_f32 v21, v22, v23
v_mul_f32 v40, v176, v40
v_mul_f32 v41, v176, v41
v_mul_f32 v42, v176, v42
v_mul_f32 v43, v176, v43
v_cvt_pk_bf16_f32 v33, v34, v35
v_mul_f32 v44, v180, v44
v_mul_f32 v45, v180, v45
v_mul_f32 v46, v180, v46
v_mul_f32 v47, v180, v47
v_cvt_pk_bf16_f32 v37, v38, v39
v_mul_f32 v56, v176, v56
v_mul_f32 v57, v176, v57
v_mul_f32 v58, v176, v58
v_mul_f32 v59, v176, v59
v_cvt_pk_bf16_f32 v49, v50, v51
v_mul_f32 v60, v180, v60
v_mul_f32 v61, v180, v61
v_mul_f32 v62, v180, v62
v_mul_f32 v63, v180, v63
v_cvt_pk_bf16_f32 v53, v54, v55
v_mul_f32 v72, v176, v72
v_mul_f32 v73, v176, v73
v_mul_f32 v74, v176, v74
v_mul_f32 v75, v176, v75
v_cvt_pk_bf16_f32 v65, v66, v67
v_mul_f32 v76, v180, v76
v_mul_f32 v77, v180, v77
v_mul_f32 v78, v180, v78
v_mul_f32 v79, v180, v79
v_cvt_pk_bf16_f32 v69, v70, v71
v_mul_f32 v88, v176, v88
v_mul_f32 v89, v176, v89
v_mul_f32 v90, v176, v90
v_mul_f32 v91, v176, v91
v_cvt_pk_bf16_f32 v81, v82, v83
v_mul_f32 v92, v180, v92
v_mul_f32 v93, v180, v93
v_mul_f32 v94, v180, v94
v_mul_f32 v95, v180, v95
v_cvt_pk_bf16_f32 v85, v86, v87
v_mul_f32 v104, v176, v104
v_mul_f32 v105, v176, v105
v_mul_f32 v106, v176, v106
v_mul_f32 v107, v176, v107
v_cvt_pk_bf16_f32 v97, v98, v99
v_mul_f32 v108, v180, v108
v_mul_f32 v109, v180, v109
v_mul_f32 v110, v180, v110
v_mul_f32 v111, v180, v111
v_cvt_pk_bf16_f32 v101, v102, v103
v_cvt_pk_bf16_f32 v2, v8, v9
v_cvt_pk_bf16_f32 v3, v10, v11
v_cvt_pk_bf16_f32 v6, v12, v13
v_cvt_pk_bf16_f32 v7, v14, v15
v_cvt_pk_bf16_f32 v18, v24, v25
v_cvt_pk_bf16_f32 v19, v26, v27
v_cvt_pk_bf16_f32 v22, v28, v29
v_cvt_pk_bf16_f32 v23, v30, v31
v_cvt_pk_bf16_f32 v34, v40, v41
v_cvt_pk_bf16_f32 v35, v42, v43
v_cvt_pk_bf16_f32 v38, v44, v45
v_cvt_pk_bf16_f32 v39, v46, v47
v_cvt_pk_bf16_f32 v50, v56, v57
v_cvt_pk_bf16_f32 v51, v58, v59
v_cvt_pk_bf16_f32 v54, v60, v61
v_cvt_pk_bf16_f32 v55, v62, v63
v_cvt_pk_bf16_f32 v66, v72, v73
v_cvt_pk_bf16_f32 v67, v74, v75
v_cvt_pk_bf16_f32 v70, v76, v77
v_cvt_pk_bf16_f32 v71, v78, v79
v_cvt_pk_bf16_f32 v82, v88, v89
v_cvt_pk_bf16_f32 v83, v90, v91
v_cvt_pk_bf16_f32 v86, v92, v93
v_cvt_pk_bf16_f32 v87, v94, v95
v_cvt_pk_bf16_f32 v98, v104, v105
v_cvt_pk_bf16_f32 v99, v106, v107
v_cvt_pk_bf16_f32 v102, v108, v109
v_cvt_pk_bf16_f32 v103, v110, v111
ds_write_b128 v254, v[0:3] offset:0
ds_write_b128 v254, v[4:7] offset:1024
ds_write_b128 v254, v[16:19] offset:4096
ds_write_b128 v254, v[20:23] offset:5120
ds_write_b128 v254, v[32:35] offset:8192
ds_write_b128 v254, v[36:39] offset:9216
ds_write_b128 v254, v[48:51] offset:12288
ds_write_b128 v254, v[52:55] offset:13312
ds_write_b128 v254, v[64:67] offset:16384
ds_write_b128 v254, v[68:71] offset:17408
ds_write_b128 v254, v[80:83] offset:20480
ds_write_b128 v254, v[84:87] offset:21504
ds_write_b128 v254, v[96:99] offset:24576
ds_write_b128 v254, v[100:103] offset:25600
v_mfma_f32_16x16x32_bf16 v[156:159], v[224:227], a[76:79], v[156:159]
s_waitcnt vmcnt(1)
s_barrier
s_waitcnt lgkmcnt(5)
v_mfma_f32_16x16x32_bf16 v[144:147], v[204:207], a[80:83], v[144:147]
buffer_load_dwordx4 v244, s[24:27], s73 offen offset:0 lds
v_mfma_f32_16x16x32_bf16 v[148:151], v[204:207], a[84:87], v[148:151]
ds_read_b64_tr_b16 v[212:213], v250 offset:4096
ds_read_b64_tr_b16 v[214:215], v250 offset:6144
v_mfma_f32_16x16x32_bf16 v[152:155], v[204:207], a[88:91], v[152:155]
s_waitcnt lgkmcnt(2)
s_barrier
v_mfma_f32_16x16x32_bf16 v[156:159], v[204:207], a[92:95], v[156:159]
buffer_load_dwordx4 v245, s[24:27], s73 offen offset:1024 lds
v_mfma_f32_16x16x32_bf16 v[144:147], v[208:211], a[96:99], v[144:147]
ds_read_b64_tr_b16 v[216:217], v250 offset:8192
ds_read_b64_tr_b16 v[218:219], v250 offset:10240
v_mfma_f32_16x16x32_bf16 v[148:151], v[208:211], a[100:103], v[148:151]
ds_read_b64_tr_b16 v[220:221], v250 offset:12288
v_mfma_f32_16x16x32_bf16 v[152:155], v[208:211], a[104:107], v[152:155]
buffer_load_dwordx4 v246, s[24:27], s73 offen offset:2048 lds
v_mfma_f32_16x16x32_bf16 v[156:159], v[208:211], a[108:111], v[156:159]
ds_read_b64_tr_b16 v[222:223], v250 offset:14336
s_waitcnt lgkmcnt(4)
v_mfma_f32_16x16x32_bf16 v[128:131], v[212:215], a[0:3], 0
v_cvt_pk_bf16_f32 v236, v144, v145
v_cvt_pk_bf16_f32 v237, v146, v147
v_mfma_f32_16x16x32_bf16 v[132:135], v[212:215], a[4:7], 0
v_cvt_pk_bf16_f32 v238, v148, v149
buffer_load_dwordx4 v247, s[24:27], s73 offen offset:3072 lds
s_add_u32 m0, s48, 81920
v_mfma_f32_16x16x32_bf16 v[136:139], v[212:215], a[8:11], 0
v_cvt_pk_bf16_f32 v239, v150, v151
s_add_u32 s73, s51, s54
v_mfma_f32_16x16x32_bf16 v[140:143], v[212:215], a[12:15], 0
v_cvt_pk_bf16_f32 v240, v152, v153
s_waitcnt lgkmcnt(2)
v_mfma_f32_16x16x32_bf16 v[128:131], v[216:219], a[16:19], v[128:131]
v_cvt_pk_bf16_f32 v241, v154, v155
buffer_load_dwordx4 v244, s[24:27], s74 offen offset:0 lds
v_mfma_f32_16x16x32_bf16 v[132:135], v[216:219], a[20:23], v[132:135]
v_cvt_pk_bf16_f32 v242, v156, v157
ds_read_b64_tr_b16 v[224:225], v250 offset:16384
ds_read_b64_tr_b16 v[226:227], v250 offset:18432
v_mfma_f32_16x16x32_bf16 v[136:139], v[216:219], a[24:27], v[136:139]
v_cvt_pk_bf16_f32 v243, v158, v159
v_mfma_f32_16x16x32_bf16 v[140:143], v[216:219], a[28:31], v[140:143]
ds_read_b64_tr_b16 v[204:205], v250 offset:20480
buffer_load_dwordx4 v245, s[24:27], s74 offen offset:1024 lds
s_waitcnt lgkmcnt(3)
v_mfma_f32_16x16x32_bf16 v[128:131], v[220:223], a[32:35], v[128:131]
ds_read_b64_tr_b16 v[206:207], v250 offset:22528
v_mfma_f32_16x16x32_bf16 v[132:135], v[220:223], a[36:39], v[132:135]
ds_read_b64_tr_b16 v[208:209], v250 offset:24576
v_mfma_f32_16x16x32_bf16 v[136:139], v[220:223], a[40:43], v[136:139]
ds_read_b64_tr_b16 v[210:211], v250 offset:26624
buffer_load_dwordx4 v246, s[24:27], s74 offen offset:2048 lds
v_mfma_f32_16x16x32_bf16 v[140:143], v[220:223], a[44:47], v[140:143]
ds_read_b64_tr_b16 v[212:213], v250 offset:28672
s_waitcnt lgkmcnt(5)
v_mfma_f32_16x16x32_bf16 v[128:131], v[224:227], a[48:51], v[128:131]
ds_read_b64_tr_b16 v[214:215], v250 offset:30720
v_mfma_f32_16x16x32_bf16 v[132:135], v[224:227], a[52:55], v[132:135]
ds_read_b128 a[112:115], v251 offset:0
v_mfma_f32_16x16x32_bf16 v[136:139], v[224:227], a[56:59], v[136:139]
buffer_load_dwordx4 v247, s[24:27], s74 offen offset:3072 lds
v_mfma_f32_16x16x32_bf16 v[140:143], v[224:227], a[60:63], v[140:143]
s_add_u32 m0, s48, 98304
s_waitcnt lgkmcnt(5)
v_mfma_f32_16x16x32_bf16 v[128:131], v[204:207], a[64:67], v[128:131]
s_add_u32 s74, s51, s54
ds_read_b128 a[116:119], v251 offset:1024
v_mfma_f32_16x16x32_bf16 v[132:135], v[204:207], a[68:71], v[132:135]
s_add_u32 s74, s74, 114688
ds_read_b128 a[120:123], v251 offset:2048
v_mfma_f32_16x16x32_bf16 v[136:139], v[204:207], a[72:75], v[136:139]
buffer_load_dwordx4 v244, s[24:27], s75 offen offset:0 lds
v_mfma_f32_16x16x32_bf16 v[140:143], v[204:207], a[76:79], v[140:143]
ds_read_b128 a[124:127], v251 offset:3072
s_waitcnt lgkmcnt(4)
v_mfma_f32_16x16x32_bf16 v[128:131], v[208:211], a[80:83], v[128:131]
ds_read_b128 a[128:131], v251 offset:4096
v_mfma_f32_16x16x32_bf16 v[132:135], v[208:211], a[84:87], v[132:135]
ds_read_b128 a[132:135], v251 offset:5120
v_mfma_f32_16x16x32_bf16 v[136:139], v[208:211], a[88:91], v[136:139]
buffer_load_dwordx4 v245, s[24:27], s75 offen offset:1024 lds
v_mfma_f32_16x16x32_bf16 v[140:143], v[208:211], a[92:95], v[140:143]
ds_read_b128 a[136:139], v251 offset:6144
v_mfma_f32_16x16x32_bf16 v[128:131], v[212:215], a[96:99], v[128:131]
ds_read_b128 a[140:143], v251 offset:7168
v_mfma_f32_16x16x32_bf16 v[132:135], v[212:215], a[100:103], v[132:135]
ds_read_b128 a[144:147], v251 offset:8192
buffer_load_dwordx4 v246, s[24:27], s75 offen offset:2048 lds
v_mfma_f32_16x16x32_bf16 v[136:139], v[212:215], a[104:107], v[136:139]
ds_read_b128 a[148:151], v251 offset:9216
v_mfma_f32_16x16x32_bf16 v[140:143], v[212:215], a[108:111], v[140:143]
s_mov_b64 exec, 0x7f
buffer_load_dword v203, v201, s[36:39], s67 offen offset:128 sc1
s_mov_b64 exec, -1
ds_read_b128 a[152:155], v251 offset:10240
ds_read_b128 a[156:159], v251 offset:11264
ds_read_b128 a[160:163], v251 offset:12288
ds_read_b128 a[164:167], v251 offset:13312
ds_read_b128 a[168:171], v251 offset:14336
ds_read_b128 a[172:175], v251 offset:15360
buffer_load_dwordx4 v247, s[24:27], s75 offen offset:3072 lds
s_add_u32 m0, s48, 114688
s_add_u32 s75, s51, s54
s_add_u32 s75, s75, 229376
s_cmp_eq_u32 s45, 7
s_cbranch_scc0 L_no_d6
v_cvt_pk_bf16_f32 v112, v128, v129
v_cvt_pk_bf16_f32 v113, v130, v131
v_cvt_pk_bf16_f32 v114, v132, v133
v_cvt_pk_bf16_f32 v115, v134, v135
v_cvt_pk_bf16_f32 v116, v136, v137
v_cvt_pk_bf16_f32 v117, v138, v139
v_cvt_pk_bf16_f32 v118, v140, v141
v_cvt_pk_bf16_f32 v119, v142, v143
s_add_u32 s69, s65, 8192
buffer_store_dwordx4 v[112:115], v253, s[36:39], s69 offen offset:0 sc1
buffer_store_dwordx4 v[116:119], v253, s[36:39], s69 offen offset:1024 sc1
s_waitcnt vmcnt(0)
s_lshl_b32 s69, s58, 1
s_add_u32 s69, s69, s66
s_mov_b64 exec, 1
buffer_store_dword v200, off, s[36:39], s69 offset:128 sc1
s_mov_b64 exec, -1
L_no_d6:
ds_read_b128 a[176:179], v251 offset:16384
ds_read_b128 a[180:183], v251 offset:17408
ds_read_b128 a[184:187], v251 offset:18432
ds_read_b128 a[188:191], v251 offset:19456
ds_read_b128 a[192:195], v251 offset:20480
buffer_load_dwordx4 v244, s[24:27], s76 offen offset:0 lds
s_sub_u32 s94, s45, 1
s_add_u32 s98, s94, 7
s_cmp_lt_i32 s94, 0
s_cselect_b32 s94, s98, s94
s_lshl_b32 s94, s94, 14
s_add_u32 s94, s94, s68
s_add_u32 s94, s94, 8192
s_sub_u32 s95, s45, 2
s_add_u32 s98, s95, 7
s_cmp_lt_i32 s95, 0
s_cselect_b32 s95, s98, s95
s_lshl_b32 s95, s95, 14
s_add_u32 s95, s95, s68
buffer_load_dwordx4 v245, s[24:27], s76 offen offset:1024 lds
s_add_u32 s95, s95, 8192
ds_read_b128 a[196:199], v251 offset:21504
ds_read_b128 a[200:203], v251 offset:22528
ds_read_b128 a[204:207], v251 offset:23552
s_waitcnt vmcnt(7)
s_barrier
ds_read_b64_tr_b16 v[204:205], v249 offset:0
ds_read_b64_tr_b16 v[206:207], v249 offset:2048
ds_read_b64_tr_b16 v[208:209], v249 offset:4096
buffer_load_dwordx4 v246, s[24:27], s76 offen offset:2048 lds
ds_read_b64_tr_b16 v[210:211], v249 offset:6144
ds_read_b64_tr_b16 v[212:213], v249 offset:8192
ds_read_b64_tr_b16 v[214:215], v249 offset:10240
ds_read_b64_tr_b16 v[216:217], v249 offset:12288
ds_read_b64_tr_b16 v[218:219], v249 offset:14336
ds_read_b64_tr_b16 v[220:221], v249 offset:16384
ds_read_b64_tr_b16 v[222:223], v249 offset:18432
buffer_load_dwordx4 v247, s[24:27], s76 offen offset:3072 lds
s_add_u32 m0, s48, 131072
s_add_u32 s76, s51, s54
s_add_u32 s76, s76, 344064
ds_read_b64_tr_b16 v[224:225], v249 offset:20480
ds_read_b64_tr_b16 v[226:227], v249 offset:22528
ds_read_b128 a[208:211], v251 offset:24576
ds_read_b128 a[212:215], v251 offset:25600
s_waitcnt lgkmcnt(12)
v_mfma_f32_16x16x32_bf16 v[160:163], v[204:207], a[112:115], 0
buffer_load_dwordx4 v244, s[24:27], s77 offen offset:0 lds
v_mfma_f32_16x16x32_bf16 v[164:167], v[204:207], a[116:119], 0
ds_read_b128 a[216:219], v251 offset:26624
v_mfma_f32_16x16x32_bf16 v[168:171], v[204:207], a[120:123], 0
ds_read_b128 a[220:223], v251 offset:27648
v_mfma_f32_16x16x32_bf16 v[172:175], v[204:207], a[124:127], 0
ds_read_b64_tr_b16 v[204:205], v249 offset:24576
s_waitcnt lgkmcnt(8)
v_mfma_f32_16x16x32_bf16 v[160:163], v[208:211], a[128:131], v[160:163]
buffer_load_dwordx4 v245, s[24:27], s77 offen offset:1024 lds
v_mfma_f32_16x16x32_bf16 v[164:167], v[208:211], a[132:135], v[164:167]
ds_read_b64_tr_b16 v[206:207], v249 offset:26624
v_mfma_f32_16x16x32_bf16 v[168:171], v[208:211], a[136:139], v[168:171]
ds_read_b128 a[224:227], v251 offset:28672
v_mfma_f32_16x16x32_bf16 v[172:175], v[208:211], a[140:143], v[172:175]
ds_read_b64_tr_b16 v[208:209], v249 offset:28672
v_mfma_f32_16x16x32_bf16 v[160:163], v[212:215], a[144:147], v[160:163]
buffer_load_dwordx4 v246, s[24:27], s77 offen offset:2048 lds
v_mfma_f32_16x16x32_bf16 v[164:167], v[212:215], a[148:151], v[164:167]
ds_read_b64_tr_b16 v[210:211], v249 offset:30720
v_mfma_f32_16x16x32_bf16 v[168:171], v[212:215], a[152:155], v[168:171]
ds_read_b128 a[228:231], v251 offset:29696
v_mfma_f32_16x16x32_bf16 v[172:175], v[212:215], a[156:159], v[172:175]
ds_read_b128 a[232:235], v251 offset:30720
v_mfma_f32_16x16x32_bf16 v[160:163], v[216:219], a[160:163], v[160:163]
buffer_load_dwordx4 v247, s[24:27], s77 offen offset:3072 lds
v_mfma_f32_16x16x32_bf16 v[164:167], v[216:219], a[164:167], v[164:167]
s_add_u32 m0, s48, 147456
s_add_u32 s77, s51, s55
v_mfma_f32_16x16x32_bf16 v[168:171], v[216:219], a[168:171], v[168:171]
ds_read_b128 a[236:239], v251 offset:31744
v_mfma_f32_16x16x32_bf16 v[172:175], v[216:219], a[172:175], v[172:175]
ds_read_b128 a[240:243], v251 offset:32768
s_waitcnt lgkmcnt(5)
v_mfma_f32_16x16x32_bf16 v[160:163], v[220:223], a[176:179], v[160:163]
buffer_load_dwordx4 v244, s[24:27], s70 offen offset:0 lds
v_mfma_f32_16x16x32_bf16 v[164:167], v[220:223], a[180:183], v[164:167]
ds_read_b128 a[244:247], v251 offset:33792
v_mfma_f32_16x16x32_bf16 v[168:171], v[220:223], a[184:187], v[168:171]
ds_read_b128 a[248:251], v251 offset:34816
v_mfma_f32_16x16x32_bf16 v[172:175], v[220:223], a[188:191], v[172:175]
ds_read_b128 a[252:255], v251 offset:35840
v_mfma_f32_16x16x32_bf16 v[160:163], v[224:227], a[192:195], v[160:163]
buffer_load_dwordx4 v245, s[24:27], s70 offen offset:1024 lds
v_mfma_f32_16x16x32_bf16 v[164:167], v[224:227], a[196:199], v[164:167]
ds_read_b128 v[0:3], v251 offset:36864
v_mfma_f32_16x16x32_bf16 v[168:171], v[224:227], a[200:203], v[168:171]
s_waitcnt lgkmcnt(4) vmcnt(6)
s_barrier
v_mfma_f32_16x16x32_bf16 v[172:175], v[224:227], a[204:207], v[172:175]
buffer_load_dwordx4 v246, s[24:27], s70 offen offset:2048 lds
v_mfma_f32_16x16x32_bf16 v[160:163], v[204:207], a[208:211], v[160:163]
ds_read_b64_tr_b16 v[212:213], v249 offset:32768
ds_read_b64_tr_b16 v[214:215], v249 offset:34816
v_mfma_f32_16x16x32_bf16 v[164:167], v[204:207], a[212:215], v[164:167]
ds_read_b64_tr_b16 v[216:217], v249 offset:36864
v_mfma_f32_16x16x32_bf16 v[168:171], v[204:207], a[216:219], v[168:171]
buffer_load_dwordx4 v247, s[24:27], s70 offen offset:3072 lds
v_mfma_f32_16x16x32_bf16 v[172:175], v[204:207], a[220:223], v[172:175]
s_add_u32 m0, s48, 65536
s_add_u32 s70, s51, s55
v_mfma_f32_16x16x32_bf16 v[160:163], v[208:211], a[224:227], v[160:163]
s_add_u32 s70, s70, 114688
ds_read_b64_tr_b16 v[218:219], v249 offset:38912
v_mfma_f32_16x16x32_bf16 v[164:167], v[208:211], a[228:231], v[164:167]
ds_read_b128 v[4:7], v251 offset:37888
v_mfma_f32_16x16x32_bf16 v[168:171], v[208:211], a[232:235], v[168:171]
buffer_load_dwordx4 v244, s[24:27], s71 offen offset:0 lds
v_mfma_f32_16x16x32_bf16 v[172:175], v[208:211], a[236:239], v[172:175]
ds_read_b128 v[8:11], v251 offset:38912
s_waitcnt lgkmcnt(4)
v_mfma_f32_16x16x32_bf16 v[160:163], v[212:215], a[240:243], v[160:163]
ds_read_b128 v[12:15], v251 offset:39936
ds_read_b128 v[16:19], v251 offset:40960
v_mfma_f32_16x16x32_bf16 v[164:167], v[212:215], a[244:247], v[164:167]
buffer_load_dwordx4 v245, s[24:27], s71 offen offset:1024 lds
ds_read_b64_tr_b16 v[220:221], v249 offset:40960
ds_read_b64_tr_b16 v[222:223], v249 offset:43008
v_mfma_f32_16x16x32_bf16 v[168:171], v[212:215], a[248:251], v[168:171]
ds_read_b128 v[20:23], v251 offset:41984
ds_read_b128 v[24:27], v251 offset:43008
v_mfma_f32_16x16x32_bf16 v[172:175], v[212:215], a[252:255], v[172:175]
ds_read_b128 v[28:31], v251 offset:44032
s_waitcnt lgkmcnt(8)
v_mfma_f32_16x16x32_bf16 v[160:163], v[216:219], v[0:3], v[160:163]
buffer_load_dwordx4 v246, s[24:27], s71 offen offset:2048 lds
v_mfma_f32_16x16x32_bf16 v[164:167], v[216:219], v[4:7], v[164:167]
ds_read_b128 v[32:35], v251 offset:45056
ds_read_b64_tr_b16 v[224:225], v249 offset:45056
ds_read_b64_tr_b16 v[226:227], v249 offset:47104
s_waitcnt lgkmcnt(8)
v_mfma_f32_16x16x32_bf16 v[168:171], v[216:219], v[8:11], v[168:171]
ds_read_b128 v[36:39], v251 offset:46080
v_mfma_f32_16x16x32_bf16 v[172:175], v[216:219], v[12:15], v[172:175]
ds_read_b128 v[40:43], v251 offset:47104
s_waitcnt lgkmcnt(8)
v_mfma_f32_16x16x32_bf16 v[160:163], v[220:223], v[16:19], v[160:163]
ds_read_b128 v[44:47], v251 offset:48128
s_waitcnt lgkmcnt(8)
v_mfma_f32_16x16x32_bf16 v[164:167], v[220:223], v[20:23], v[164:167]
ds_read_b128 v[48:51], v251 offset:49152
ds_read_b64_tr_b16 v[204:205], v249 offset:49152
ds_read_b64_tr_b16 v[206:207], v249 offset:51200
s_waitcnt lgkmcnt(9)
v_mfma_f32_16x16x32_bf16 v[168:171], v[220:223], v[24:27], v[168:171]
buffer_load_dwordx4 v247, s[24:27], s71 offen offset:3072 lds
ds_read_b128 v[52:55], v251 offset:50176
v_mfma_f32_16x16x32_bf16 v[172:175], v[220:223], v[28:31], v[172:175]
s_add_u32 m0, s48, 81920
ds_read_b128 v[56:59], v251 offset:51200
s_waitcnt lgkmcnt(8)
v_mfma_f32_16x16x32_bf16 v[160:163], v[224:227], v[32:35], v[160:163]
s_add_u32 s71, s51, s55
ds_read_b128 v[60:63], v251 offset:52224
s_waitcnt lgkmcnt(8)
v_mfma_f32_16x16x32_bf16 v[164:167], v[224:227], v[36:39], v[164:167]
s_add_u32 s71, s71, 229376
ds_read_b128 v[64:67], v251 offset:53248
ds_read_b64_tr_b16 v[208:209], v249 offset:53248
v_cmp_ne_u32 vcc, 0, v203
s_nop 3
s_and_b32 s99, vcc_lo, 15
s_cmp_eq_u32 s45, 7
s_cselect_b32 s99, 15, s3
s_cmp_eq_u32 s99, 15
s_cbranch_scc1 L_d0_ok
s_mov_b32 s100, 0x5000
L_d0_spin:
s_sleep 2
s_mov_b64 exec, 0x7f
buffer_load_dword v203, v201, s[36:39], s67 offen offset:128 sc1
s_mov_b64 exec, -1
s_waitcnt vmcnt(0)
v_cmp_ne_u32 vcc, 0, v203
s_sub_u32 s100, s100, 1
s_cmp_eq_u32 s100, 0
s_cbranch_scc1 L_d0_ok
s_and_b32 s99, vcc_lo, 15
s_cmp_lg_u32 s99, 15
s_cbranch_scc1 L_d0_spin
L_d0_ok:
buffer_load_dwordx4 v[144:147], v253, s[36:39], s94 offen offset:0 sc1
ds_read_b64_tr_b16 v[210:211], v249 offset:55296
s_waitcnt lgkmcnt(6)
v_mfma_f32_16x16x32_bf16 v[168:171], v[224:227], v[40:43], v[168:171]
s_add_u32 s100, s63, 8192
ds_read_b128 v[68:71], v251 offset:54272
v_mfma_f32_16x16x32_bf16 v[172:175], v[224:227], v[44:47], v[172:175]
buffer_load_dwordx4 v[148:151], v253, s[36:39], s94 offen offset:1024 sc1
ds_read_b128 v[72:75], v251 offset:55296
v_mfma_f32_16x16x32_bf16 v[160:163], v[204:207], v[48:51], v[160:163]
ds_read_b128 v[76:79], v251 offset:56320
s_waitcnt lgkmcnt(6)
v_mfma_f32_16x16x32_bf16 v[164:167], v[204:207], v[52:55], v[164:167]
buffer_load_dwordx4 v[152:155], v253, s[36:39], s95 offen offset:0 sc1
ds_read_b128 v[80:83], v251 offset:57344
ds_read_b64_tr_b16 v[212:213], v249 offset:57344
ds_read_b64_tr_b16 v[214:215], v249 offset:59392
buffer_load_dwordx4 v[156:159], v253, s[36:39], s95 offen offset:1024 sc1
v_mfma_f32_16x16x32_bf16 v[168:171], v[204:207], v[56:59], v[168:171]
ds_read_b128 v[84:87], v251 offset:58368
ds_read_b128 v[88:91], v251 offset:59392
ds_read_b128 v[92:95], v251 offset:60416
ds_read_b128 v[96:99], v251 offset:61440
ds_read_b128 v[100:103], v251 offset:62464
ds_read_b128 v[104:107], v251 offset:63488
ds_read_b128 v[108:111], v251 offset:64512
ds_read_b64_tr_b16 v[216:217], v249 offset:61440
ds_read_b64_tr_b16 v[218:219], v249 offset:63488
v_mfma_f32_16x16x32_bf16 v[172:175], v[204:207], v[60:63], v[172:175]
s_waitcnt lgkmcnt(12)
v_mfma_f32_16x16x32_bf16 v[160:163], v[208:211], v[64:67], v[160:163]
buffer_load_dwordx4 v244, s[24:27], s72 offen offset:0 lds
v_mfma_f32_16x16x32_bf16 v[164:167], v[208:211], v[68:71], v[164:167]
v_mfma_f32_16x16x32_bf16 v[168:171], v[208:211], v[72:75], v[168:171]
v_mfma_f32_16x16x32_bf16 v[172:175], v[208:211], v[76:79], v[172:175]
s_waitcnt lgkmcnt(5)
v_mfma_f32_16x16x32_bf16 v[160:163], v[212:215], v[80:83], v[160:163]
buffer_load_dwordx4 v245, s[24:27], s72 offen offset:1024 lds
s_waitcnt lgkmcnt(0) vmcnt(10)
s_barrier
v_mfma_f32_16x16x32_bf16 v[164:167], v[212:215], v[84:87], v[164:167]
ds_read_b64_tr_b16 v[220:221], v250 offset:0
ds_read_b64_tr_b16 v[222:223], v250 offset:2048
v_mfma_f32_16x16x32_bf16 v[168:171], v[212:215], v[88:91], v[168:171]
ds_read_b64_tr_b16 v[224:225], v250 offset:4096
v_mfma_f32_16x16x32_bf16 v[172:175], v[212:215], v[92:95], v[172:175]
buffer_load_dwordx4 v246, s[24:27], s72 offen offset:2048 lds
v_mfma_f32_16x16x32_bf16 v[160:163], v[216:219], v[96:99], v[160:163]
ds_read_b64_tr_b16 v[226:227], v250 offset:6144
v_mfma_f32_16x16x32_bf16 v[164:167], v[216:219], v[100:103], v[164:167]
ds_read_b64_tr_b16 v[204:205], v250 offset:8192
v_mfma_f32_16x16x32_bf16 v[168:171], v[216:219], v[104:107], v[168:171]
ds_read_b64_tr_b16 v[206:207], v250 offset:10240
buffer_load_dwordx4 v247, s[24:27], s72 offen offset:3072 lds
v_mfma_f32_16x16x32_bf16 v[172:175], v[216:219], v[108:111], v[172:175]
s_add_u32 m0, s48, 98304
v_cvt_pk_bf16_f32 v192, v160, v161
v_cvt_pk_bf16_f32 v193, v162, v163
s_waitcnt lgkmcnt(4)
v_mfma_f32_16x16x32_bf16 v[176:179], v[220:223], a[112:115], 0
v_cvt_pk_bf16_f32 v194, v164, v165
s_add_u32 s72, s51, s55
v_mfma_f32_16x16x32_bf16 v[180:183], v[220:223], a[116:119], 0
v_cvt_pk_bf16_f32 v195, v166, v167
s_add_u32 s72, s72, 344064
v_mfma_f32_16x16x32_bf16 v[184:187], v[220:223], a[120:123], 0
v_cvt_pk_bf16_f32 v196, v168, v169
v_mfma_f32_16x16x32_bf16 v[188:191], v[220:223], a[124:127], 0
v_cvt_pk_bf16_f32 v197, v170, v171
s_waitcnt lgkmcnt(2)
v_mfma_f32_16x16x32_bf16 v[176:179], v[224:227], a[128:131], v[176:179]
v_cvt_pk_bf16_f32 v198, v172, v173
v_cvt_pk_bf16_f32 v199, v174, v175
v_mfma_f32_16x16x32_bf16 v[180:183], v[224:227], a[132:135], v[180:183]
buffer_load_dwordx4 v244, s[24:27], s73 offen offset:0 lds
ds_read_b64_tr_b16 v[208:209], v250 offset:12288
ds_read_b64_tr_b16 v[210:211], v250 offset:14336
v_mfma_f32_16x16x32_bf16 v[184:187], v[224:227], a[136:139], v[184:187]
ds_read_b64_tr_b16 v[212:213], v250 offset:16384
s_sub_u32 s94, s45, 3
s_add_u32 s98, s94, 7
s_cmp_lt_i32 s94, 0
s_cselect_b32 s94, s98, s94
s_lshl_b32 s94, s94, 14
s_add_u32 s94, s94, s68
s_sub_u32 s95, s45, 4
s_add_u32 s98, s95, 7
s_cmp_lt_i32 s95, 0
s_cselect_b32 s95, s98, s95
s_lshl_b32 s95, s95, 14
s_add_u32 s95, s95, s68
s_add_u32 s94, s94, 8192
s_add_u32 s95, s95, 8192
v_mfma_f32_16x16x32_bf16 v[188:191], v[224:227], a[140:143], v[188:191]
s_lshl_b32 s98, s44, 5
s_waitcnt lgkmcnt(3)
v_mfma_f32_16x16x32_bf16 v[176:179], v[204:207], a[144:147], v[176:179]
buffer_load_dwordx4 v245, s[24:27], s73 offen offset:1024 lds
v_mfma_f32_16x16x32_bf16 v[180:183], v[204:207], a[148:151], v[180:183]
ds_read_b64_tr_b16 v[214:215], v250 offset:18432
v_mfma_f32_16x16x32_bf16 v[184:187], v[204:207], a[152:155], v[184:187]
ds_read_b64_tr_b16 v[216:217], v250 offset:20480
v_mfma_f32_16x16x32_bf16 v[188:191], v[204:207], a[156:159], v[188:191]
ds_read_b64_tr_b16 v[218:219], v250 offset:22528
s_waitcnt lgkmcnt(3)
v_mfma_f32_16x16x32_bf16 v[176:179], v[208:211], a[160:163], v[176:179]
buffer_load_dwordx4 v246, s[24:27], s73 offen offset:2048 lds
v_mfma_f32_16x16x32_bf16 v[180:183], v[208:211], a[164:167], v[180:183]
ds_read_b64_tr_b16 v[220:221], v250 offset:24576
v_mfma_f32_16x16x32_bf16 v[184:187], v[208:211], a[168:171], v[184:187]
ds_read_b64_tr_b16 v[222:223], v250 offset:26624
v_mfma_f32_16x16x32_bf16 v[188:191], v[208:211], a[172:175], v[188:191]
ds_read_b64_tr_b16 v[224:225], v250 offset:28672
s_waitcnt lgkmcnt(5)
v_mfma_f32_16x16x32_bf16 v[176:179], v[212:215], a[176:179], v[176:179]
buffer_load_dwordx4 v247, s[24:27], s73 offen offset:3072 lds
v_mfma_f32_16x16x32_bf16 v[180:183], v[212:215], a[180:183], v[180:183]
s_add_u32 m0, s48, 114688
s_add_u32 s73, s51, s56
v_mfma_f32_16x16x32_bf16 v[184:187], v[212:215], a[184:187], v[184:187]
ds_read_b64_tr_b16 v[226:227], v250 offset:30720
v_mfma_f32_16x16x32_bf16 v[188:191], v[212:215], a[188:191], v[188:191]
s_waitcnt lgkmcnt(4)
v_mfma_f32_16x16x32_bf16 v[176:179], v[216:219], a[192:195], v[176:179]
buffer_load_dwordx4 v244, s[24:27], s74 offen offset:0 lds
v_mfma_f32_16x16x32_bf16 v[180:183], v[216:219], a[196:199], v[180:183]
v_mfma_f32_16x16x32_bf16 v[184:187], v[216:219], a[200:203], v[184:187]
v_mfma_f32_16x16x32_bf16 v[188:191], v[216:219], a[204:207], v[188:191]
s_waitcnt lgkmcnt(1)
v_mfma_f32_16x16x32_bf16 v[176:179], v[220:223], a[208:211], v[176:179]
buffer_load_dwordx4 v245, s[24:27], s74 offen offset:1024 lds
s_waitcnt lgkmcnt(0) vmcnt(6)
s_barrier
v_mfma_f32_16x16x32_bf16 v[180:183], v[220:223], a[212:215], v[180:183]
ds_read_b64_tr_b16 v[204:205], v249 offset:0
ds_read_b64_tr_b16 v[206:207], v249 offset:2048
v_mfma_f32_16x16x32_bf16 v[184:187], v[220:223], a[216:219], v[184:187]
ds_read_b64_tr_b16 v[208:209], v249 offset:4096
v_mfma_f32_16x16x32_bf16 v[188:191], v[220:223], a[220:223], v[188:191]
buffer_load_dwordx4 v246, s[24:27], s74 offen offset:2048 lds
v_mfma_f32_16x16x32_bf16 v[176:179], v[224:227], a[224:227], v[176:179]
ds_read_b64_tr_b16 v[210:211], v249 offset:6144
v_mfma_f32_16x16x32_bf16 v[180:183], v[224:227], a[228:231], v[180:183]
ds_read_b64_tr_b16 v[212:213], v249 offset:8192
v_mfma_f32_16x16x32_bf16 v[184:187], v[224:227], a[232:235], v[184:187]
ds_read_b64_tr_b16 v[214:215], v249 offset:10240
buffer_load_dwordx4 v247, s[24:27], s74 offen offset:3072 lds
v_mfma_f32_16x16x32_bf16 v[188:191], v[224:227], a[236:239], v[188:191]
s_add_u32 m0, s48, 0
s_add_u32 s74, s51, s56
s_add_u32 s74, s74, 114688
s_waitcnt lgkmcnt(4)
v_mfma_f32_16x16x32_bf16 v[176:179], v[204:207], a[240:243], v[176:179]
ds_read_b64_tr_b16 v[216:217], v249 offset:12288
v_mfma_f32_16x16x32_bf16 v[180:183], v[204:207], a[244:247], v[180:183]
ds_read_b64_tr_b16 v[218:219], v249 offset:14336
v_mfma_f32_16x16x32_bf16 v[184:187], v[204:207], a[248:251], v[184:187]
buffer_load_dwordx4 v244, s[24:27], s75 offen offset:0 lds
v_mfma_f32_16x16x32_bf16 v[188:191], v[204:207], a[252:255], v[188:191]
ds_read_b64_tr_b16 v[220:221], v249 offset:16384
s_waitcnt lgkmcnt(5)
v_mfma_f32_16x16x32_bf16 v[176:179], v[208:211], v[0:3], v[176:179]
ds_read_b64_tr_b16 v[222:223], v249 offset:18432
v_mfma_f32_16x16x32_bf16 v[180:183], v[208:211], v[4:7], v[180:183]
ds_read_b64_tr_b16 v[224:225], v249 offset:20480
v_mfma_f32_16x16x32_bf16 v[184:187], v[208:211], v[8:11], v[184:187]
buffer_load_dwordx4 v245, s[24:27], s75 offen offset:1024 lds
v_mfma_f32_16x16x32_bf16 v[188:191], v[208:211], v[12:15], v[188:191]
ds_read_b64_tr_b16 v[226:227], v249 offset:22528
s_waitcnt lgkmcnt(5)
v_mfma_f32_16x16x32_bf16 v[176:179], v[212:215], v[16:19], v[176:179]
v_dot2c_f32_bf16 v128, s92, v144
v_dot2c_f32_bf16 v129, s93, v144
v_dot2c_f32_bf16 v130, s92, v145
v_dot2c_f32_bf16 v131, s93, v145
v_dot2c_f32_bf16 v132, s92, v146
v_dot2c_f32_bf16 v133, s93, v146
v_dot2c_f32_bf16 v134, s92, v147
v_dot2c_f32_bf16 v135, s93, v147
v_dot2c_f32_bf16 v136, s92, v148
v_dot2c_f32_bf16 v137, s93, v148
v_dot2c_f32_bf16 v138, s92, v149
v_dot2c_f32_bf16 v139, s93, v149
v_dot2c_f32_bf16 v140, s92, v150
v_dot2c_f32_bf16 v141, s93, v150
v_dot2c_f32_bf16 v142, s92, v151
v_dot2c_f32_bf16 v143, s93, v151
buffer_load_dwordx4 v[144:147], v253, s[36:39], s94 offen offset:0 sc1
v_mfma_f32_16x16x32_bf16 v[180:183], v[212:215], v[20:23], v[180:183]
v_dot2c_f32_bf16 v128, s92, v152
v_dot2c_f32_bf16 v129, s93, v152
v_dot2c_f32_bf16 v130, s92, v153
v_dot2c_f32_bf16 v131, s93, v153
v_dot2c_f32_bf16 v132, s92, v154
v_dot2c_f32_bf16 v133, s93, v154
v_dot2c_f32_bf16 v134, s92, v155
v_dot2c_f32_bf16 v135, s93, v155
v_dot2c_f32_bf16 v136, s92, v156
v_dot2c_f32_bf16 v137, s93, v156
v_dot2c_f32_bf16 v138, s92, v157
v_dot2c_f32_bf16 v139, s93, v157
v_dot2c_f32_bf16 v140, s92, v158
v_dot2c_f32_bf16 v141, s93, v158
v_dot2c_f32_bf16 v142, s92, v159
v_dot2c_f32_bf16 v143, s93, v159
buffer_load_dwordx4 v[148:151], v253, s[36:39], s94 offen offset:1024 sc1
v_mfma_f32_16x16x32_bf16 v[184:187], v[212:215], v[24:27], v[184:187]
ds_read_b64_tr_b16 v[204:205], v249 offset:24576
v_mfma_f32_16x16x32_bf16 v[188:191], v[212:215], v[28:31], v[188:191]
ds_read_b64_tr_b16 v[206:207], v249 offset:26624
buffer_load_dwordx4 v[152:155], v253, s[36:39], s95 offen offset:0 sc1
s_waitcnt lgkmcnt(2)
v_mfma_f32_16x16x32_bf16 v[176:179], v[216:219], v[32:35], v[176:179]
ds_read_b64_tr_b16 v[208:209], v249 offset:28672
v_mfma_f32_16x16x32_bf16 v[180:183], v[216:219], v[36:39], v[180:183]
buffer_load_dwordx4 v[156:159], v253, s[36:39], s95 offen offset:1024 sc1
v_mfma_f32_16x16x32_bf16 v[184:187], v[216:219], v[40:43], v[184:187]
ds_read_b64_tr_b16 v[210:211], v249 offset:30720
v_mfma_f32_16x16x32_bf16 v[188:191], v[216:219], v[44:47], v[188:191]
v_mfma_f32_16x16x32_bf16 v[176:179], v[220:223], v[48:51], v[176:179]
v_mfma_f32_16x16x32_bf16 v[180:183], v[220:223], v[52:55], v[180:183]
buffer_load_dwordx4 v246, s[24:27], s75 offen offset:2048 lds
v_mfma_f32_16x16x32_bf16 v[184:187], v[220:223], v[56:59], v[184:187]
v_mfma_f32_16x16x32_bf16 v[188:191], v[220:223], v[60:63], v[188:191]
v_mfma_f32_16x16x32_bf16 v[176:179], v[224:227], v[64:67], v[176:179]
v_mfma_f32_16x16x32_bf16 v[180:183], v[224:227], v[68:71], v[180:183]
buffer_load_dwordx4 v247, s[24:27], s75 offen offset:3072 lds
v_mfma_f32_16x16x32_bf16 v[184:187], v[224:227], v[72:75], v[184:187]
s_add_u32 m0, s48, 16384
s_add_u32 s75, s51, s56
v_mfma_f32_16x16x32_bf16 v[188:191], v[224:227], v[76:79], v[188:191]
s_add_u32 s75, s75, 229376
s_waitcnt lgkmcnt(0)
v_mfma_f32_16x16x32_bf16 v[176:179], v[204:207], v[80:83], v[176:179]
s_waitcnt vmcnt(8)
s_barrier
v_mfma_f32_16x16x32_bf16 v[180:183], v[204:207], v[84:87], v[180:183]
buffer_load_dwordx4 v244, s[24:27], s76 offen offset:0 lds
ds_read_b64_tr_b16 v[212:213], v249 offset:32768
ds_read_b64_tr_b16 v[214:215], v249 offset:34816
v_mfma_f32_16x16x32_bf16 v[184:187], v[204:207], v[88:91], v[184:187]
ds_read_b64_tr_b16 v[216:217], v249 offset:36864
v_mfma_f32_16x16x32_bf16 v[188:191], v[204:207], v[92:95], v[188:191]
ds_read_b64_tr_b16 v[218:219], v249 offset:38912
v_mfma_f32_16x16x32_bf16 v[176:179], v[208:211], v[96:99], v[176:179]
buffer_load_dwordx4 v245, s[24:27], s76 offen offset:1024 lds
v_mfma_f32_16x16x32_bf16 v[180:183], v[208:211], v[100:103], v[180:183]
ds_read_b64_tr_b16 v[220:221], v249 offset:40960
v_mfma_f32_16x16x32_bf16 v[184:187], v[208:211], v[104:107], v[184:187]
ds_read_b64_tr_b16 v[222:223], v249 offset:43008
v_mfma_f32_16x16x32_bf16 v[188:191], v[208:211], v[108:111], v[188:191]
ds_read_b64_tr_b16 v[224:225], v249 offset:45056
buffer_load_dwordx4 v246, s[24:27], s76 offen offset:2048 lds
ds_read_b64_tr_b16 v[226:227], v249 offset:47104
s_waitcnt lgkmcnt(6)
v_mfma_f32_16x16x32_bf16 v[160:163], v[212:215], a[112:115], 0
ds_read_b64_tr_b16 v[204:205], v249 offset:49152
v_mfma_f32_16x16x32_bf16 v[164:167], v[212:215], a[116:119], 0
ds_read_b64_tr_b16 v[206:207], v249 offset:51200
v_mfma_f32_16x16x32_bf16 v[168:171], v[212:215], a[120:123], 0
ds_read_b64_tr_b16 v[208:209], v249 offset:53248
buffer_load_dwordx4 v247, s[24:27], s76 offen offset:3072 lds
v_mfma_f32_16x16x32_bf16 v[172:175], v[212:215], a[124:127], 0
s_add_u32 m0, s48, 32768
s_waitcnt lgkmcnt(7)
v_mfma_f32_16x16x32_bf16 v[160:163], v[216:219], a[128:131], v[160:163]
buffer_store_dwordx4 v[192:195], v253, s[36:39], s59 offen offset:0 sc1
v_mfma_f32_16x16x32_bf16 v[164:167], v[216:219], a[132:135], v[164:167]
s_add_u32 s76, s51, s56
v_cvt_pk_bf16_f32 v192, v176, v177
buffer_store_dwordx4 v[196:199], v253, s[36:39], s59 offen offset:1024 sc1
v_cvt_pk_bf16_f32 v193, v178, v179
v_cvt_pk_bf16_f32 v194, v180, v181
v_cvt_pk_bf16_f32 v195, v182, v183
v_cvt_pk_bf16_f32 v196, v184, v185
v_cvt_pk_bf16_f32 v197, v186, v187
buffer_store_dwordx4 v[228:231], v253, s[36:39], s100 offen offset:0 sc1
v_cvt_pk_bf16_f32 v198, v188, v189
v_cvt_pk_bf16_f32 v199, v190, v191
v_mfma_f32_16x16x32_bf16 v[168:171], v[216:219], a[136:139], v[168:171]
s_add_u32 s76, s76, 344064
ds_read_b64_tr_b16 v[210:211], v249 offset:55296
buffer_store_dwordx4 v[232:235], v253, s[36:39], s100 offen offset:1024 sc1
v_mfma_f32_16x16x32_bf16 v[172:175], v[216:219], a[140:143], v[172:175]
ds_read_b64_tr_b16 v[212:213], v249 offset:57344
s_add_u32 s100, s64, 8192
s_waitcnt lgkmcnt(2)
v_mfma_f32_16x16x32_bf16 v[160:163], v[220:223], a[144:147], v[160:163]
buffer_store_dwordx4 v[236:239], v253, s[36:39], s100 offen offset:0 sc1
v_mfma_f32_16x16x32_bf16 v[164:167], v[220:223], a[148:151], v[164:167]
ds_read_b64_tr_b16 v[214:215], v249 offset:59392
buffer_store_dwordx4 v[240:243], v253, s[36:39], s100 offen offset:1024 sc1
v_mfma_f32_16x16x32_bf16 v[168:171], v[220:223], a[152:155], v[168:171]
ds_read_b64_tr_b16 v[216:217], v249 offset:61440
v_mfma_f32_16x16x32_bf16 v[172:175], v[220:223], a[156:159], v[172:175]
ds_read_b64_tr_b16 v[218:219], v249 offset:63488
v_mfma_f32_16x16x32_bf16 v[160:163], v[224:227], a[160:163], v[160:163]
v_mfma_f32_16x16x32_bf16 v[164:167], v[224:227], a[164:167], v[164:167]
buffer_load_dwordx4 v244, s[24:27], s77 offen offset:0 lds
v_mfma_f32_16x16x32_bf16 v[168:171], v[224:227], a[168:171], v[168:171]
v_mfma_f32_16x16x32_bf16 v[172:175], v[224:227], a[172:175], v[172:175]
v_mfma_f32_16x16x32_bf16 v[160:163], v[204:207], a[176:179], v[160:163]
v_mfma_f32_16x16x32_bf16 v[164:167], v[204:207], a[180:183], v[164:167]
buffer_load_dwordx4 v245, s[24:27], s77 offen offset:1024 lds
v_mfma_f32_16x16x32_bf16 v[168:171], v[204:207], a[184:187], v[168:171]
v_mfma_f32_16x16x32_bf16 v[172:175], v[204:207], a[188:191], v[172:175]
s_waitcnt lgkmcnt(0)
v_mfma_f32_16x16x32_bf16 v[160:163], v[208:211], a[192:195], v[160:163]
v_mfma_f32_16x16x32_bf16 v[164:167], v[208:211], a[196:199], v[164:167]
buffer_load_dwordx4 v246, s[24:27], s77 offen offset:2048 lds
v_mfma_f32_16x16x32_bf16 v[168:171], v[208:211], a[200:203], v[168:171]
v_mfma_f32_16x16x32_bf16 v[172:175], v[208:211], a[204:207], v[172:175]
v_mfma_f32_16x16x32_bf16 v[160:163], v[212:215], a[208:211], v[160:163]
s_waitcnt vmcnt(9)
s_barrier
v_mfma_f32_16x16x32_bf16 v[164:167], v[212:215], a[212:215], v[164:167]
buffer_load_dwordx4 v247, s[24:27], s77 offen offset:3072 lds
ds_read_b64_tr_b16 v[220:221], v248 offset:0
ds_read_b64_tr_b16 v[222:223], v248 offset:2048
v_mfma_f32_16x16x32_bf16 v[168:171], v[212:215], a[216:219], v[168:171]
s_add_u32 m0, s48, 49152
s_add_u32 s77, s51, s57
v_mfma_f32_16x16x32_bf16 v[172:175], v[212:215], a[220:223], v[172:175]
ds_read_b64_tr_b16 v[224:225], v248 offset:4096
ds_read_b64_tr_b16 v[226:227], v248 offset:6144
v_mfma_f32_16x16x32_bf16 v[160:163], v[216:219], a[224:227], v[160:163]
buffer_load_dwordx4 v244, s[24:27], s70 offen offset:0 lds
v_mfma_f32_16x16x32_bf16 v[164:167], v[216:219], a[228:231], v[164:167]
ds_read_b64_tr_b16 v[204:205], v248 offset:8192
v_mfma_f32_16x16x32_bf16 v[168:171], v[216:219], a[232:235], v[168:171]
ds_read_b64_tr_b16 v[206:207], v248 offset:10240
v_mfma_f32_16x16x32_bf16 v[172:175], v[216:219], a[236:239], v[172:175]
ds_read_b64_tr_b16 v[208:209], v248 offset:12288
buffer_load_dwordx4 v245, s[24:27], s70 offen offset:1024 lds
s_waitcnt lgkmcnt(5)
v_mfma_f32_16x16x32_bf16 v[160:163], v[220:223], a[240:243], v[160:163]
ds_read_b64_tr_b16 v[210:211], v248 offset:14336
v_mfma_f32_16x16x32_bf16 v[164:167], v[220:223], a[244:247], v[164:167]
ds_read_b64_tr_b16 v[212:213], v248 offset:16384
v_mfma_f32_16x16x32_bf16 v[168:171], v[220:223], a[248:251], v[168:171]
ds_read_b64_tr_b16 v[214:215], v248 offset:18432
buffer_load_dwordx4 v246, s[24:27], s70 offen offset:2048 lds
v_mfma_f32_16x16x32_bf16 v[172:175], v[220:223], a[252:255], v[172:175]
ds_read_b64_tr_b16 v[216:217], v248 offset:20480
s_waitcnt lgkmcnt(7)
v_mfma_f32_16x16x32_bf16 v[160:163], v[224:227], v[0:3], v[160:163]
ds_read_b64_tr_b16 v[218:219], v248 offset:22528
v_mfma_f32_16x16x32_bf16 v[164:167], v[224:227], v[4:7], v[164:167]
ds_read_b64_tr_b16 v[220:221], v248 offset:24576
v_mfma_f32_16x16x32_bf16 v[168:171], v[224:227], v[8:11], v[168:171]
buffer_load_dwordx4 v247, s[24:27], s70 offen offset:3072 lds
v_mfma_f32_16x16x32_bf16 v[172:175], v[224:227], v[12:15], v[172:175]
s_add_u32 m0, s48, 131072
s_waitcnt lgkmcnt(5)
v_mfma_f32_16x16x32_bf16 v[160:163], v[204:207], v[16:19], v[160:163]
s_add_u32 s70, s51, s57
ds_read_b64_tr_b16 v[222:223], v248 offset:26624
v_mfma_f32_16x16x32_bf16 v[164:167], v[204:207], v[20:23], v[164:167]
s_add_u32 s70, s70, 114688
ds_read_b64_tr_b16 v[224:225], v248 offset:28672
v_mfma_f32_16x16x32_bf16 v[168:171], v[204:207], v[24:27], v[168:171]
buffer_load_dwordx4 v244, s[24:27], s71 offen offset:0 lds
v_mfma_f32_16x16x32_bf16 v[172:175], v[204:207], v[28:31], v[172:175]
ds_read_b64_tr_b16 v[226:227], v248 offset:30720
v_dot2c_f32_bf16 v128, s92, v144
v_mfma_f32_16x16x32_bf16 v[160:163], v[208:211], v[32:35], v[160:163]
v_dot2c_f32_bf16 v129, s93, v144
v_mfma_f32_16x16x32_bf16 v[164:167], v[208:211], v[36:39], v[164:167]
v_dot2c_f32_bf16 v128, s92, v152
v_mfma_f32_16x16x32_bf16 v[168:171], v[208:211], v[40:43], v[168:171]
buffer_load_dwordx4 v245, s[24:27], s71 offen offset:1024 lds
v_mfma_f32_16x16x32_bf16 v[172:175], v[208:211], v[44:47], v[172:175]
v_dot2c_f32_bf16 v129, s93, v152
s_waitcnt lgkmcnt(2)
v_mfma_f32_16x16x32_bf16 v[160:163], v[212:215], v[48:51], v[160:163]
v_lshrrev_b32 v152, 4, v255
v_mfma_f32_16x16x32_bf16 v[164:167], v[212:215], v[52:55], v[164:167]
v_lshlrev_b32 v152, 3, v152
v_mfma_f32_16x16x32_bf16 v[168:171], v[212:215], v[56:59], v[168:171]
buffer_load_dwordx4 v246, s[24:27], s71 offen offset:2048 lds
v_mfma_f32_16x16x32_bf16 v[172:175], v[212:215], v[60:63], v[172:175]
v_add_u32 v202, v202, v152
v_add_u32 v202, s98, v202
v_mfma_f32_16x16x32_bf16 v[160:163], v[216:219], v[64:67], v[160:163]
v_dot2c_f32_bf16 v130, s92, v145
v_mfma_f32_16x16x32_bf16 v[164:167], v[216:219], v[68:71], v[164:167]
v_dot2c_f32_bf16 v131, s93, v145
v_mfma_f32_16x16x32_bf16 v[168:171], v[216:219], v[72:75], v[168:171]
buffer_load_dwordx4 v247, s[24:27], s71 offen offset:3072 lds
v_mfma_f32_16x16x32_bf16 v[172:175], v[216:219], v[76:79], v[172:175]
s_add_u32 m0, s48, 147456
s_add_u32 s71, s51, s57
v_mfma_f32_16x16x32_bf16 v[160:163], v[220:223], v[80:83], v[160:163]
s_add_u32 s71, s71, 229376
v_dot2c_f32_bf16 v132, s92, v146
v_mfma_f32_16x16x32_bf16 v[164:167], v[220:223], v[84:87], v[164:167]
v_dot2c_f32_bf16 v133, s93, v146
v_mfma_f32_16x16x32_bf16 v[168:171], v[220:223], v[88:91], v[168:171]
buffer_load_dwordx4 v244, s[24:27], s72 offen offset:0 lds
v_mfma_f32_16x16x32_bf16 v[172:175], v[220:223], v[92:95], v[172:175]
v_dot2c_f32_bf16 v134, s92, v147
s_waitcnt lgkmcnt(0)
v_mfma_f32_16x16x32_bf16 v[160:163], v[224:227], v[96:99], v[160:163]
v_dot2c_f32_bf16 v135, s93, v147
v_mfma_f32_16x16x32_bf16 v[164:167], v[224:227], v[100:103], v[164:167]
v_dot2c_f32_bf16 v136, s92, v148
buffer_load_dwordx4 v245, s[24:27], s72 offen offset:1024 lds
v_mfma_f32_16x16x32_bf16 v[168:171], v[224:227], v[104:107], v[168:171]
v_dot2c_f32_bf16 v137, s93, v148
s_waitcnt vmcnt(6)
s_barrier
ds_read_b64_tr_b16 v[204:205], v248 offset:32768
ds_read_b64_tr_b16 v[206:207], v248 offset:34816
ds_read_b64_tr_b16 v[208:209], v248 offset:36864
ds_read_b64_tr_b16 v[210:211], v248 offset:38912
buffer_load_dwordx4 v246, s[24:27], s72 offen offset:2048 lds
v_mfma_f32_16x16x32_bf16 v[172:175], v[224:227], v[108:111], v[172:175]
ds_read_b64_tr_b16 v[212:213], v248 offset:40960
ds_read_b64_tr_b16 v[214:215], v248 offset:43008
ds_read_b64_tr_b16 v[216:217], v248 offset:45056
ds_read_b64_tr_b16 v[218:219], v248 offset:47104
ds_read_b64_tr_b16 v[220:221], v248 offset:49152
ds_read_b64_tr_b16 v[222:223], v248 offset:51200
buffer_load_dwordx4 v247, s[24:27], s72 offen offset:3072 lds
s_add_u32 m0, s48, 65536
s_add_u32 s72, s51, s57
s_add_u32 s72, s72, 344064
ds_read_b64_tr_b16 v[224:225], v248 offset:53248
ds_read_b64_tr_b16 v[226:227], v248 offset:55296
v_dot2c_f32_bf16 v138, s92, v149
s_waitcnt lgkmcnt(10)
v_mfma_f32_16x16x32_bf16 v[176:179], v[204:207], a[112:115], 0
v_dot2c_f32_bf16 v139, s93, v149
v_mfma_f32_16x16x32_bf16 v[180:183], v[204:207], a[116:119], 0
buffer_load_dwordx4 v244, s[24:27], s73 offen offset:0 lds
v_mfma_f32_16x16x32_bf16 v[184:187], v[204:207], a[120:123], 0
v_dot2c_f32_bf16 v140, s92, v150
v_dot2c_f32_bf16 v141, s93, v150
v_mfma_f32_16x16x32_bf16 v[188:191], v[204:207], a[124:127], 0
ds_read_b64_tr_b16 v[204:205], v248 offset:57344
s_waitcnt lgkmcnt(5)
v_mfma_f32_16x16x32_bf16 v[176:179], v[208:211], a[128:131], v[176:179]
ds_read_b64_tr_b16 v[206:207], v248 offset:59392
v_dot2c_f32_bf16 v142, s92, v151
v_mfma_f32_16x16x32_bf16 v[180:183], v[208:211], a[132:135], v[180:183]
buffer_load_dwordx4 v245, s[24:27], s73 offen offset:1024 lds
v_mfma_f32_16x16x32_bf16 v[184:187], v[208:211], a[136:139], v[184:187]
v_dot2c_f32_bf16 v143, s93, v151
v_dot2c_f32_bf16 v130, s92, v153
v_mfma_f32_16x16x32_bf16 v[188:191], v[208:211], a[140:143], v[188:191]
ds_read_b64_tr_b16 v[208:209], v248 offset:61440
v_dot2c_f32_bf16 v131, s93, v153
v_mfma_f32_16x16x32_bf16 v[176:179], v[212:215], a[144:147], v[176:179]
ds_read_b64_tr_b16 v[210:211], v248 offset:63488
v_dot2c_f32_bf16 v132, s92, v154
v_mfma_f32_16x16x32_bf16 v[180:183], v[212:215], a[148:151], v[180:183]
buffer_load_dwordx4 v246, s[24:27], s73 offen offset:2048 lds
v_mfma_f32_16x16x32_bf16 v[184:187], v[212:215], a[152:155], v[184:187]
v_dot2c_f32_bf16 v133, s93, v154
v_dot2c_f32_bf16 v134, s92, v155
v_mfma_f32_16x16x32_bf16 v[188:191], v[212:215], a[156:159], v[188:191]
v_dot2c_f32_bf16 v135, s93, v155
v_mfma_f32_16x16x32_bf16 v[176:179], v[216:219], a[160:163], v[176:179]
v_dot2c_f32_bf16 v136, s92, v156
v_mfma_f32_16x16x32_bf16 v[180:183], v[216:219], a[164:167], v[180:183]
buffer_load_dwordx4 v247, s[24:27], s73 offen offset:3072 lds
v_mfma_f32_16x16x32_bf16 v[184:187], v[216:219], a[168:171], v[184:187]
s_add_u32 m0, s48, 81920
s_add_u32 s73, s51, s58
v_mfma_f32_16x16x32_bf16 v[188:191], v[216:219], a[172:175], v[188:191]
v_dot2c_f32_bf16 v137, s93, v156
s_waitcnt lgkmcnt(0)
v_mfma_f32_16x16x32_bf16 v[176:179], v[220:223], a[176:179], v[176:179]
v_dot2c_f32_bf16 v138, s92, v157
v_mfma_f32_16x16x32_bf16 v[180:183], v[220:223], a[180:183], v[180:183]
buffer_load_dwordx4 v244, s[24:27], s74 offen offset:0 lds
v_mfma_f32_16x16x32_bf16 v[184:187], v[220:223], a[184:187], v[184:187]
v_dot2c_f32_bf16 v139, s93, v157
v_dot2c_f32_bf16 v140, s92, v158
v_mfma_f32_16x16x32_bf16 v[188:191], v[220:223], a[188:191], v[188:191]
v_dot2c_f32_bf16 v141, s93, v158
v_mfma_f32_16x16x32_bf16 v[176:179], v[224:227], a[192:195], v[176:179]
v_dot2c_f32_bf16 v142, s92, v159
v_mfma_f32_16x16x32_bf16 v[180:183], v[224:227], a[196:199], v[180:183]
buffer_load_dwordx4 v245, s[24:27], s74 offen offset:1024 lds
v_mfma_f32_16x16x32_bf16 v[184:187], v[224:227], a[200:203], v[184:187]
s_waitcnt vmcnt(6)
s_barrier
v_mfma_f32_16x16x32_bf16 v[188:191], v[224:227], a[204:207], v[188:191]
ds_read_b64_tr_b16 v[212:213], v250 offset:0
v_dot2c_f32_bf16 v143, s93, v159
v_mfma_f32_16x16x32_bf16 v[176:179], v[204:207], a[208:211], v[176:179]
buffer_load_dwordx4 v246, s[24:27], s74 offen offset:2048 lds
v_mfma_f32_16x16x32_bf16 v[180:183], v[204:207], a[212:215], v[180:183]
ds_read_b64_tr_b16 v[214:215], v250 offset:2048
v_mfma_f32_16x16x32_bf16 v[184:187], v[204:207], a[216:219], v[184:187]
ds_read_b64_tr_b16 v[216:217], v250 offset:4096
v_mfma_f32_16x16x32_bf16 v[188:191], v[204:207], a[220:223], v[188:191]
ds_read_b64_tr_b16 v[218:219], v250 offset:6144
v_mfma_f32_16x16x32_bf16 v[176:179], v[208:211], a[224:227], v[176:179]
buffer_load_dwordx4 v247, s[24:27], s74 offen offset:3072 lds
v_mfma_f32_16x16x32_bf16 v[180:183], v[208:211], a[228:231], v[180:183]
s_add_u32 m0, s48, 98304
s_add_u32 s74, s51, s58
buffer_store_dwordx4 v[192:195], v253, s[36:39], s60 offen offset:0 sc1
v_mfma_f32_16x16x32_bf16 v[184:187], v[208:211], a[232:235], v[184:187]
s_add_u32 s74, s74, 114688
v_cvt_pk_bf16_f32 v192, v160, v161
v_cvt_pk_bf16_f32 v193, v162, v163
buffer_store_dwordx4 v[196:199], v253, s[36:39], s60 offen offset:1024 sc1
v_cvt_pk_bf16_f32 v194, v164, v165
v_cvt_pk_bf16_f32 v195, v166, v167
v_cvt_pk_bf16_f32 v196, v168, v169
v_cvt_pk_bf16_f32 v197, v170, v171
v_cvt_pk_bf16_f32 v198, v172, v173
v_cvt_pk_bf16_f32 v199, v174, v175
v_mfma_f32_16x16x32_bf16 v[188:191], v[208:211], a[236:239], v[188:191]
ds_read_b64_tr_b16 v[220:221], v250 offset:8192
s_waitcnt lgkmcnt(2)
v_mfma_f32_16x16x32_bf16 v[176:179], v[212:215], a[240:243], v[176:179]
ds_read_b64_tr_b16 v[222:223], v250 offset:10240
v_mfma_f32_16x16x32_bf16 v[180:183], v[212:215], a[244:247], v[180:183]
buffer_load_dwordx4 v244, s[24:27], s75 offen offset:0 lds
v_mfma_f32_16x16x32_bf16 v[184:187], v[212:215], a[248:251], v[184:187]
ds_read_b64_tr_b16 v[224:225], v250 offset:12288
v_mfma_f32_16x16x32_bf16 v[188:191], v[212:215], a[252:255], v[188:191]
ds_read_b64_tr_b16 v[226:227], v250 offset:14336
s_waitcnt lgkmcnt(4)
v_mfma_f32_16x16x32_bf16 v[176:179], v[216:219], v[0:3], v[176:179]
ds_read_b64_tr_b16 v[204:205], v250 offset:16384
v_mfma_f32_16x16x32_bf16 v[180:183], v[216:219], v[4:7], v[180:183]
buffer_load_dwordx4 v245, s[24:27], s75 offen offset:1024 lds
v_mfma_f32_16x16x32_bf16 v[184:187], v[216:219], v[8:11], v[184:187]
ds_read_b64_tr_b16 v[206:207], v250 offset:18432
v_mfma_f32_16x16x32_bf16 v[188:191], v[216:219], v[12:15], v[188:191]
ds_read_b64_tr_b16 v[208:209], v250 offset:20480
s_waitcnt lgkmcnt(5)
v_mfma_f32_16x16x32_bf16 v[176:179], v[220:223], v[16:19], v[176:179]
s_lshl_b32 s3, s52, 1
s_add_u32 s3, s3, s66
s_mov_b64 exec, 1
buffer_store_dword v200, off, s[36:39], s3 offset:0 sc1
s_mov_b64 exec, -1
v_mfma_f32_16x16x32_bf16 v[180:183], v[220:223], v[20:23], v[180:183]
ds_read_b64_tr_b16 v[210:211], v250 offset:22528
v_mfma_f32_16x16x32_bf16 v[184:187], v[220:223], v[24:27], v[184:187]
ds_read_b64_tr_b16 v[212:213], v250 offset:24576
s_lshl_b32 s3, s56, 1
s_add_u32 s3, s3, s66
s_mov_b64 exec, 1
buffer_store_dword v200, off, s[36:39], s3 offset:128 sc1
s_mov_b64 exec, -1
v_mfma_f32_16x16x32_bf16 v[188:191], v[220:223], v[28:31], v[188:191]
ds_read_b64_tr_b16 v[214:215], v250 offset:26624
s_waitcnt lgkmcnt(5)
v_mfma_f32_16x16x32_bf16 v[176:179], v[224:227], v[32:35], v[176:179]
ds_read_b64_tr_b16 v[216:217], v250 offset:28672
v_mfma_f32_16x16x32_bf16 v[180:183], v[224:227], v[36:39], v[180:183]
buffer_load_dwordx4 v246, s[24:27], s75 offen offset:2048 lds
v_mfma_f32_16x16x32_bf16 v[184:187], v[224:227], v[40:43], v[184:187]
s_lshl_b32 s3, s57, 1
s_add_u32 s3, s3, s66
s_mov_b64 exec, 1
buffer_store_dword v200, off, s[36:39], s3 offset:128 sc1
s_mov_b64 exec, -1
v_mfma_f32_16x16x32_bf16 v[188:191], v[224:227], v[44:47], v[188:191]
ds_read_b64_tr_b16 v[218:219], v250 offset:30720
s_waitcnt lgkmcnt(3)
v_mfma_f32_16x16x32_bf16 v[176:179], v[204:207], v[48:51], v[176:179]
v_mfma_f32_16x16x32_bf16 v[180:183], v[204:207], v[52:55], v[180:183]
buffer_load_dwordx4 v247, s[24:27], s75 offen offset:3072 lds
v_mfma_f32_16x16x32_bf16 v[184:187], v[204:207], v[56:59], v[184:187]
s_add_u32 m0, s48, 114688
s_add_u32 s75, s51, s58
v_mfma_f32_16x16x32_bf16 v[188:191], v[204:207], v[60:63], v[188:191]
s_add_u32 s75, s75, 229376
v_mfma_f32_16x16x32_bf16 v[176:179], v[208:211], v[64:67], v[176:179]
v_mfma_f32_16x16x32_bf16 v[180:183], v[208:211], v[68:71], v[180:183]
buffer_load_dwordx4 v244, s[24:27], s76 offen offset:0 lds
v_mfma_f32_16x16x32_bf16 v[184:187], v[208:211], v[72:75], v[184:187]
s_waitcnt lgkmcnt(0) vmcnt(10)
s_barrier
v_mfma_f32_16x16x32_bf16 v[188:191], v[208:211], v[76:79], v[188:191]
ds_read_b64_tr_b16 v[220:221], v249 offset:0
ds_read_b64_tr_b16 v[222:223], v249 offset:2048
v_mfma_f32_16x16x32_bf16 v[176:179], v[212:215], v[80:83], v[176:179]
buffer_load_dwordx4 v245, s[24:27], s76 offen offset:1024 lds
v_mfma_f32_16x16x32_bf16 v[180:183], v[212:215], v[84:87], v[180:183]
ds_read_b64_tr_b16 v[224:225], v249 offset:4096
v_mfma_f32_16x16x32_bf16 v[184:187], v[212:215], v[88:91], v[184:187]
ds_read_b64_tr_b16 v[226:227], v249 offset:6144
v_mfma_f32_16x16x32_bf16 v[188:191], v[212:215], v[92:95], v[188:191]
ds_read_b64_tr_b16 v[204:205], v249 offset:8192
v_mfma_f32_16x16x32_bf16 v[176:179], v[216:219], v[96:99], v[176:179]
buffer_load_dwordx4 v246, s[24:27], s76 offen offset:2048 lds
v_mfma_f32_16x16x32_bf16 v[180:183], v[216:219], v[100:103], v[180:183]
ds_read_b64_tr_b16 v[206:207], v249 offset:10240
v_mfma_f32_16x16x32_bf16 v[184:187], v[216:219], v[104:107], v[184:187]
ds_read_b64_tr_b16 v[208:209], v249 offset:12288
v_mfma_f32_16x16x32_bf16 v[188:191], v[216:219], v[108:111], v[188:191]
ds_read_b64_tr_b16 v[210:211], v249 offset:14336
buffer_load_dwordx4 v247, s[24:27], s76 offen offset:3072 lds
s_waitcnt lgkmcnt(6)
v_mfma_f32_16x16x32_bf16 v[160:163], v[220:223], a[112:115], 0
s_add_u32 m0, s48, 0
s_add_u32 s76, s51, s58
v_mfma_f32_16x16x32_bf16 v[164:167], v[220:223], a[116:119], 0
s_add_u32 s76, s76, 344064
ds_read_b64_tr_b16 v[212:213], v249 offset:16384
v_mfma_f32_16x16x32_bf16 v[168:171], v[220:223], a[120:123], 0
ds_read_b64_tr_b16 v[214:215], v249 offset:18432
v_mfma_f32_16x16x32_bf16 v[172:175], v[220:223], a[124:127], 0
ds_read_b64_tr_b16 v[216:217], v249 offset:20480
s_waitcnt lgkmcnt(6)
v_mfma_f32_16x16x32_bf16 v[160:163], v[224:227], a[128:131], v[160:163]
buffer_load_dwordx4 v244, s[24:27], s77 offen offset:0 lds
v_mfma_f32_16x16x32_bf16 v[164:167], v[224:227], a[132:135], v[164:167]
ds_read_b64_tr_b16 v[218:219], v249 offset:22528
v_mfma_f32_16x16x32_bf16 v[168:171], v[224:227], a[136:139], v[168:171]
ds_read_b64_tr_b16 v[220:221], v249 offset:24576
v_mfma_f32_16x16x32_bf16 v[172:175], v[224:227], a[140:143], v[172:175]
ds_read_b64_tr_b16 v[222:223], v249 offset:26624
s_waitcnt lgkmcnt(6)
v_mfma_f32_16x16x32_bf16 v[160:163], v[204:207], a[144:147], v[160:163]
buffer_load_dwordx4 v245, s[24:27], s77 offen offset:1024 lds
v_mfma_f32_16x16x32_bf16 v[164:167], v[204:207], a[148:151], v[164:167]
ds_read_b64_tr_b16 v[224:225], v249 offset:28672
v_mfma_f32_16x16x32_bf16 v[168:171], v[204:207], a[152:155], v[168:171]
ds_read_b64_tr_b16 v[226:227], v249 offset:30720
v_mfma_f32_16x16x32_bf16 v[172:175], v[204:207], a[156:159], v[172:175]
v_mfma_f32_16x16x32_bf16 v[160:163], v[208:211], a[160:163], v[160:163]
buffer_load_dwordx4 v246, s[24:27], s77 offen offset:2048 lds
v_mfma_f32_16x16x32_bf16 v[164:167], v[208:211], a[164:167], v[164:167]
v_mfma_f32_16x16x32_bf16 v[168:171], v[208:211], a[168:171], v[168:171]
v_mfma_f32_16x16x32_bf16 v[172:175], v[208:211], a[172:175], v[172:175]
s_waitcnt lgkmcnt(2)
v_mfma_f32_16x16x32_bf16 v[160:163], v[212:215], a[176:179], v[160:163]
buffer_load_dwordx4 v247, s[24:27], s77 offen offset:3072 lds
v_mfma_f32_16x16x32_bf16 v[164:167], v[212:215], a[180:183], v[164:167]
s_add_u32 m0, s48, 16384
s_lshl_b32 s77, s45, 7
v_mfma_f32_16x16x32_bf16 v[168:171], v[212:215], a[184:187], v[168:171]
v_mfma_f32_16x16x32_bf16 v[172:175], v[212:215], a[188:191], v[172:175]
v_mfma_f32_16x16x32_bf16 v[160:163], v[216:219], a[192:195], v[160:163]
buffer_load_dwordx4 v244, s[24:27], s70 offen offset:0 lds
v_mfma_f32_16x16x32_bf16 v[164:167], v[216:219], a[196:199], v[164:167]
v_mfma_f32_16x16x32_bf16 v[168:171], v[216:219], a[200:203], v[168:171]
v_mfma_f32_16x16x32_bf16 v[172:175], v[216:219], a[204:207], v[172:175]
v_mfma_f32_16x16x32_bf16 v[160:163], v[220:223], a[208:211], v[160:163]
buffer_load_dwordx4 v245, s[24:27], s70 offen offset:1024 lds
s_waitcnt lgkmcnt(0) vmcnt(6)
s_barrier
v_mfma_f32_16x16x32_bf16 v[164:167], v[220:223], a[212:215], v[164:167]
ds_read_b64_tr_b16 v[204:205], v249 offset:32768
ds_read_b64_tr_b16 v[206:207], v249 offset:34816
v_mfma_f32_16x16x32_bf16 v[168:171], v[220:223], a[216:219], v[168:171]
ds_read_b64_tr_b16 v[208:209], v249 offset:36864
v_mfma_f32_16x16x32_bf16 v[172:175], v[220:223], a[220:223], v[172:175]
buffer_load_dwordx4 v246, s[24:27], s70 offen offset:2048 lds
v_mfma_f32_16x16x32_bf16 v[160:163], v[224:227], a[224:227], v[160:163]
ds_read_b64_tr_b16 v[210:211], v249 offset:38912
v_mfma_f32_16x16x32_bf16 v[164:167], v[224:227], a[228:231], v[164:167]
ds_read_b64_tr_b16 v[212:213], v249 offset:40960
v_mfma_f32_16x16x32_bf16 v[168:171], v[224:227], a[232:235], v[168:171]
ds_read_b64_tr_b16 v[214:215], v249 offset:43008
buffer_load_dwordx4 v247, s[24:27], s70 offen offset:3072 lds
v_mfma_f32_16x16x32_bf16 v[172:175], v[224:227], a[236:239], v[172:175]
s_add_u32 m0, s48, 32768
s_lshl_b32 s70, s45, 7
s_add_u32 s70, s70, 14336
buffer_store_dwordx4 v[192:195], v253, s[36:39], s61 offen offset:0 sc1
s_waitcnt lgkmcnt(4)
v_mfma_f32_16x16x32_bf16 v[160:163], v[204:207], a[240:243], v[160:163]
v_cvt_pk_bf16_f32 v192, v176, v177
v_cvt_pk_bf16_f32 v193, v178, v179
buffer_store_dwordx4 v[196:199], v253, s[36:39], s61 offen offset:1024 sc1
v_cvt_pk_bf16_f32 v194, v180, v181
v_cvt_pk_bf16_f32 v195, v182, v183
v_cvt_pk_bf16_f32 v196, v184, v185
v_cvt_pk_bf16_f32 v197, v186, v187
v_cvt_pk_bf16_f32 v198, v188, v189
v_cvt_pk_bf16_f32 v199, v190, v191
v_mfma_f32_16x16x32_bf16 v[164:167], v[204:207], a[244:247], v[164:167]
ds_read_b64_tr_b16 v[216:217], v249 offset:45056
v_mfma_f32_16x16x32_bf16 v[168:171], v[204:207], a[248:251], v[168:171]
ds_read_b64_tr_b16 v[218:219], v249 offset:47104
v_mfma_f32_16x16x32_bf16 v[172:175], v[204:207], a[252:255], v[172:175]
ds_read_b64_tr_b16 v[220:221], v249 offset:49152
s_waitcnt lgkmcnt(3)
v_mfma_f32_16x16x32_bf16 v[160:163], v[208:211], v[0:3], v[160:163]
buffer_load_dwordx4 v244, s[24:27], s71 offen offset:0 lds
v_mfma_f32_16x16x32_bf16 v[164:167], v[208:211], v[4:7], v[164:167]
ds_read_b64_tr_b16 v[222:223], v249 offset:51200
v_mfma_f32_16x16x32_bf16 v[168:171], v[208:211], v[8:11], v[168:171]
ds_read_b64_tr_b16 v[224:225], v249 offset:53248
v_mfma_f32_16x16x32_bf16 v[172:175], v[208:211], v[12:15], v[172:175]
ds_read_b64_tr_b16 v[226:227], v249 offset:55296
v_mfma_f32_16x16x32_bf16 v[160:163], v[212:215], v[16:19], v[160:163]
buffer_load_dwordx4 v245, s[24:27], s71 offen offset:1024 lds
v_mfma_f32_16x16x32_bf16 v[164:167], v[212:215], v[20:23], v[164:167]
ds_read_b64_tr_b16 v[204:205], v249 offset:57344
v_mfma_f32_16x16x32_bf16 v[168:171], v[212:215], v[24:27], v[168:171]
ds_read_b64_tr_b16 v[206:207], v249 offset:59392
v_mfma_f32_16x16x32_bf16 v[172:175], v[212:215], v[28:31], v[172:175]
ds_read_b64_tr_b16 v[208:209], v249 offset:61440
s_waitcnt lgkmcnt(6)
v_mfma_f32_16x16x32_bf16 v[160:163], v[216:219], v[32:35], v[160:163]
buffer_load_dwordx4 v246, s[24:27], s71 offen offset:2048 lds
v_mfma_f32_16x16x32_bf16 v[164:167], v[216:219], v[36:39], v[164:167]
ds_read_b64_tr_b16 v[210:211], v249 offset:63488
v_mfma_f32_16x16x32_bf16 v[168:171], v[216:219], v[40:43], v[168:171]
v_mfma_f32_16x16x32_bf16 v[172:175], v[216:219], v[44:47], v[172:175]
s_waitcnt lgkmcnt(4)
v_mfma_f32_16x16x32_bf16 v[160:163], v[220:223], v[48:51], v[160:163]
buffer_load_dwordx4 v247, s[24:27], s71 offen offset:3072 lds
v_mfma_f32_16x16x32_bf16 v[164:167], v[220:223], v[52:55], v[164:167]
s_add_u32 m0, s48, 49152
s_lshl_b32 s71, s45, 7
v_mfma_f32_16x16x32_bf16 v[168:171], v[220:223], v[56:59], v[168:171]
s_add_u32 s71, s71, 28672
v_mfma_f32_16x16x32_bf16 v[172:175], v[220:223], v[60:63], v[172:175]
v_mfma_f32_16x16x32_bf16 v[160:163], v[224:227], v[64:67], v[160:163]
buffer_load_dwordx4 v244, s[24:27], s72 offen offset:0 lds
v_mfma_f32_16x16x32_bf16 v[164:167], v[224:227], v[68:71], v[164:167]
s_waitcnt lgkmcnt(0) vmcnt(7)
s_barrier
v_mfma_f32_16x16x32_bf16 v[168:171], v[224:227], v[72:75], v[168:171]
ds_read_b64_tr_b16 v[212:213], v248 offset:0
v_mfma_f32_16x16x32_bf16 v[172:175], v[224:227], v[76:79], v[172:175]
buffer_load_dwordx4 v245, s[24:27], s72 offen offset:1024 lds
v_mfma_f32_16x16x32_bf16 v[160:163], v[204:207], v[80:83], v[160:163]
ds_read_b64_tr_b16 v[214:215], v248 offset:2048
v_mfma_f32_16x16x32_bf16 v[164:167], v[204:207], v[84:87], v[164:167]
ds_read_b64_tr_b16 v[216:217], v248 offset:4096
v_mfma_f32_16x16x32_bf16 v[168:171], v[204:207], v[88:91], v[168:171]
ds_read_b64_tr_b16 v[218:219], v248 offset:6144
v_mfma_f32_16x16x32_bf16 v[172:175], v[204:207], v[92:95], v[172:175]
buffer_load_dwordx4 v246, s[24:27], s72 offen offset:2048 lds
v_mfma_f32_16x16x32_bf16 v[160:163], v[208:211], v[96:99], v[160:163]
ds_read_b64_tr_b16 v[220:221], v248 offset:8192
v_mfma_f32_16x16x32_bf16 v[164:167], v[208:211], v[100:103], v[164:167]
ds_read_b64_tr_b16 v[222:223], v248 offset:10240
v_mfma_f32_16x16x32_bf16 v[168:171], v[208:211], v[104:107], v[168:171]
ds_read_b64_tr_b16 v[224:225], v248 offset:12288
buffer_load_dwordx4 v247, s[24:27], s72 offen offset:3072 lds
v_mfma_f32_16x16x32_bf16 v[172:175], v[208:211], v[108:111], v[172:175]
s_add_u32 m0, s48, 131072
s_waitcnt lgkmcnt(5)
v_mfma_f32_16x16x32_bf16 v[176:179], v[212:215], a[112:115], 0
s_lshl_b32 s72, s45, 7
ds_read_b64_tr_b16 v[226:227], v248 offset:14336
v_mfma_f32_16x16x32_bf16 v[180:183], v[212:215], a[116:119], 0
s_add_u32 s72, s72, 43008
ds_read_b64_tr_b16 v[204:205], v248 offset:16384
v_mfma_f32_16x16x32_bf16 v[184:187], v[212:215], a[120:123], 0
buffer_load_dwordx4 v244, s[24:27], s73 offen offset:0 lds
v_mfma_f32_16x16x32_bf16 v[188:191], v[212:215], a[124:127], 0
ds_read_b64_tr_b16 v[206:207], v248 offset:18432
s_waitcnt lgkmcnt(5)
v_mfma_f32_16x16x32_bf16 v[176:179], v[216:219], a[128:131], v[176:179]
ds_read_b64_tr_b16 v[208:209], v248 offset:20480
v_mfma_f32_16x16x32_bf16 v[180:183], v[216:219], a[132:135], v[180:183]
ds_read_b64_tr_b16 v[210:211], v248 offset:22528
v_mfma_f32_16x16x32_bf16 v[184:187], v[216:219], a[136:139], v[184:187]
buffer_load_dwordx4 v245, s[24:27], s73 offen offset:1024 lds
v_mfma_f32_16x16x32_bf16 v[188:191], v[216:219], a[140:143], v[188:191]
ds_read_b64_tr_b16 v[212:213], v248 offset:24576
s_lshl_b32 s3, s53, 1
s_add_u32 s3, s3, s66
s_mov_b64 exec, 1
buffer_store_dword v200, off, s[36:39], s3 offset:0 sc1
s_mov_b64 exec, -1
s_waitcnt lgkmcnt(4)
v_mfma_f32_16x16x32_bf16 v[176:179], v[220:223], a[144:147], v[176:179]
ds_read_b64_tr_b16 v[214:215], v248 offset:26624
v_mfma_f32_16x16x32_bf16 v[180:183], v[220:223], a[148:151], v[180:183]
ds_read_b64_tr_b16 v[216:217], v248 offset:28672
v_mfma_f32_16x16x32_bf16 v[184:187], v[220:223], a[152:155], v[184:187]
buffer_load_dwordx4 v246, s[24:27], s73 offen offset:2048 lds
v_mfma_f32_16x16x32_bf16 v[188:191], v[220:223], a[156:159], v[188:191]
ds_read_b64_tr_b16 v[218:219], v248 offset:30720
v_mfma_f32_16x16x32_bf16 v[176:179], v[224:227], a[160:163], v[176:179]
v_mfma_f32_16x16x32_bf16 v[180:183], v[224:227], a[164:167], v[180:183]
v_mfma_f32_16x16x32_bf16 v[184:187], v[224:227], a[168:171], v[184:187]
buffer_load_dwordx4 v247, s[24:27], s73 offen offset:3072 lds
v_mfma_f32_16x16x32_bf16 v[188:191], v[224:227], a[172:175], v[188:191]
s_add_u32 m0, s48, 147456
s_waitcnt lgkmcnt(2)
v_mfma_f32_16x16x32_bf16 v[176:179], v[204:207], a[176:179], v[176:179]
v_mfma_f32_16x16x32_bf16 v[180:183], v[204:207], a[180:183], v[180:183]
v_mfma_f32_16x16x32_bf16 v[184:187], v[204:207], a[184:187], v[184:187]
buffer_load_dwordx4 v244, s[24:27], s74 offen offset:0 lds
v_mfma_f32_16x16x32_bf16 v[188:191], v[204:207], a[188:191], v[188:191]
v_mfma_f32_16x16x32_bf16 v[176:179], v[208:211], a[192:195], v[176:179]
v_mfma_f32_16x16x32_bf16 v[180:183], v[208:211], a[196:199], v[180:183]
v_mfma_f32_16x16x32_bf16 v[184:187], v[208:211], a[200:203], v[184:187]
buffer_load_dwordx4 v245, s[24:27], s74 offen offset:1024 lds
v_mfma_f32_16x16x32_bf16 v[188:191], v[208:211], a[204:207], v[188:191]
s_waitcnt lgkmcnt(0) vmcnt(7)
s_barrier
v_mfma_f32_16x16x32_bf16 v[176:179], v[212:215], a[208:211], v[176:179]
ds_read_b64_tr_b16 v[220:221], v248 offset:32768
ds_read_b64_tr_b16 v[222:223], v248 offset:34816
v_mfma_f32_16x16x32_bf16 v[180:183], v[212:215], a[212:215], v[180:183]
buffer_load_dwordx4 v246, s[24:27], s74 offen offset:2048 lds
v_mfma_f32_16x16x32_bf16 v[184:187], v[212:215], a[216:219], v[184:187]
ds_read_b64_tr_b16 v[224:225], v248 offset:36864
v_mfma_f32_16x16x32_bf16 v[188:191], v[212:215], a[220:223], v[188:191]
ds_read_b64_tr_b16 v[226:227], v248 offset:38912
v_mfma_f32_16x16x32_bf16 v[176:179], v[216:219], a[224:227], v[176:179]
ds_read_b64_tr_b16 v[204:205], v248 offset:40960
v_mfma_f32_16x16x32_bf16 v[180:183], v[216:219], a[228:231], v[180:183]
buffer_load_dwordx4 v247, s[24:27], s74 offen offset:3072 lds
v_mfma_f32_16x16x32_bf16 v[184:187], v[216:219], a[232:235], v[184:187]
s_add_u32 m0, s48, 65536
ds_read_b64_tr_b16 v[206:207], v248 offset:43008
buffer_store_dwordx4 v[192:195], v253, s[36:39], s62 offen offset:0 sc1
v_mfma_f32_16x16x32_bf16 v[188:191], v[216:219], a[236:239], v[188:191]
ds_read_b64_tr_b16 v[208:209], v248 offset:45056
v_cvt_pk_bf16_f32 v192, v160, v161
v_cvt_pk_bf16_f32 v193, v162, v163
buffer_store_dwordx4 v[196:199], v253, s[36:39], s62 offen offset:1024 sc1
v_cvt_pk_bf16_f32 v194, v164, v165
v_cvt_pk_bf16_f32 v195, v166, v167
v_cvt_pk_bf16_f32 v196, v168, v169
v_cvt_pk_bf16_f32 v197, v170, v171
v_cvt_pk_bf16_f32 v198, v172, v173
v_cvt_pk_bf16_f32 v199, v174, v175
s_waitcnt lgkmcnt(4)
v_mfma_f32_16x16x32_bf16 v[176:179], v[220:223], a[240:243], v[176:179]
ds_read_b64_tr_b16 v[210:211], v248 offset:47104
v_mfma_f32_16x16x32_bf16 v[180:183], v[220:223], a[244:247], v[180:183]
buffer_load_dwordx4 v244, s[24:27], s75 offen offset:0 lds
v_mfma_f32_16x16x32_bf16 v[184:187], v[220:223], a[248:251], v[184:187]
ds_read_b64_tr_b16 v[212:213], v248 offset:49152
v_mfma_f32_16x16x32_bf16 v[188:191], v[220:223], a[252:255], v[188:191]
ds_read_b64_tr_b16 v[214:215], v248 offset:51200
s_waitcnt lgkmcnt(4)
v_mfma_f32_16x16x32_bf16 v[176:179], v[224:227], v[0:3], v[176:179]
ds_read_b64_tr_b16 v[216:217], v248 offset:53248
v_mfma_f32_16x16x32_bf16 v[180:183], v[224:227], v[4:7], v[180:183]
buffer_load_dwordx4 v245, s[24:27], s75 offen offset:1024 lds
v_mfma_f32_16x16x32_bf16 v[184:187], v[224:227], v[8:11], v[184:187]
ds_read_b64_tr_b16 v[218:219], v248 offset:55296
v_mfma_f32_16x16x32_bf16 v[188:191], v[224:227], v[12:15], v[188:191]
ds_read_b64_tr_b16 v[220:221], v248 offset:57344
v_mfma_f32_16x16x32_bf16 v[176:179], v[204:207], v[16:19], v[176:179]
ds_read_b64_tr_b16 v[222:223], v248 offset:59392
v_mfma_f32_16x16x32_bf16 v[180:183], v[204:207], v[20:23], v[180:183]
buffer_load_dwordx4 v246, s[24:27], s75 offen offset:2048 lds
v_mfma_f32_16x16x32_bf16 v[184:187], v[204:207], v[24:27], v[184:187]
ds_read_b64_tr_b16 v[224:225], v248 offset:61440
v_mfma_f32_16x16x32_bf16 v[188:191], v[204:207], v[28:31], v[188:191]
ds_read_b64_tr_b16 v[226:227], v248 offset:63488
s_waitcnt lgkmcnt(5)
v_mfma_f32_16x16x32_bf16 v[176:179], v[208:211], v[32:35], v[176:179]
v_mfma_f32_16x16x32_bf16 v[180:183], v[208:211], v[36:39], v[180:183]
buffer_load_dwordx4 v247, s[24:27], s75 offen offset:3072 lds
v_mfma_f32_16x16x32_bf16 v[184:187], v[208:211], v[40:43], v[184:187]
s_add_u32 m0, s48, 81920
v_mfma_f32_16x16x32_bf16 v[188:191], v[208:211], v[44:47], v[188:191]
v_mfma_f32_16x16x32_bf16 v[176:179], v[212:215], v[48:51], v[176:179]
v_mfma_f32_16x16x32_bf16 v[180:183], v[212:215], v[52:55], v[180:183]
buffer_load_dwordx4 v244, s[24:27], s76 offen offset:0 lds
v_mfma_f32_16x16x32_bf16 v[184:187], v[212:215], v[56:59], v[184:187]
v_mfma_f32_16x16x32_bf16 v[188:191], v[212:215], v[60:63], v[188:191]
s_waitcnt lgkmcnt(0)
v_mfma_f32_16x16x32_bf16 v[176:179], v[216:219], v[64:67], v[176:179]
s_waitcnt vmcnt(7)
s_barrier
v_mfma_f32_16x16x32_bf16 v[180:183], v[216:219], v[68:71], v[180:183]
buffer_load_dwordx4 v245, s[24:27], s76 offen offset:1024 lds
v_mfma_f32_16x16x32_bf16 v[184:187], v[216:219], v[72:75], v[184:187]
ds_read_b64_tr_b16 v[204:205], v250 offset:0
v_mfma_f32_16x16x32_bf16 v[188:191], v[216:219], v[76:79], v[188:191]
ds_read_b64_tr_b16 v[206:207], v250 offset:2048
v_mfma_f32_16x16x32_bf16 v[176:179], v[220:223], v[80:83], v[176:179]
ds_read_b64_tr_b16 v[208:209], v250 offset:4096
v_mfma_f32_16x16x32_bf16 v[180:183], v[220:223], v[84:87], v[180:183]
buffer_load_dwordx4 v246, s[24:27], s76 offen offset:2048 lds
v_mfma_f32_16x16x32_bf16 v[184:187], v[220:223], v[88:91], v[184:187]
ds_read_b64_tr_b16 v[210:211], v250 offset:6144
v_mfma_f32_16x16x32_bf16 v[188:191], v[220:223], v[92:95], v[188:191]
ds_read_b64_tr_b16 v[212:213], v250 offset:8192
v_mfma_f32_16x16x32_bf16 v[176:179], v[224:227], v[96:99], v[176:179]
ds_read_b64_tr_b16 v[214:215], v250 offset:10240
v_mfma_f32_16x16x32_bf16 v[180:183], v[224:227], v[100:103], v[180:183]
buffer_load_dwordx4 v247, s[24:27], s76 offen offset:3072 lds
v_mfma_f32_16x16x32_bf16 v[184:187], v[224:227], v[104:107], v[184:187]
ds_read_b64_tr_b16 v[216:217], v250 offset:12288
buffer_store_dwordx4 v[192:195], v253, s[36:39], s63 offen offset:0 sc1
v_mfma_f32_16x16x32_bf16 v[188:191], v[224:227], v[108:111], v[188:191]
ds_read_b64_tr_b16 v[218:219], v250 offset:14336
s_waitcnt lgkmcnt(5)
v_mfma_f32_16x16x32_bf16 v[160:163], v[204:207], a[112:115], 0
buffer_store_dwordx4 v[196:199], v253, s[36:39], s63 offen offset:1024 sc1
v_mfma_f32_16x16x32_bf16 v[164:167], v[204:207], a[116:119], 0
v_cvt_pk_bf16_f32 v192, v176, v177
v_cvt_pk_bf16_f32 v193, v178, v179
v_mfma_f32_16x16x32_bf16 v[168:171], v[204:207], a[120:123], 0
v_cvt_pk_bf16_f32 v194, v180, v181
v_mfma_f32_16x16x32_bf16 v[172:175], v[204:207], a[124:127], 0
v_cvt_pk_bf16_f32 v195, v182, v183
s_waitcnt lgkmcnt(2)
v_mfma_f32_16x16x32_bf16 v[160:163], v[208:211], a[128:131], v[160:163]
v_cvt_pk_bf16_f32 v196, v184, v185
v_cvt_pk_bf16_f32 v197, v186, v187
v_mfma_f32_16x16x32_bf16 v[164:167], v[208:211], a[132:135], v[164:167]
v_cvt_pk_bf16_f32 v198, v188, v189
v_cvt_pk_bf16_f32 v199, v190, v191
v_mfma_f32_16x16x32_bf16 v[168:171], v[208:211], a[136:139], v[168:171]
buffer_load_dwordx2 v[144:145], v202, s[8:11], s77 offen
v_mfma_f32_16x16x32_bf16 v[172:175], v[208:211], a[140:143], v[172:175]
buffer_load_dwordx2 v[146:147], v202, s[8:11], s70 offen
v_mfma_f32_16x16x32_bf16 v[160:163], v[212:215], a[144:147], v[160:163]
buffer_load_dwordx2 v[148:149], v202, s[8:11], s71 offen
v_mfma_f32_16x16x32_bf16 v[164:167], v[212:215], a[148:151], v[164:167]
buffer_load_dwordx2 v[150:151], v202, s[8:11], s72 offen
ds_read_b64_tr_b16 v[220:221], v250 offset:16384
s_lshl_b32 s3, s54, 1
s_add_u32 s3, s3, s66
s_mov_b64 exec, 1
buffer_store_dword v200, off, s[36:39], s3 offset:0 sc1
s_mov_b64 exec, -1
ds_read_b64_tr_b16 v[222:223], v250 offset:18432
buffer_store_dwordx4 v[192:195], v253, s[36:39], s64 offen offset:0 sc1
v_mfma_f32_16x16x32_bf16 v[168:171], v[212:215], a[152:155], v[168:171]
ds_read_b64_tr_b16 v[224:225], v250 offset:20480
v_mfma_f32_16x16x32_bf16 v[172:175], v[212:215], a[156:159], v[172:175]
ds_read_b64_tr_b16 v[226:227], v250 offset:22528
buffer_store_dwordx4 v[196:199], v253, s[36:39], s64 offen offset:1024 sc1
s_waitcnt lgkmcnt(4)
v_mfma_f32_16x16x32_bf16 v[160:163], v[216:219], a[160:163], v[160:163]
ds_read_b64_tr_b16 v[204:205], v250 offset:24576
v_mfma_f32_16x16x32_bf16 v[164:167], v[216:219], a[164:167], v[164:167]
ds_read_b64_tr_b16 v[206:207], v250 offset:26624
v_mfma_f32_16x16x32_bf16 v[168:171], v[216:219], a[168:171], v[168:171]
ds_read_b64_tr_b16 v[208:209], v250 offset:28672
v_mfma_f32_16x16x32_bf16 v[172:175], v[216:219], a[172:175], v[172:175]
ds_read_b64_tr_b16 v[210:211], v250 offset:30720
s_waitcnt lgkmcnt(6)
v_mfma_f32_16x16x32_bf16 v[160:163], v[220:223], a[176:179], v[160:163]
v_mfma_f32_16x16x32_bf16 v[164:167], v[220:223], a[180:183], v[164:167]
v_mfma_f32_16x16x32_bf16 v[168:171], v[220:223], a[184:187], v[168:171]
v_mfma_f32_16x16x32_bf16 v[172:175], v[220:223], a[188:191], v[172:175]
s_waitcnt lgkmcnt(4)
v_mfma_f32_16x16x32_bf16 v[160:163], v[224:227], a[192:195], v[160:163]
v_mfma_f32_16x16x32_bf16 v[164:167], v[224:227], a[196:199], v[164:167]
v_mfma_f32_16x16x32_bf16 v[168:171], v[224:227], a[200:203], v[168:171]
s_waitcnt lgkmcnt(0) vmcnt(9)
s_barrier
v_mfma_f32_16x16x32_bf16 v[172:175], v[224:227], a[204:207], v[172:175]
ds_read_b64_tr_b16 v[212:213], v249 offset:0
ds_read_b64_tr_b16 v[214:215], v249 offset:2048
v_mfma_f32_16x16x32_bf16 v[160:163], v[204:207], a[208:211], v[160:163]
ds_read_b64_tr_b16 v[216:217], v249 offset:4096
v_mfma_f32_16x16x32_bf16 v[164:167], v[204:207], a[212:215], v[164:167]
ds_read_b64_tr_b16 v[218:219], v249 offset:6144
v_mfma_f32_16x16x32_bf16 v[168:171], v[204:207], a[216:219], v[168:171]
ds_read_b64_tr_b16 v[220:221], v249 offset:8192
v_mfma_f32_16x16x32_bf16 v[172:175], v[204:207], a[220:223], v[172:175]
ds_read_b64_tr_b16 v[222:223], v249 offset:10240
v_mfma_f32_16x16x32_bf16 v[160:163], v[208:211], a[224:227], v[160:163]
ds_read_b64_tr_b16 v[224:225], v249 offset:12288
v_mfma_f32_16x16x32_bf16 v[164:167], v[208:211], a[228:231], v[164:167]
ds_read_b64_tr_b16 v[226:227], v249 offset:14336
v_mfma_f32_16x16x32_bf16 v[168:171], v[208:211], a[232:235], v[168:171]
ds_read_b64_tr_b16 v[204:205], v249 offset:16384
v_mfma_f32_16x16x32_bf16 v[172:175], v[208:211], a[236:239], v[172:175]
ds_read_b64_tr_b16 v[206:207], v249 offset:18432
s_waitcnt lgkmcnt(8)
v_mfma_f32_16x16x32_bf16 v[160:163], v[212:215], a[240:243], v[160:163]
ds_read_b64_tr_b16 v[208:209], v249 offset:20480
v_mfma_f32_16x16x32_bf16 v[164:167], v[212:215], a[244:247], v[164:167]
ds_read_b64_tr_b16 v[210:211], v249 offset:22528
v_mfma_f32_16x16x32_bf16 v[168:171], v[212:215], a[248:251], v[168:171]
v_mfma_f32_16x16x32_bf16 v[172:175], v[212:215], a[252:255], v[172:175]
ds_read_b64_tr_b16 v[212:213], v249 offset:24576
s_waitcnt lgkmcnt(7)
v_mfma_f32_16x16x32_bf16 v[160:163], v[216:219], v[0:3], v[160:163]
ds_read_b64_tr_b16 v[214:215], v249 offset:26624
v_mfma_f32_16x16x32_bf16 v[164:167], v[216:219], v[4:7], v[164:167]
v_mfma_f32_16x16x32_bf16 v[168:171], v[216:219], v[8:11], v[168:171]
v_mfma_f32_16x16x32_bf16 v[172:175], v[216:219], v[12:15], v[172:175]
ds_read_b64_tr_b16 v[216:217], v249 offset:28672
v_mfma_f32_16x16x32_bf16 v[160:163], v[220:223], v[16:19], v[160:163]
ds_read_b64_tr_b16 v[218:219], v249 offset:30720
v_mfma_f32_16x16x32_bf16 v[164:167], v[220:223], v[20:23], v[164:167]
v_mfma_f32_16x16x32_bf16 v[168:171], v[220:223], v[24:27], v[168:171]
v_mfma_f32_16x16x32_bf16 v[172:175], v[220:223], v[28:31], v[172:175]
s_waitcnt lgkmcnt(3)
v_mfma_f32_16x16x32_bf16 v[160:163], v[224:227], v[32:35], v[160:163]
v_mfma_f32_16x16x32_bf16 v[164:167], v[224:227], v[36:39], v[164:167]
v_mfma_f32_16x16x32_bf16 v[168:171], v[224:227], v[40:43], v[168:171]
v_mfma_f32_16x16x32_bf16 v[172:175], v[224:227], v[44:47], v[172:175]
v_mfma_f32_16x16x32_bf16 v[160:163], v[204:207], v[48:51], v[160:163]
v_mfma_f32_16x16x32_bf16 v[164:167], v[204:207], v[52:55], v[164:167]
v_mfma_f32_16x16x32_bf16 v[168:171], v[204:207], v[56:59], v[168:171]
v_mfma_f32_16x16x32_bf16 v[172:175], v[204:207], v[60:63], v[172:175]
v_mfma_f32_16x16x32_bf16 v[160:163], v[208:211], v[64:67], v[160:163]
v_mfma_f32_16x16x32_bf16 v[164:167], v[208:211], v[68:71], v[164:167]
v_mfma_f32_16x16x32_bf16 v[168:171], v[208:211], v[72:75], v[168:171]
v_mfma_f32_16x16x32_bf16 v[172:175], v[208:211], v[76:79], v[172:175]
s_waitcnt lgkmcnt(0)
v_mfma_f32_16x16x32_bf16 v[160:163], v[212:215], v[80:83], v[160:163]
v_mfma_f32_16x16x32_bf16 v[164:167], v[212:215], v[84:87], v[164:167]
v_mfma_f32_16x16x32_bf16 v[168:171], v[212:215], v[88:91], v[168:171]
v_mfma_f32_16x16x32_bf16 v[172:175], v[212:215], v[92:95], v[172:175]
v_mfma_f32_16x16x32_bf16 v[160:163], v[216:219], v[96:99], v[160:163]
v_mfma_f32_16x16x32_bf16 v[164:167], v[216:219], v[100:103], v[164:167]
v_mfma_f32_16x16x32_bf16 v[168:171], v[216:219], v[104:107], v[168:171]
v_mfma_f32_16x16x32_bf16 v[172:175], v[216:219], v[108:111], v[172:175]
s_lshl_b32 s3, s55, 1
s_add_u32 s3, s3, s66
s_mov_b64 exec, 1
buffer_store_dword v200, off, s[36:39], s3 offset:0 sc1
s_mov_b64 exec, -1
s_waitcnt vmcnt(8)
s_lshl_b32 s3, s56, 1
s_add_u32 s3, s3, s66
s_mov_b64 exec, 1
buffer_store_dword v200, off, s[36:39], s3 offset:0 sc1
s_mov_b64 exec, -1
s_mov_b64 exec, 0x7f
buffer_load_dword v203, v201, s[36:39], s67 offen offset:128 sc1
s_mov_b64 exec, -1
s_waitcnt vmcnt(0) lgkmcnt(0)
s_lshl_b32 s70, s57, 1
s_add_u32 s70, s70, s66
s_mov_b64 exec, 1
buffer_store_dword v200, off, s[36:39], s70 sc1
s_mov_b64 exec, -1
s_nop 7
s_cmp_eq_u32 s45, 7
s_cbranch_scc0 L_owner
v_cvt_pk_bf16_f32 v192, v160, v161
v_cvt_pk_bf16_f32 v193, v162, v163
v_cvt_pk_bf16_f32 v194, v164, v165
v_cvt_pk_bf16_f32 v195, v166, v167
v_cvt_pk_bf16_f32 v196, v168, v169
v_cvt_pk_bf16_f32 v197, v170, v171
v_cvt_pk_bf16_f32 v198, v172, v173
v_cvt_pk_bf16_f32 v199, v174, v175
buffer_store_dwordx4 v[192:195], v253, s[36:39], s65 offen offset:0 sc1
buffer_store_dwordx4 v[196:199], v253, s[36:39], s65 offen offset:1024 sc1
s_waitcnt vmcnt(0)
s_lshl_b32 s70, s58, 1
s_add_u32 s70, s70, s66
s_mov_b64 exec, 1
buffer_store_dword v200, off, s[36:39], s70 sc1
s_waitcnt vmcnt(0)
s_endpgm
L_owner:
s_mov_b32 s71, 0x5000
v_cmp_ne_u32 vcc, 0, v203
s_nop 4
s_and_b32 s3, vcc_lo, 112
s_cmp_eq_u32 s3, 112
s_cbranch_scc1 L_gotd
L_polld:
s_mov_b64 exec, 0x7f
buffer_load_dword v203, v201, s[36:39], s67 offen offset:128 sc1
s_mov_b64 exec, -1
s_waitcnt vmcnt(0)
v_cmp_ne_u32 vcc, 0, v203
s_sub_u32 s71, s71, 1
s_cmp_eq_u32 s71, 0
s_cbranch_scc1 L_gotd
s_nop 1
s_and_b32 s3, vcc_lo, 112
s_cmp_lg_u32 s3, 112
s_cbranch_scc1 L_polld
L_gotd:
s_sub_u32 s72, s45, 5
s_add_u32 s3, s72, 7
s_cmp_lt_i32 s72, 0
s_cselect_b32 s72, s3, s72
s_lshl_b32 s72, s72, 14
s_add_u32 s72, s72, s68
s_add_u32 s72, s72, 8192
buffer_load_dwordx4 v[56:59], v253, s[36:39], s72 offen offset:0 sc1
buffer_load_dwordx4 v[60:63], v253, s[36:39], s72 offen offset:1024 sc1
s_sub_u32 s72, s45, 6
s_add_u32 s3, s72, 7
s_cmp_lt_i32 s72, 0
s_cselect_b32 s72, s3, s72
s_lshl_b32 s72, s72, 14
s_add_u32 s72, s72, s68
s_add_u32 s72, s72, 8192
buffer_load_dwordx4 v[64:67], v253, s[36:39], s72 offen offset:0 sc1
buffer_load_dwordx4 v[68:71], v253, s[36:39], s72 offen offset:1024 sc1
s_add_u32 s72, s68, 114688
s_add_u32 s72, s72, 8192
buffer_load_dwordx4 v[72:75], v253, s[36:39], s72 offen offset:0 sc1
buffer_load_dwordx4 v[76:79], v253, s[36:39], s72 offen offset:1024 sc1
s_mov_b64 exec, 0x7f
buffer_load_dword v203, v201, s[36:39], s67 offen sc1
s_mov_b64 exec, -1
s_waitcnt vmcnt(5)
v_dot2c_f32_bf16 v128, s92, v56
v_dot2c_f32_bf16 v129, s93, v56
v_dot2c_f32_bf16 v130, s92, v57
v_dot2c_f32_bf16 v131, s93, v57
v_dot2c_f32_bf16 v132, s92, v58
v_dot2c_f32_bf16 v133, s93, v58
v_dot2c_f32_bf16 v134, s92, v59
v_dot2c_f32_bf16 v135, s93, v59
v_dot2c_f32_bf16 v136, s92, v60
v_dot2c_f32_bf16 v137, s93, v60
v_dot2c_f32_bf16 v138, s92, v61
v_dot2c_f32_bf16 v139, s93, v61
v_dot2c_f32_bf16 v140, s92, v62
v_dot2c_f32_bf16 v141, s93, v62
v_dot2c_f32_bf16 v142, s92, v63
v_dot2c_f32_bf16 v143, s93, v63
s_waitcnt vmcnt(3)
v_dot2c_f32_bf16 v128, s92, v64
v_dot2c_f32_bf16 v129, s93, v64
v_dot2c_f32_bf16 v130, s92, v65
v_dot2c_f32_bf16 v131, s93, v65
v_dot2c_f32_bf16 v132, s92, v66
v_dot2c_f32_bf16 v133, s93, v66
v_dot2c_f32_bf16 v134, s92, v67
v_dot2c_f32_bf16 v135, s93, v67
v_dot2c_f32_bf16 v136, s92, v68
v_dot2c_f32_bf16 v137, s93, v68
v_dot2c_f32_bf16 v138, s92, v69
v_dot2c_f32_bf16 v139, s93, v69
v_dot2c_f32_bf16 v140, s92, v70
v_dot2c_f32_bf16 v141, s93, v70
v_dot2c_f32_bf16 v142, s92, v71
v_dot2c_f32_bf16 v143, s93, v71
s_waitcnt vmcnt(1)
v_dot2c_f32_bf16 v128, s92, v72
v_dot2c_f32_bf16 v129, s93, v72
v_dot2c_f32_bf16 v130, s92, v73
v_dot2c_f32_bf16 v131, s93, v73
v_dot2c_f32_bf16 v132, s92, v74
v_dot2c_f32_bf16 v133, s93, v74
v_dot2c_f32_bf16 v134, s92, v75
v_dot2c_f32_bf16 v135, s93, v75
v_dot2c_f32_bf16 v136, s92, v76
v_dot2c_f32_bf16 v137, s93, v76
v_dot2c_f32_bf16 v138, s92, v77
v_dot2c_f32_bf16 v139, s93, v77
v_dot2c_f32_bf16 v140, s92, v78
v_dot2c_f32_bf16 v141, s93, v78
v_dot2c_f32_bf16 v142, s92, v79
v_dot2c_f32_bf16 v143, s93, v79
s_nop 3
v_mul_f32 v112, 0xbfb8aa3b, v128
v_mul_f32 v113, 0xbfb8aa3b, v129
v_mul_f32 v114, 0xbfb8aa3b, v130
v_mul_f32 v115, 0xbfb8aa3b, v131
v_mul_f32 v116, 0xbfb8aa3b, v132
v_mul_f32 v117, 0xbfb8aa3b, v133
v_mul_f32 v118, 0xbfb8aa3b, v134
v_mul_f32 v119, 0xbfb8aa3b, v135
v_mul_f32 v120, 0xbfb8aa3b, v136
v_mul_f32 v121, 0xbfb8aa3b, v137
v_mul_f32 v122, 0xbfb8aa3b, v138
v_mul_f32 v123, 0xbfb8aa3b, v139
v_mul_f32 v124, 0xbfb8aa3b, v140
v_mul_f32 v125, 0xbfb8aa3b, v141
v_mul_f32 v126, 0xbfb8aa3b, v142
v_mul_f32 v127, 0xbfb8aa3b, v143
v_exp_f32 v112, v112
v_exp_f32 v113, v113
v_exp_f32 v114, v114
v_exp_f32 v115, v115
v_exp_f32 v116, v116
v_exp_f32 v117, v117
v_exp_f32 v118, v118
v_exp_f32 v119, v119
v_exp_f32 v120, v120
v_exp_f32 v121, v121
v_exp_f32 v122, v122
v_exp_f32 v123, v123
v_exp_f32 v124, v124
v_exp_f32 v125, v125
v_exp_f32 v126, v126
v_exp_f32 v127, v127
v_add_f32 v112, 1.0, v112
v_add_f32 v113, 1.0, v113
v_add_f32 v114, 1.0, v114
v_add_f32 v115, 1.0, v115
v_add_f32 v116, 1.0, v116
v_add_f32 v117, 1.0, v117
v_add_f32 v118, 1.0, v118
v_add_f32 v119, 1.0, v119
v_add_f32 v120, 1.0, v120
v_add_f32 v121, 1.0, v121
v_add_f32 v122, 1.0, v122
v_add_f32 v123, 1.0, v123
v_add_f32 v124, 1.0, v124
v_add_f32 v125, 1.0, v125
v_add_f32 v126, 1.0, v126
v_add_f32 v127, 1.0, v127
v_rcp_f32 v112, v112
v_rcp_f32 v113, v113
v_rcp_f32 v114, v114
v_rcp_f32 v115, v115
v_rcp_f32 v116, v116
v_rcp_f32 v117, v117
v_rcp_f32 v118, v118
v_rcp_f32 v119, v119
v_rcp_f32 v120, v120
v_rcp_f32 v121, v121
v_rcp_f32 v122, v122
v_rcp_f32 v123, v123
v_rcp_f32 v124, v124
v_rcp_f32 v125, v125
v_rcp_f32 v126, v126
v_rcp_f32 v127, v127
v_mul_f32 v128, v128, v112
v_mul_f32 v129, v129, v113
v_mul_f32 v130, v130, v114
v_mul_f32 v131, v131, v115
v_mul_f32 v132, v132, v116
v_mul_f32 v133, v133, v117
v_mul_f32 v134, v134, v118
v_mul_f32 v135, v135, v119
v_mul_f32 v136, v136, v120
v_mul_f32 v137, v137, v121
v_mul_f32 v138, v138, v122
v_mul_f32 v139, v139, v123
v_mul_f32 v140, v140, v124
v_mul_f32 v141, v141, v125
v_mul_f32 v142, v142, v126
v_mul_f32 v143, v143, v127
s_waitcnt vmcnt(0)
v_cmp_ne_u32 vcc, 0, v203
s_nop 3
s_and_b32 s3, vcc_lo, 127
s_cmp_eq_u32 s3, 127
s_cbranch_scc1 L_got
L_poll:
s_mov_b64 exec, 0x7f
buffer_load_dword v203, v201, s[36:39], s67 offen offset:0 sc1
s_mov_b64 exec, -1
s_waitcnt vmcnt(0)
v_cmp_ne_u32 vcc, 0, v203
s_sub_u32 s71, s71, 1
s_cmp_eq_u32 s71, 0
s_cbranch_scc1 L_got
s_nop 1
s_and_b32 s3, vcc_lo, 127
s_cmp_lg_u32 s3, 127
s_cbranch_scc1 L_poll
L_got:
s_sub_u32 s72, s45, 1
s_add_u32 s3, s72, 7
s_cmp_lt_i32 s72, 0
s_cselect_b32 s72, s3, s72
s_lshl_b32 s72, s72, 14
s_add_u32 s72, s72, s68
buffer_load_dwordx4 v[0:3], v253, s[36:39], s72 offen offset:0 sc1
buffer_load_dwordx4 v[4:7], v253, s[36:39], s72 offen offset:1024 sc1
s_sub_u32 s72, s45, 2
s_add_u32 s3, s72, 7
s_cmp_lt_i32 s72, 0
s_cselect_b32 s72, s3, s72
s_lshl_b32 s72, s72, 14
s_add_u32 s72, s72, s68
buffer_load_dwordx4 v[8:11], v253, s[36:39], s72 offen offset:0 sc1
buffer_load_dwordx4 v[12:15], v253, s[36:39], s72 offen offset:1024 sc1
s_sub_u32 s72, s45, 3
s_add_u32 s3, s72, 7
s_cmp_lt_i32 s72, 0
s_cselect_b32 s72, s3, s72
s_lshl_b32 s72, s72, 14
s_add_u32 s72, s72, s68
buffer_load_dwordx4 v[16:19], v253, s[36:39], s72 offen offset:0 sc1
buffer_load_dwordx4 v[20:23], v253, s[36:39], s72 offen offset:1024 sc1
s_sub_u32 s72, s45, 4
s_add_u32 s3, s72, 7
s_cmp_lt_i32 s72, 0
s_cselect_b32 s72, s3, s72
s_lshl_b32 s72, s72, 14
s_add_u32 s72, s72, s68
buffer_load_dwordx4 v[24:27], v253, s[36:39], s72 offen offset:0 sc1
buffer_load_dwordx4 v[28:31], v253, s[36:39], s72 offen offset:1024 sc1
s_sub_u32 s72, s45, 5
s_add_u32 s3, s72, 7
s_cmp_lt_i32 s72, 0
s_cselect_b32 s72, s3, s72
s_lshl_b32 s72, s72, 14
s_add_u32 s72, s72, s68
buffer_load_dwordx4 v[32:35], v253, s[36:39], s72 offen offset:0 sc1
buffer_load_dwordx4 v[36:39], v253, s[36:39], s72 offen offset:1024 sc1
s_sub_u32 s72, s45, 6
s_add_u32 s3, s72, 7
s_cmp_lt_i32 s72, 0
s_cselect_b32 s72, s3, s72
s_lshl_b32 s72, s72, 14
s_add_u32 s72, s72, s68
buffer_load_dwordx4 v[40:43], v253, s[36:39], s72 offen offset:0 sc1
buffer_load_dwordx4 v[44:47], v253, s[36:39], s72 offen offset:1024 sc1
s_add_u32 s72, s68, 114688
buffer_load_dwordx4 v[48:51], v253, s[36:39], s72 offen offset:0 sc1
buffer_load_dwordx4 v[52:55], v253, s[36:39], s72 offen offset:1024 sc1
s_mul_i32 s70, s46, 57344
s_lshl_b32 s71, s45, 7
s_add_u32 s70, s70, s71
s_waitcnt vmcnt(12)
v_dot2c_f32_bf16 v160, s92, v0
v_dot2c_f32_bf16 v161, s93, v0
v_dot2c_f32_bf16 v162, s92, v1
v_dot2c_f32_bf16 v163, s93, v1
v_dot2c_f32_bf16 v164, s92, v2
v_dot2c_f32_bf16 v165, s93, v2
v_dot2c_f32_bf16 v166, s92, v3
v_dot2c_f32_bf16 v167, s93, v3
v_dot2c_f32_bf16 v168, s92, v4
v_dot2c_f32_bf16 v169, s93, v4
v_dot2c_f32_bf16 v170, s92, v5
v_dot2c_f32_bf16 v171, s93, v5
v_dot2c_f32_bf16 v172, s92, v6
v_dot2c_f32_bf16 v173, s93, v6
v_dot2c_f32_bf16 v174, s92, v7
v_dot2c_f32_bf16 v175, s93, v7
s_waitcnt vmcnt(10)
v_dot2c_f32_bf16 v160, s92, v8
v_dot2c_f32_bf16 v161, s93, v8
v_dot2c_f32_bf16 v162, s92, v9
v_dot2c_f32_bf16 v163, s93, v9
v_dot2c_f32_bf16 v164, s92, v10
v_dot2c_f32_bf16 v165, s93, v10
v_dot2c_f32_bf16 v166, s92, v11
v_dot2c_f32_bf16 v167, s93, v11
v_dot2c_f32_bf16 v168, s92, v12
v_dot2c_f32_bf16 v169, s93, v12
v_dot2c_f32_bf16 v170, s92, v13
v_dot2c_f32_bf16 v171, s93, v13
v_dot2c_f32_bf16 v172, s92, v14
v_dot2c_f32_bf16 v173, s93, v14
v_dot2c_f32_bf16 v174, s92, v15
v_dot2c_f32_bf16 v175, s93, v15
s_waitcnt vmcnt(8)
v_dot2c_f32_bf16 v160, s92, v16
v_dot2c_f32_bf16 v161, s93, v16
v_dot2c_f32_bf16 v162, s92, v17
v_dot2c_f32_bf16 v163, s93, v17
v_dot2c_f32_bf16 v164, s92, v18
v_dot2c_f32_bf16 v165, s93, v18
v_dot2c_f32_bf16 v166, s92, v19
v_dot2c_f32_bf16 v167, s93, v19
v_dot2c_f32_bf16 v168, s92, v20
v_dot2c_f32_bf16 v169, s93, v20
v_dot2c_f32_bf16 v170, s92, v21
v_dot2c_f32_bf16 v171, s93, v21
v_dot2c_f32_bf16 v172, s92, v22
v_dot2c_f32_bf16 v173, s93, v22
v_dot2c_f32_bf16 v174, s92, v23
v_dot2c_f32_bf16 v175, s93, v23
s_waitcnt vmcnt(6)
v_dot2c_f32_bf16 v160, s92, v24
v_dot2c_f32_bf16 v161, s93, v24
v_dot2c_f32_bf16 v162, s92, v25
v_dot2c_f32_bf16 v163, s93, v25
v_dot2c_f32_bf16 v164, s92, v26
v_dot2c_f32_bf16 v165, s93, v26
v_dot2c_f32_bf16 v166, s92, v27
v_dot2c_f32_bf16 v167, s93, v27
v_dot2c_f32_bf16 v168, s92, v28
v_dot2c_f32_bf16 v169, s93, v28
v_dot2c_f32_bf16 v170, s92, v29
v_dot2c_f32_bf16 v171, s93, v29
v_dot2c_f32_bf16 v172, s92, v30
v_dot2c_f32_bf16 v173, s93, v30
v_dot2c_f32_bf16 v174, s92, v31
v_dot2c_f32_bf16 v175, s93, v31
s_waitcnt vmcnt(4)
v_dot2c_f32_bf16 v160, s92, v32
v_dot2c_f32_bf16 v161, s93, v32
v_dot2c_f32_bf16 v162, s92, v33
v_dot2c_f32_bf16 v163, s93, v33
v_dot2c_f32_bf16 v164, s92, v34
v_dot2c_f32_bf16 v165, s93, v34
v_dot2c_f32_bf16 v166, s92, v35
v_dot2c_f32_bf16 v167, s93, v35
v_dot2c_f32_bf16 v168, s92, v36
v_dot2c_f32_bf16 v169, s93, v36
v_dot2c_f32_bf16 v170, s92, v37
v_dot2c_f32_bf16 v171, s93, v37
v_dot2c_f32_bf16 v172, s92, v38
v_dot2c_f32_bf16 v173, s93, v38
v_dot2c_f32_bf16 v174, s92, v39
v_dot2c_f32_bf16 v175, s93, v39
s_waitcnt vmcnt(2)
v_dot2c_f32_bf16 v160, s92, v40
v_dot2c_f32_bf16 v161, s93, v40
v_dot2c_f32_bf16 v162, s92, v41
v_dot2c_f32_bf16 v163, s93, v41
v_dot2c_f32_bf16 v164, s92, v42
v_dot2c_f32_bf16 v165, s93, v42
v_dot2c_f32_bf16 v166, s92, v43
v_dot2c_f32_bf16 v167, s93, v43
v_dot2c_f32_bf16 v168, s92, v44
v_dot2c_f32_bf16 v169, s93, v44
v_dot2c_f32_bf16 v170, s92, v45
v_dot2c_f32_bf16 v171, s93, v45
v_dot2c_f32_bf16 v172, s92, v46
v_dot2c_f32_bf16 v173, s93, v46
v_dot2c_f32_bf16 v174, s92, v47
v_dot2c_f32_bf16 v175, s93, v47
s_waitcnt vmcnt(0)
v_dot2c_f32_bf16 v160, s92, v48
v_dot2c_f32_bf16 v161, s93, v48
v_dot2c_f32_bf16 v162, s92, v49
v_dot2c_f32_bf16 v163, s93, v49
v_dot2c_f32_bf16 v164, s92, v50
v_dot2c_f32_bf16 v165, s93, v50
v_dot2c_f32_bf16 v166, s92, v51
v_dot2c_f32_bf16 v167, s93, v51
v_dot2c_f32_bf16 v168, s92, v52
v_dot2c_f32_bf16 v169, s93, v52
v_dot2c_f32_bf16 v170, s92, v53
v_dot2c_f32_bf16 v171, s93, v53
v_dot2c_f32_bf16 v172, s92, v54
v_dot2c_f32_bf16 v173, s93, v54
v_dot2c_f32_bf16 v174, s92, v55
v_dot2c_f32_bf16 v175, s93, v55
s_nop 3
v_lshlrev_b32 v192, 16, v144
v_and_b32 v193, 0xffff0000, v144
v_lshlrev_b32 v194, 16, v145
v_and_b32 v195, 0xffff0000, v145
v_fma_f32 v160, v160, v128, v192
v_fma_f32 v161, v161, v129, v193
v_fma_f32 v162, v162, v130, v194
v_fma_f32 v163, v163, v131, v195
v_cvt_pk_bf16_f32 v196, v160, v161
v_cvt_pk_bf16_f32 v197, v162, v163
buffer_store_dwordx2 v[196:197], v202, s[40:43], s70 offen
s_add_u32 s70, s70, 14336
v_lshlrev_b32 v192, 16, v146
v_and_b32 v193, 0xffff0000, v146
v_lshlrev_b32 v194, 16, v147
v_and_b32 v195, 0xffff0000, v147
v_fma_f32 v164, v164, v132, v192
v_fma_f32 v165, v165, v133, v193
v_fma_f32 v166, v166, v134, v194
v_fma_f32 v167, v167, v135, v195
v_cvt_pk_bf16_f32 v198, v164, v165
v_cvt_pk_bf16_f32 v199, v166, v167
buffer_store_dwordx2 v[198:199], v202, s[40:43], s70 offen
s_add_u32 s70, s70, 14336
v_lshlrev_b32 v192, 16, v148
v_and_b32 v193, 0xffff0000, v148
v_lshlrev_b32 v194, 16, v149
v_and_b32 v195, 0xffff0000, v149
v_fma_f32 v168, v168, v136, v192
v_fma_f32 v169, v169, v137, v193
v_fma_f32 v170, v170, v138, v194
v_fma_f32 v171, v171, v139, v195
v_cvt_pk_bf16_f32 v196, v168, v169
v_cvt_pk_bf16_f32 v197, v170, v171
buffer_store_dwordx2 v[196:197], v202, s[40:43], s70 offen
s_add_u32 s70, s70, 14336
v_lshlrev_b32 v192, 16, v150
v_and_b32 v193, 0xffff0000, v150
v_lshlrev_b32 v194, 16, v151
v_and_b32 v195, 0xffff0000, v151
v_fma_f32 v172, v172, v140, v192
v_fma_f32 v173, v173, v141, v193
v_fma_f32 v174, v174, v142, v194
v_fma_f32 v175, v175, v143, v195
v_cvt_pk_bf16_f32 v198, v172, v173
v_cvt_pk_bf16_f32 v199, v174, v175
buffer_store_dwordx2 v[198:199], v202, s[40:43], s70 offen
s_add_u32 s70, s70, 14336
s_waitcnt vmcnt(0) lgkmcnt(0)
L_end_main:
s_endpgm
L_fallback:
s_waitcnt vmcnt(0) lgkmcnt(0)
s_nop 7
s_nop 7
v_mov_b32 v128, v192
s_nop 1
v_permlane16_swap_b32 v192, v128
v_max_f32 v192, v192, v128
v_mov_b32 v128, v192
s_nop 1
v_permlane32_swap_b32 v192, v128
v_max_f32 v192, v192, v128
v_sub_f32 v184, v184, v192
v_sub_f32 v185, v185, v192
v_sub_f32 v186, v186, v192
v_sub_f32 v187, v187, v192
v_mov_b32 v128, v193
s_nop 1
v_permlane16_swap_b32 v193, v128
v_max_f32 v193, v193, v128
v_mov_b32 v128, v193
s_nop 1
v_permlane32_swap_b32 v193, v128
v_max_f32 v193, v193, v128
v_sub_f32 v188, v188, v193
v_sub_f32 v189, v189, v193
v_sub_f32 v190, v190, v193
v_sub_f32 v191, v191, v193
v_mov_b32 v0, 0
v_mov_b32 v1, 0
v_mov_b32 v2, 0
v_mov_b32 v3, 0
v_mov_b32 v4, 0
v_mov_b32 v5, 0
v_mov_b32 v6, 0
v_mov_b32 v7, 0
v_mov_b32 v8, 0
v_mov_b32 v9, 0
v_mov_b32 v10, 0
v_mov_b32 v11, 0
v_mov_b32 v12, 0
v_mov_b32 v13, 0
v_mov_b32 v14, 0
v_mov_b32 v15, 0
v_mov_b32 v16, 0
v_mov_b32 v17, 0
v_mov_b32 v18, 0
v_mov_b32 v19, 0
v_mov_b32 v20, 0
v_mov_b32 v21, 0
v_mov_b32 v22, 0
v_mov_b32 v23, 0
v_mov_b32 v24, 0
v_mov_b32 v25, 0
v_mov_b32 v26, 0
v_mov_b32 v27, 0
v_mov_b32 v28, 0
v_mov_b32 v29, 0
v_mov_b32 v30, 0
v_mov_b32 v31, 0
v_mov_b32 v32, 0
v_mov_b32 v33, 0
v_mov_b32 v34, 0
v_mov_b32 v35, 0
v_mov_b32 v36, 0
v_mov_b32 v37, 0
v_mov_b32 v38, 0
v_mov_b32 v39, 0
v_mov_b32 v40, 0
v_mov_b32 v41, 0
v_mov_b32 v42, 0
v_mov_b32 v43, 0
v_mov_b32 v44, 0
v_mov_b32 v45, 0
v_mov_b32 v46, 0
v_mov_b32 v47, 0
v_mov_b32 v48, 0
v_mov_b32 v49, 0
v_mov_b32 v50, 0
v_mov_b32 v51, 0
v_mov_b32 v52, 0
v_mov_b32 v53, 0
v_mov_b32 v54, 0
v_mov_b32 v55, 0
v_mov_b32 v56, 0
v_mov_b32 v57, 0
v_mov_b32 v58, 0
v_mov_b32 v59, 0
v_mov_b32 v60, 0
v_mov_b32 v61, 0
v_mov_b32 v62, 0
v_mov_b32 v63, 0
v_mov_b32 v64, 0
v_mov_b32 v65, 0
v_mov_b32 v66, 0
v_mov_b32 v67, 0
v_mov_b32 v68, 0
v_mov_b32 v69, 0
v_mov_b32 v70, 0
v_mov_b32 v71, 0
v_mov_b32 v72, 0
v_mov_b32 v73, 0
v_mov_b32 v74, 0
v_mov_b32 v75, 0
v_mov_b32 v76, 0
v_mov_b32 v77, 0
v_mov_b32 v78, 0
v_mov_b32 v79, 0
v_mov_b32 v80, 0
v_mov_b32 v81, 0
v_mov_b32 v82, 0
v_mov_b32 v83, 0
v_mov_b32 v84, 0
v_mov_b32 v85, 0
v_mov_b32 v86, 0
v_mov_b32 v87, 0
v_mov_b32 v88, 0
v_mov_b32 v89, 0
v_mov_b32 v90, 0
v_mov_b32 v91, 0
v_mov_b32 v92, 0
v_mov_b32 v93, 0
v_mov_b32 v94, 0
v_mov_b32 v95, 0
v_mov_b32 v96, 0
v_mov_b32 v97, 0
v_mov_b32 v98, 0
v_mov_b32 v99, 0
v_mov_b32 v100, 0
v_mov_b32 v101, 0
v_mov_b32 v102, 0
v_mov_b32 v103, 0
v_mov_b32 v104, 0
v_mov_b32 v105, 0
v_mov_b32 v106, 0
v_mov_b32 v107, 0
v_mov_b32 v108, 0
v_mov_b32 v109, 0
v_mov_b32 v110, 0
v_mov_b32 v111, 0
v_mov_b32 v112, 0
v_mov_b32 v113, 0
v_mov_b32 v114, 0
v_mov_b32 v115, 0
v_mov_b32 v116, 0
v_mov_b32 v117, 0
v_mov_b32 v118, 0
v_mov_b32 v119, 0
v_mov_b32 v120, 0
v_mov_b32 v121, 0
v_mov_b32 v122, 0
v_mov_b32 v123, 0
v_mov_b32 v124, 0
v_mov_b32 v125, 0
v_mov_b32 v126, 0
v_mov_b32 v127, 0
v_mov_b32 v176, 0
v_mov_b32 v177, 0
v_mov_b32 v178, 0
v_mov_b32 v179, 0
v_mov_b32 v180, 0
v_mov_b32 v181, 0
v_mov_b32 v182, 0
v_mov_b32 v183, 0
v_lshrrev_b32 v128, 5, v255
v_and_b32 v129, 31, v255
s_lshl_b32 s98, s44, 3
v_add_u32 v130, s98, v128
v_lshlrev_b32 v131, 9, v130
v_add_u32 v160, 0, v130
v_and_b32 v160, 15, v160
v_xor_b32 v160, v129, v160
v_lshlrev_b32 v160, 4, v160
v_add_u32 v160, v131, v160
v_add_u32 v164, 0, v128
v_and_b32 v164, 7, v164
v_lshlrev_b32 v164, 1, v164
v_xor_b32 v164, v129, v164
v_lshlrev_b32 v164, 4, v164
v_add_u32 v164, v131, v164
v_add_u32 v161, 2, v130
v_and_b32 v161, 15, v161
v_xor_b32 v161, v129, v161
v_lshlrev_b32 v161, 4, v161
v_add_u32 v161, v131, v161
v_add_u32 v165, 2, v128
v_and_b32 v165, 7, v165
v_lshlrev_b32 v165, 1, v165
v_xor_b32 v165, v129, v165
v_lshlrev_b32 v165, 4, v165
v_add_u32 v165, v131, v165
v_add_u32 v162, 4, v130
v_and_b32 v162, 15, v162
v_xor_b32 v162, v129, v162
v_lshlrev_b32 v162, 4, v162
v_add_u32 v162, v131, v162
v_add_u32 v166, 4, v128
v_and_b32 v166, 7, v166
v_lshlrev_b32 v166, 1, v166
v_xor_b32 v166, v129, v166
v_lshlrev_b32 v166, 4, v166
v_add_u32 v166, v131, v166
v_add_u32 v163, 6, v130
v_and_b32 v163, 15, v163
v_xor_b32 v163, v129, v163
v_lshlrev_b32 v163, 4, v163
v_add_u32 v163, v131, v163
v_add_u32 v167, 6, v128
v_and_b32 v167, 7, v167
v_lshlrev_b32 v167, 1, v167
v_xor_b32 v167, v129, v167
v_lshlrev_b32 v167, 4, v167
v_add_u32 v167, v131, v167
v_subrev_u32 v156, 98304, v231
v_subrev_u32 v157, 98304, v232
v_subrev_u32 v158, 98304, v233
v_subrev_u32 v159, 98304, v234
s_mov_b32 s99, 0
L_fb_loop:
s_mov_b32 m0, s48
s_nop 0
buffer_load_dwordx4 v160, s[12:15], s99 offen offset:0 lds
buffer_load_dwordx4 v161, s[12:15], s99 offen offset:1024 lds
buffer_load_dwordx4 v162, s[12:15], s99 offen offset:2048 lds
buffer_load_dwordx4 v163, s[12:15], s99 offen offset:3072 lds
s_add_u32 m0, s48, 16384
s_nop 0
buffer_load_dwordx4 v164, s[16:19], s99 offen offset:0 lds
buffer_load_dwordx4 v165, s[16:19], s99 offen offset:1024 lds
buffer_load_dwordx4 v166, s[16:19], s99 offen offset:2048 lds
buffer_load_dwordx4 v167, s[16:19], s99 offen offset:3072 lds
s_waitcnt vmcnt(0)
s_barrier
s_cmp_eq_u32 s99, 245760
s_cbranch_scc1 L_fb_last
ds_read_b128 v[152:155], v156 offset:0
s_waitcnt lgkmcnt(0)
v_mfma_f32_16x16x32_bf16 v[128:131], v[152:155], a[112:115], v[184:187]
v_mfma_f32_16x16x32_bf16 v[132:135], v[152:155], a[116:119], v[188:191]
s_nop 7
ds_read_b128 v[152:155], v157 offset:0
s_waitcnt lgkmcnt(0)
v_mfma_f32_16x16x32_bf16 v[128:131], v[152:155], a[120:123], v[128:131]
v_mfma_f32_16x16x32_bf16 v[132:135], v[152:155], a[124:127], v[132:135]
s_nop 7
ds_read_b128 v[152:155], v158 offset:0
s_waitcnt lgkmcnt(0)
v_mfma_f32_16x16x32_bf16 v[128:131], v[152:155], a[128:131], v[128:131]
v_mfma_f32_16x16x32_bf16 v[132:135], v[152:155], a[132:135], v[132:135]
s_nop 7
ds_read_b128 v[152:155], v159 offset:0
s_waitcnt lgkmcnt(0)
v_mfma_f32_16x16x32_bf16 v[128:131], v[152:155], a[136:139], v[128:131]
v_mfma_f32_16x16x32_bf16 v[132:135], v[152:155], a[140:143], v[132:135]
s_nop 7
ds_read_b128 v[152:155], v156 offset:256
s_waitcnt lgkmcnt(0)
v_mfma_f32_16x16x32_bf16 v[128:131], v[152:155], a[144:147], v[128:131]
v_mfma_f32_16x16x32_bf16 v[132:135], v[152:155], a[148:151], v[132:135]
s_nop 7
ds_read_b128 v[152:155], v157 offset:256
s_waitcnt lgkmcnt(0)
v_mfma_f32_16x16x32_bf16 v[128:131], v[152:155], a[152:155], v[128:131]
v_mfma_f32_16x16x32_bf16 v[132:135], v[152:155], a[156:159], v[132:135]
s_nop 7
ds_read_b128 v[152:155], v158 offset:256
s_waitcnt lgkmcnt(0)
v_mfma_f32_16x16x32_bf16 v[128:131], v[152:155], a[160:163], v[128:131]
v_mfma_f32_16x16x32_bf16 v[132:135], v[152:155], a[164:167], v[132:135]
s_nop 7
ds_read_b128 v[152:155], v159 offset:256
s_waitcnt lgkmcnt(0)
v_mfma_f32_16x16x32_bf16 v[128:131], v[152:155], a[168:171], v[128:131]
v_mfma_f32_16x16x32_bf16 v[132:135], v[152:155], a[172:175], v[132:135]
s_nop 7
ds_read_b128 v[152:155], v156 offset:8192
s_waitcnt lgkmcnt(0)
v_mfma_f32_16x16x32_bf16 v[136:139], v[152:155], a[112:115], v[184:187]
v_mfma_f32_16x16x32_bf16 v[140:143], v[152:155], a[116:119], v[188:191]
s_nop 7
ds_read_b128 v[152:155], v157 offset:8192
s_waitcnt lgkmcnt(0)
v_mfma_f32_16x16x32_bf16 v[136:139], v[152:155], a[120:123], v[136:139]
v_mfma_f32_16x16x32_bf16 v[140:143], v[152:155], a[124:127], v[140:143]
s_nop 7
ds_read_b128 v[152:155], v158 offset:8192
s_waitcnt lgkmcnt(0)
v_mfma_f32_16x16x32_bf16 v[136:139], v[152:155], a[128:131], v[136:139]
v_mfma_f32_16x16x32_bf16 v[140:143], v[152:155], a[132:135], v[140:143]
s_nop 7
ds_read_b128 v[152:155], v159 offset:8192
s_waitcnt lgkmcnt(0)
v_mfma_f32_16x16x32_bf16 v[136:139], v[152:155], a[136:139], v[136:139]
v_mfma_f32_16x16x32_bf16 v[140:143], v[152:155], a[140:143], v[140:143]
s_nop 7
ds_read_b128 v[152:155], v156 offset:8448
s_waitcnt lgkmcnt(0)
v_mfma_f32_16x16x32_bf16 v[136:139], v[152:155], a[144:147], v[136:139]
v_mfma_f32_16x16x32_bf16 v[140:143], v[152:155], a[148:151], v[140:143]
s_nop 7
ds_read_b128 v[152:155], v157 offset:8448
s_waitcnt lgkmcnt(0)
v_mfma_f32_16x16x32_bf16 v[136:139], v[152:155], a[152:155], v[136:139]
v_mfma_f32_16x16x32_bf16 v[140:143], v[152:155], a[156:159], v[140:143]
s_nop 7
ds_read_b128 v[152:155], v158 offset:8448
s_waitcnt lgkmcnt(0)
v_mfma_f32_16x16x32_bf16 v[136:139], v[152:155], a[160:163], v[136:139]
v_mfma_f32_16x16x32_bf16 v[140:143], v[152:155], a[164:167], v[140:143]
s_nop 7
ds_read_b128 v[152:155], v159 offset:8448
s_waitcnt lgkmcnt(0)
v_mfma_f32_16x16x32_bf16 v[136:139], v[152:155], a[168:171], v[136:139]
v_mfma_f32_16x16x32_bf16 v[140:143], v[152:155], a[172:175], v[140:143]
s_nop 7
s_nop 7
s_nop 7
v_exp_f32 v128, v128
v_exp_f32 v129, v129
v_exp_f32 v130, v130
v_exp_f32 v131, v131
v_exp_f32 v132, v132
v_exp_f32 v133, v133
v_exp_f32 v134, v134
v_exp_f32 v135, v135
v_exp_f32 v136, v136
v_exp_f32 v137, v137
v_exp_f32 v138, v138
v_exp_f32 v139, v139
v_exp_f32 v140, v140
v_exp_f32 v141, v141
v_exp_f32 v142, v142
v_exp_f32 v143, v143
s_nop 1
v_cvt_pk_bf16_f32 v144, v128, v129
v_cvt_pk_bf16_f32 v145, v130, v131
v_cvt_pk_bf16_f32 v146, v136, v137
v_cvt_pk_bf16_f32 v147, v138, v139
v_cvt_pk_bf16_f32 v148, v132, v133
v_cvt_pk_bf16_f32 v149, v134, v135
v_cvt_pk_bf16_f32 v150, v140, v141
v_cvt_pk_bf16_f32 v151, v142, v143
s_nop 1
ds_read_b64_tr_b16 v[152:153], v236 offset:16384
ds_read_b64_tr_b16 v[154:155], v236 offset:24576
s_waitcnt lgkmcnt(0)
v_mfma_f32_16x16x32_bf16 v[0:3], v[152:155], v[144:147], v[0:3]
v_mfma_f32_16x16x32_bf16 v[4:7], v[152:155], v[148:151], v[4:7]
s_nop 7
ds_read_b64_tr_b16 v[152:153], v237 offset:16384
ds_read_b64_tr_b16 v[154:155], v237 offset:24576
s_waitcnt lgkmcnt(0)
v_mfma_f32_16x16x32_bf16 v[8:11], v[152:155], v[144:147], v[8:11]
v_mfma_f32_16x16x32_bf16 v[12:15], v[152:155], v[148:151], v[12:15]
s_nop 7
ds_read_b64_tr_b16 v[152:153], v238 offset:16384
ds_read_b64_tr_b16 v[154:155], v238 offset:24576
s_waitcnt lgkmcnt(0)
v_mfma_f32_16x16x32_bf16 v[16:19], v[152:155], v[144:147], v[16:19]
v_mfma_f32_16x16x32_bf16 v[20:23], v[152:155], v[148:151], v[20:23]
s_nop 7
ds_read_b64_tr_b16 v[152:153], v239 offset:16384
ds_read_b64_tr_b16 v[154:155], v239 offset:24576
s_waitcnt lgkmcnt(0)
v_mfma_f32_16x16x32_bf16 v[24:27], v[152:155], v[144:147], v[24:27]
v_mfma_f32_16x16x32_bf16 v[28:31], v[152:155], v[148:151], v[28:31]
s_nop 7
ds_read_b64_tr_b16 v[152:153], v240 offset:16384
ds_read_b64_tr_b16 v[154:155], v240 offset:24576
s_waitcnt lgkmcnt(0)
v_mfma_f32_16x16x32_bf16 v[32:35], v[152:155], v[144:147], v[32:35]
v_mfma_f32_16x16x32_bf16 v[36:39], v[152:155], v[148:151], v[36:39]
s_nop 7
ds_read_b64_tr_b16 v[152:153], v241 offset:16384
ds_read_b64_tr_b16 v[154:155], v241 offset:24576
s_waitcnt lgkmcnt(0)
v_mfma_f32_16x16x32_bf16 v[40:43], v[152:155], v[144:147], v[40:43]
v_mfma_f32_16x16x32_bf16 v[44:47], v[152:155], v[148:151], v[44:47]
s_nop 7
ds_read_b64_tr_b16 v[152:153], v242 offset:16384
ds_read_b64_tr_b16 v[154:155], v242 offset:24576
s_waitcnt lgkmcnt(0)
v_mfma_f32_16x16x32_bf16 v[48:51], v[152:155], v[144:147], v[48:51]
v_mfma_f32_16x16x32_bf16 v[52:55], v[152:155], v[148:151], v[52:55]
s_nop 7
ds_read_b64_tr_b16 v[152:153], v243 offset:16384
ds_read_b64_tr_b16 v[154:155], v243 offset:24576
s_waitcnt lgkmcnt(0)
v_mfma_f32_16x16x32_bf16 v[56:59], v[152:155], v[144:147], v[56:59]
v_mfma_f32_16x16x32_bf16 v[60:63], v[152:155], v[148:151], v[60:63]
s_nop 7
ds_read_b64_tr_b16 v[152:153], v236 offset:16640
ds_read_b64_tr_b16 v[154:155], v236 offset:24832
s_waitcnt lgkmcnt(0)
v_mfma_f32_16x16x32_bf16 v[64:67], v[152:155], v[144:147], v[64:67]
v_mfma_f32_16x16x32_bf16 v[68:71], v[152:155], v[148:151], v[68:71]
s_nop 7
ds_read_b64_tr_b16 v[152:153], v237 offset:16640
ds_read_b64_tr_b16 v[154:155], v237 offset:24832
s_waitcnt lgkmcnt(0)
v_mfma_f32_16x16x32_bf16 v[72:75], v[152:155], v[144:147], v[72:75]
v_mfma_f32_16x16x32_bf16 v[76:79], v[152:155], v[148:151], v[76:79]
s_nop 7
ds_read_b64_tr_b16 v[152:153], v238 offset:16640
ds_read_b64_tr_b16 v[154:155], v238 offset:24832
s_waitcnt lgkmcnt(0)
v_mfma_f32_16x16x32_bf16 v[80:83], v[152:155], v[144:147], v[80:83]
v_mfma_f32_16x16x32_bf16 v[84:87], v[152:155], v[148:151], v[84:87]
s_nop 7
ds_read_b64_tr_b16 v[152:153], v239 offset:16640
ds_read_b64_tr_b16 v[154:155], v239 offset:24832
s_waitcnt lgkmcnt(0)
v_mfma_f32_16x16x32_bf16 v[88:91], v[152:155], v[144:147], v[88:91]
v_mfma_f32_16x16x32_bf16 v[92:95], v[152:155], v[148:151], v[92:95]
s_nop 7
ds_read_b64_tr_b16 v[152:153], v240 offset:16640
ds_read_b64_tr_b16 v[154:155], v240 offset:24832
s_waitcnt lgkmcnt(0)
v_mfma_f32_16x16x32_bf16 v[96:99], v[152:155], v[144:147], v[96:99]
v_mfma_f32_16x16x32_bf16 v[100:103], v[152:155], v[148:151], v[100:103]
s_nop 7
ds_read_b64_tr_b16 v[152:153], v241 offset:16640
ds_read_b64_tr_b16 v[154:155], v241 offset:24832
s_waitcnt lgkmcnt(0)
v_mfma_f32_16x16x32_bf16 v[104:107], v[152:155], v[144:147], v[104:107]
v_mfma_f32_16x16x32_bf16 v[108:111], v[152:155], v[148:151], v[108:111]
s_nop 7
ds_read_b64_tr_b16 v[152:153], v242 offset:16640
ds_read_b64_tr_b16 v[154:155], v242 offset:24832
s_waitcnt lgkmcnt(0)
v_mfma_f32_16x16x32_bf16 v[112:115], v[152:155], v[144:147], v[112:115]
v_mfma_f32_16x16x32_bf16 v[116:119], v[152:155], v[148:151], v[116:119]
s_nop 7
ds_read_b64_tr_b16 v[152:153], v243 offset:16640
ds_read_b64_tr_b16 v[154:155], v243 offset:24832
s_waitcnt lgkmcnt(0)
v_mfma_f32_16x16x32_bf16 v[120:123], v[152:155], v[144:147], v[120:123]
v_mfma_f32_16x16x32_bf16 v[124:127], v[152:155], v[148:151], v[124:127]
s_nop 7
v_mfma_f32_16x16x32_bf16 v[176:179], v[196:199], v[144:147], v[176:179]
v_mfma_f32_16x16x32_bf16 v[180:183], v[196:199], v[148:151], v[180:183]
s_barrier
s_add_u32 s99, s99, 16384
s_branch L_fb_loop
L_fb_last:
ds_read_b128 v[152:155], v156 offset:0
s_waitcnt lgkmcnt(0)
v_mfma_f32_16x16x32_bf16 v[128:131], v[152:155], a[112:115], v[184:187]
v_mfma_f32_16x16x32_bf16 v[132:135], v[152:155], a[116:119], v[188:191]
s_nop 7
ds_read_b128 v[152:155], v157 offset:0
s_waitcnt lgkmcnt(0)
v_mfma_f32_16x16x32_bf16 v[128:131], v[152:155], a[120:123], v[128:131]
v_mfma_f32_16x16x32_bf16 v[132:135], v[152:155], a[124:127], v[132:135]
s_nop 7
ds_read_b128 v[152:155], v158 offset:0
s_waitcnt lgkmcnt(0)
v_mfma_f32_16x16x32_bf16 v[128:131], v[152:155], a[128:131], v[128:131]
v_mfma_f32_16x16x32_bf16 v[132:135], v[152:155], a[132:135], v[132:135]
s_nop 7
ds_read_b128 v[152:155], v159 offset:0
s_waitcnt lgkmcnt(0)
v_mfma_f32_16x16x32_bf16 v[128:131], v[152:155], a[136:139], v[128:131]
v_mfma_f32_16x16x32_bf16 v[132:135], v[152:155], a[140:143], v[132:135]
s_nop 7
ds_read_b128 v[152:155], v156 offset:256
s_waitcnt lgkmcnt(0)
v_mfma_f32_16x16x32_bf16 v[128:131], v[152:155], a[144:147], v[128:131]
v_mfma_f32_16x16x32_bf16 v[132:135], v[152:155], a[148:151], v[132:135]
s_nop 7
ds_read_b128 v[152:155], v157 offset:256
s_waitcnt lgkmcnt(0)
v_mfma_f32_16x16x32_bf16 v[128:131], v[152:155], a[152:155], v[128:131]
v_mfma_f32_16x16x32_bf16 v[132:135], v[152:155], a[156:159], v[132:135]
s_nop 7
ds_read_b128 v[152:155], v158 offset:256
s_waitcnt lgkmcnt(0)
v_mfma_f32_16x16x32_bf16 v[128:131], v[152:155], a[160:163], v[128:131]
v_mfma_f32_16x16x32_bf16 v[132:135], v[152:155], a[164:167], v[132:135]
s_nop 7
ds_read_b128 v[152:155], v159 offset:256
s_waitcnt lgkmcnt(0)
v_mfma_f32_16x16x32_bf16 v[128:131], v[152:155], a[168:171], v[128:131]
v_mfma_f32_16x16x32_bf16 v[132:135], v[152:155], a[172:175], v[132:135]
s_nop 7
ds_read_b128 v[152:155], v156 offset:8192
s_waitcnt lgkmcnt(0)
v_mfma_f32_16x16x32_bf16 v[136:139], v[152:155], a[112:115], v[184:187]
v_mfma_f32_16x16x32_bf16 v[140:143], v[152:155], a[116:119], v[188:191]
s_nop 7
ds_read_b128 v[152:155], v157 offset:8192
s_waitcnt lgkmcnt(0)
v_mfma_f32_16x16x32_bf16 v[136:139], v[152:155], a[120:123], v[136:139]
v_mfma_f32_16x16x32_bf16 v[140:143], v[152:155], a[124:127], v[140:143]
s_nop 7
ds_read_b128 v[152:155], v158 offset:8192
s_waitcnt lgkmcnt(0)
v_mfma_f32_16x16x32_bf16 v[136:139], v[152:155], a[128:131], v[136:139]
v_mfma_f32_16x16x32_bf16 v[140:143], v[152:155], a[132:135], v[140:143]
s_nop 7
ds_read_b128 v[152:155], v159 offset:8192
s_waitcnt lgkmcnt(0)
v_mfma_f32_16x16x32_bf16 v[136:139], v[152:155], a[136:139], v[136:139]
v_mfma_f32_16x16x32_bf16 v[140:143], v[152:155], a[140:143], v[140:143]
s_nop 7
ds_read_b128 v[152:155], v156 offset:8448
s_waitcnt lgkmcnt(0)
v_mfma_f32_16x16x32_bf16 v[136:139], v[152:155], a[144:147], v[136:139]
v_mfma_f32_16x16x32_bf16 v[140:143], v[152:155], a[148:151], v[140:143]
s_nop 7
ds_read_b128 v[152:155], v157 offset:8448
s_waitcnt lgkmcnt(0)
v_mfma_f32_16x16x32_bf16 v[136:139], v[152:155], a[152:155], v[136:139]
v_mfma_f32_16x16x32_bf16 v[140:143], v[152:155], a[156:159], v[140:143]
s_nop 7
ds_read_b128 v[152:155], v158 offset:8448
s_waitcnt lgkmcnt(0)
v_mfma_f32_16x16x32_bf16 v[136:139], v[152:155], a[160:163], v[136:139]
v_mfma_f32_16x16x32_bf16 v[140:143], v[152:155], a[164:167], v[140:143]
s_nop 7
ds_read_b128 v[152:155], v159 offset:8448
s_waitcnt lgkmcnt(0)
v_mfma_f32_16x16x32_bf16 v[136:139], v[152:155], a[168:171], v[136:139]
v_mfma_f32_16x16x32_bf16 v[140:143], v[152:155], a[172:175], v[140:143]
s_nop 7
s_nop 7
s_nop 7
v_exp_f32 v128, v128
v_exp_f32 v129, v129
v_exp_f32 v130, v130
v_exp_f32 v131, v131
v_exp_f32 v132, v132
v_exp_f32 v133, v133
v_exp_f32 v134, v134
v_exp_f32 v135, v135
v_exp_f32 v136, v136
v_exp_f32 v137, v137
v_exp_f32 v138, v138
v_exp_f32 v139, v139
v_exp_f32 v140, v140
v_exp_f32 v141, v141
v_exp_f32 v142, v142
v_exp_f32 v143, v143
s_nop 1
v_cvt_pk_bf16_f32 v168, v128, v129
v_cvt_pk_bf16_f32 v169, v130, v131
v_cvt_pk_bf16_f32 v170, v136, v137
v_cvt_pk_bf16_f32 v171, v138, v139
v_cvt_pk_bf16_f32 v172, v132, v133
v_cvt_pk_bf16_f32 v173, v134, v135
v_cvt_pk_bf16_f32 v174, v140, v141
v_cvt_pk_bf16_f32 v175, v142, v143
s_nop 1
s_barrier
s_nop 7
s_nop 7
s_branch L_fb_ret
.section .rodata,"a"
.p2align 6
.amdhsa_kernel recurrent_scan__sliding_block_cached__glu_gated_geglu__prompt_kernel
  .amdhsa_next_free_vgpr 512
  .amdhsa_next_free_sgpr 102
  .amdhsa_accum_offset 256
  .amdhsa_group_segment_fixed_size 0
  .amdhsa_kernarg_size 96
  .amdhsa_user_sgpr_count 2
  .amdhsa_user_sgpr_kernarg_segment_ptr 1
  .amdhsa_system_sgpr_workgroup_id_x 1
.end_amdhsa_kernel
.text
```
